```python
import torch

def _softmax(x, axis=-1):
    return torch.softmax(x, dim=axis)

def _gelu(x):
    return torch.nn.functional.gelu(x, approximate='tanh')

def _silu(x):
    return torch.nn.functional.silu(x)

def _sigmoid(x):
    return torch.sigmoid(x)

def _layernorm(x, axis=-1, eps=1e-05):
    m = x.mean(dim=axis, keepdim=True)
    v = x.var(dim=axis, keepdim=True, unbiased=False)
    return (x - m) / torch.sqrt(v + eps)

def _scatter_add(tgt, idx, src, axis=0):
    return tgt.clone().index_add_(axis, idx, src)

def _segment_sum(src, seg, n):
    out = torch.zeros((n,) + src.shape[1:], dtype=src.dtype)
    return out.index_add_(0, seg, src)

def _pad(x, pw):
    flat = tuple((v for pair in reversed(pw) for v in pair))
    return torch.nn.functional.pad(x, flat)
kernel_name = 'recurrent_scan__sliding_local_dilated__mixer_gmlp__prompt'

def setup_inputs():

    _w = lambda a: (lambda t: t.to(torch.bfloat16) if t.is_floating_point() else t)(torch.as_tensor(a))

    def _A_setup():
        B, S, D = (1, 2048, 576)
        return {'x': _w((lambda *s: torch.randn(*s, dtype=torch.bfloat16) * 0.05)(B, S, D)), 'wqkv': _w((lambda *s: torch.randn(*s, dtype=torch.bfloat16) * 0.05)(D, 3 * D)), 'wo': _w((lambda *s: torch.randn(*s, dtype=torch.bfloat16) * 0.05)(D, D))}
    _A_in = _A_setup()

    def _B_setup():
        B, S, D, F = (1, 2048, 576, 4608)
        Fh = F // 2
        return {'x': _w((lambda *s: torch.randn(*s, dtype=torch.bfloat16) * 0.05)(B, S, D)), 'w_in': _w((lambda *s: torch.randn(*s, dtype=torch.bfloat16) * 0.8)(D, 2 * Fh)), 'w_sp': _w(0.01 * (lambda *s: torch.randn(*s, dtype=torch.bfloat16) * 0.8)(S, S)), 'b_sp': _w(1.0 + 0.01 * (lambda *s: torch.randn(*s, dtype=torch.bfloat16) * 0.05)(S)), 'w_out': _w((lambda *s: torch.randn(*s, dtype=torch.bfloat16) * 0.05)(Fh, D))}
    _B_in = _B_setup()
    return {'A_x': _A_in['x'], 'A_wqkv': _A_in['wqkv'], 'A_wo': _A_in['wo'], 'B_x': _B_in['x'], 'B_w_in': _B_in['w_in'], 'B_w_sp': _B_in['w_sp'], 'B_b_sp': _B_in['b_sp'], 'B_w_out': _B_in['w_out']}

def reference(A_x, A_wqkv, A_wo, B_x, B_w_in, B_w_sp, B_b_sp, B_w_out):

    def _A_ref(x, wqkv, wo):
        B, S, D = x.shape
        H = 32
        Dh = D // H
        W, dil = (8, 2)
        qkv = (lambda x, *d: x.permute(*d))((x @ wqkv).reshape(B, S, 3, H, Dh), 2, 0, 3, 1, 4)
        q, k, v = (qkv[0], qkv[1], qkv[2])
        scale = Dh ** (-0.5)
        pos = torch.arange(S)
        off = torch.arange(W) * dil
        idx = pos[:, None] - off[None, :]
        mask = idx >= 0
        idx_c = torch.where(mask, idx, 0).reshape(-1)
        kg = k[:, :, idx_c, :].reshape(B, H, S, W, Dh)
        vg = v[:, :, idx_c, :].reshape(B, H, S, W, Dh)
        logits = torch.einsum('bhsd,bhswd->bhsw', q, kg) * scale
        logits = torch.where(mask[None, None, :, :], logits, -1000000000.0)
        attn = _softmax(logits, axis=-1)
        o = torch.einsum('bhsw,bhswd->bhsd', attn, vg)
        return (lambda x, *d: x.permute(*d))(o, 0, 2, 1, 3).reshape(B, S, D) @ wo

    def _B_ref(x, w_in, w_sp, b_sp, w_out):
        B, S, D = x.shape
        F = w_in.shape[-1]
        Fh = F // 2
        z = _gelu(torch.einsum('bsd,df->bsf', x, w_in))
        z1 = z[..., :Fh].clone()
        z2 = _layernorm(z[..., Fh:], axis=-1)
        g = torch.einsum('ts,bsf->btf', w_sp, z2) + b_sp[None, :, None]
        return torch.einsum('bsf,fd->bsd', z1 * g, w_out)
    x = A_x
    xn = _layernorm(x, axis=-1)
    s = _A_ref(xn, A_wqkv, A_wo)
    g = _silu(_B_ref(xn, B_w_in, B_w_sp, B_b_sp, B_w_out))
    return x + s * g
```

```asm
; @launch grid=(256,1,1) block=(512,1,1) lds=163840
.amdgcn_target "amdgcn-amd-amdhsa--gfx950"
.text
.p2align 8
code_begin:
.text
.globl recurrent_scan__sliding_local_dilated__mixer_gmlp__prompt_kernel
.p2align 8
.type recurrent_scan__sliding_local_dilated__mixer_gmlp__prompt_kernel,@function
recurrent_scan__sliding_local_dilated__mixer_gmlp__prompt_kernel:
    s_cmp_ge_u32 s2, 256
    s_cbranch_scc1 recurrent_scan__sliding_local_dilated__mixer_gmlp__prompt_kernel_end
    s_load_dwordx4 s[4:7], s[0:1], 0
    s_load_dwordx4 s[8:11], s[0:1], 32
    s_load_dwordx4 s[96:99], s[0:1], 72
    v_and_b32 v1, 63, v0
    v_lshrrev_b32 v16, 6, v0
    s_nop 0
    v_readfirstlane_b32 s36, v16
    s_and_b32 s72, s2, 7
    s_lshr_b32 s73, s2, 3
    s_and_b32 s37, s72, 1
    s_lshl_b32 s37, s37, 3
    s_and_b32 s74, s73, 7
    s_add_u32 s37, s37, s74
    s_lshr_b32 s38, s72, 1
    s_lshl_b32 s38, s38, 2
    s_lshr_b32 s74, s73, 3
    s_add_u32 s38, s38, s74
    s_and_b32 s60, s73, 7
    s_lshl_b32 s60, s60, 1
    s_add_u32 s60, s60, s74
    s_mul_i32 s60, s60, 0
    s_sub_u32 s74, s60, 9
    s_min_u32 s60, s60, s74
    s_sub_u32 s74, s60, 9
    s_min_u32 s60, s60, s74
    v_lshrrev_b32 v16, 3, v1
    v_and_b32 v17, 7, v1
    s_cmp_ge_u32 s36, 4
    s_cbranch_scc1 recurrent_scan__sliding_local_dilated__mixer_gmlp__prompt_kernel_prod
    v_lshrrev_b32 v18, 4, v1
    v_xor_b32 v18, v18, v17
    v_lshlrev_b32 v18, 4, v18
    v_mul_u32_u24 v56, 1152, v16
    v_add_u32 v56, v56, v18
    v_xor_b32 v57, 64, v56
    s_lshl_b32 s72, s37, 7
    s_lshl_b32 s73, s36, 5
    s_add_u32 s72, s72, s73
    s_mul_i32 s68, s72, 1152
    s_add_u32 s69, s68, 8192
    s_add_u32 s70, s68, 16384
    s_add_u32 s71, s68, 24576
    s_lshl_b32 s75, s36, 14
    s_add_u32 s75, s75, 73728
    s_lshl_b32 s79, s36, 12
    s_add_u32 s79, s79, 147456
    s_waitcnt lgkmcnt(0)
    s_mov_b32 s12, s4
    s_mov_b32 s13, s5
    s_mov_b32 s14, 2359296
    s_mov_b32 s15, 0x00020000
    s_lshl_b32 s51, s60, 7
    v_add_u32 v58, s51, v56
    v_add_u32 v59, s51, v57
    s_add_u32 m0, s75, 0
    s_add_u32 s51, s51, 128
    buffer_load_dwordx4 v58, s[12:15], s68 offen offset:0  lds
    buffer_load_dwordx4 v59, s[12:15], s69 offen offset:1024  lds
    buffer_load_dwordx4 v58, s[12:15], s70 offen offset:2048  lds
    buffer_load_dwordx4 v59, s[12:15], s71 offen offset:3072  lds
    s_cmp_eq_u32 s51, 1152
    s_cselect_b32 s51, 0, s51
    v_add_u32 v58, s51, v56
    v_add_u32 v59, s51, v57
    s_add_u32 m0, s75, 4096
    s_add_u32 s51, s51, 128
    buffer_load_dwordx4 v58, s[12:15], s68 offen offset:0  lds
    buffer_load_dwordx4 v59, s[12:15], s69 offen offset:1024  lds
    buffer_load_dwordx4 v58, s[12:15], s70 offen offset:2048  lds
    buffer_load_dwordx4 v59, s[12:15], s71 offen offset:3072  lds
    s_cmp_eq_u32 s51, 1152
    s_cselect_b32 s51, 0, s51
    v_add_u32 v58, s51, v56
    v_add_u32 v59, s51, v57
    s_add_u32 m0, s75, 8192
    s_add_u32 s51, s51, 128
    buffer_load_dwordx4 v58, s[12:15], s68 offen offset:0  lds
    buffer_load_dwordx4 v59, s[12:15], s69 offen offset:1024  lds
    buffer_load_dwordx4 v58, s[12:15], s70 offen offset:2048  lds
    buffer_load_dwordx4 v59, s[12:15], s71 offen offset:3072  lds
    s_cmp_eq_u32 s51, 1152
    s_cselect_b32 s51, 0, s51
    v_add_u32 v58, s51, v56
    v_add_u32 v59, s51, v57
    s_add_u32 m0, s75, 12288
    s_add_u32 s51, s51, 128
    buffer_load_dwordx4 v58, s[12:15], s68 offen offset:0  lds
    buffer_load_dwordx4 v59, s[12:15], s69 offen offset:1024  lds
    buffer_load_dwordx4 v58, s[12:15], s70 offen offset:2048  lds
    buffer_load_dwordx4 v59, s[12:15], s71 offen offset:3072  lds
    s_cmp_eq_u32 s51, 1152
    s_cselect_b32 s51, 0, s51
    v_add_u32 v58, s51, v56
    v_add_u32 v59, s51, v57
    s_mov_b32 m0, s79
    s_add_u32 s51, s51, 128
    buffer_load_dwordx4 v58, s[12:15], s68 offen offset:0  lds
    buffer_load_dwordx4 v59, s[12:15], s69 offen offset:1024  lds
    buffer_load_dwordx4 v58, s[12:15], s70 offen offset:2048  lds
    buffer_load_dwordx4 v59, s[12:15], s71 offen offset:3072  lds
    s_cmp_eq_u32 s51, 1152
    s_cselect_b32 s51, 0, s51
    s_add_u32 s24, s98, 0
    s_addc_u32 s25, s99, 0
    s_mov_b32 s26, 25952256
    s_mov_b32 s27, 0x00020000
    s_add_u32 s28, s98, 51392512
    s_addc_u32 s29, s99, 0
    s_mov_b32 s30, 4096
    s_mov_b32 s31, 0x00020000
    s_lshl_b32 s32, s37, 8
    s_lshl_b32 s72, s38, 4
    s_add_u32 s32, s32, s72
    s_lshl_b32 s72, s36, 2
    s_add_u32 s32, s32, s72
    v_mov_b32 v12, 163832
    v_mov_b32 v13, 0
    s_min_u32 s72, s38, 4
    s_lshl_b32 s42, s38, 1
    s_add_u32 s42, s42, s72
    s_add_u32 s42, s42, 36
    s_lshl_b32 s72, s38, 1
    s_sub_u32 s72, s72, 6
    s_sub_u32 s44, s38, 3
    s_cmp_lt_u32 s38, 4
    s_cselect_b32 s39, 3, 2
    s_cselect_b32 s44, s44, s72
    s_mul_i32 s3, s38, 288
    s_and_b32 s72, s38, 1
    s_lshl_b32 s73, s72, 5
    s_add_u32 s43, s3, s73
    s_sub_u32 s43, s43, 512
    s_xor_b32 s72, s72, 1
    s_lshl_b32 s72, s72, 8
    s_add_u32 s3, s3, s72
    s_add_u32 s72, s38, 1
    s_bfe_u32 s41, s72, 0x10001
    s_mov_b32 s101, 73728
    s_mov_b32 s63, 0x409d30fc
    s_mov_b32 s64, 0x00003f80
    s_mov_b32 s65, 0x3f800000
    s_mov_b32 s66, 0x3f803f80
    s_mov_b32 s46, 0
    s_add_u32 s72, s42, s46
    s_add_u32 s74, s44, s46
    s_min_u32 s74, s74, 26
    s_add_u32 s74, s74, 72
    s_cmp_lt_u32 s46, s39
    s_cselect_b32 s47, s72, s74
    s_cselect_b32 s48, -1, 0
    s_lshl_b32 s59, s47, 18
    v_lshrrev_b32 v18, 5, v1
    v_lshlrev_b32 v18, 3, v18
    v_bfe_u32 v19, v1, 2, 2
    v_add_u32 v18, v18, v19
    v_lshlrev_b32 v4, 7, v18
    v_lshrrev_b32 v19, 1, v19
    v_lshl_add_u32 v4, v19, 6, v4
    v_bfe_u32 v19, v1, 4, 1
    v_lshl_add_u32 v4, v19, 5, v4
    v_and_b32 v19, 1, v1
    v_lshl_add_u32 v4, v19, 4, v4
    v_lshlrev_b32 v5, 3, v19
    v_bfe_u32 v19, v1, 1, 1
    v_lshl_add_u32 v4, v19, 3, v4
    v_and_b32 v23, s48, v5
    v_xor_b32 v2, v23, v4
    v_xor_b32 v3, 64, v2
    v_and_b32 v18, 31, v1
    v_bfe_u32 v19, v1, 1, 3
    v_lshrrev_b32 v20, 5, v1
    v_xor_b32 v19, v19, v20
    v_lshlrev_b32 v19, 4, v19
    v_lshl_add_u32 v19, v18, 7, v19
    v_add_u32 v60, s75, v19
    v_xor_b32 v61, 32, v60
    v_xor_b32 v62, 64, v60
    v_xor_b32 v63, 96, v60
    v_add_u32 v64, s79, v19
    v_xor_b32 v65, 32, v64
    v_xor_b32 v66, 64, v64
    v_xor_b32 v67, 96, v64
    v_lshlrev_b32 v7, 3, v1
    v_add_u32 v7, s79, v7
    s_lshl_b32 s72, s37, 7
    s_lshl_b32 s73, s36, 5
    s_add_u32 s72, s72, s73
    v_add_u32 v6, s72, v18
    v_lshlrev_b32 v6, 4, v6
    v_lshl_add_u32 v6, v20, 15, v6
    v_mov_b32 v10, 0
    v_mov_b32 v11, 0
    v_lshlrev_b32 v68, 4, v1
    v_add_u32 v68, s75, v68
    s_waitcnt vmcnt(16)
    ds_read_b128 v[112:115], v60 offset:0
    ds_read_b128 v[116:119], v61 offset:0
    ds_read_b128 v[120:123], v62 offset:0
    ds_read_b128 v[124:127], v63 offset:0
    v_add_u32 v58, s51, v56
    v_add_u32 v59, s51, v57
    s_add_u32 s51, s51, 128
    buffer_load_dwordx4 v[192:195], v58, s[12:15], s68 offen offset:0
    buffer_load_dwordx4 v[196:199], v59, s[12:15], s69 offen offset:1024
    buffer_load_dwordx4 v[200:203], v58, s[12:15], s70 offen offset:2048
    buffer_load_dwordx4 v[204:207], v59, s[12:15], s71 offen offset:3072
    s_cmp_eq_u32 s51, 1152
    s_cselect_b32 s51, 0, s51
    s_waitcnt vmcnt(16)
    ds_read_b128 v[128:131], v60 offset:4096
    ds_read_b128 v[132:135], v61 offset:4096
    ds_read_b128 v[136:139], v62 offset:4096
    ds_read_b128 v[140:143], v63 offset:4096
    v_add_u32 v58, s51, v56
    v_add_u32 v59, s51, v57
    s_add_u32 s51, s51, 128
    buffer_load_dwordx4 v[208:211], v58, s[12:15], s68 offen offset:0
    buffer_load_dwordx4 v[212:215], v59, s[12:15], s69 offen offset:1024
    buffer_load_dwordx4 v[216:219], v58, s[12:15], s70 offen offset:2048
    buffer_load_dwordx4 v[220:223], v59, s[12:15], s71 offen offset:3072
    s_cmp_eq_u32 s51, 1152
    s_cselect_b32 s51, 0, s51
    s_waitcnt lgkmcnt(4)
.p2align 3
    v_dot2_f32_bf16 v48, v112, s66, 0
    v_dot2_f32_bf16 v49, v112, v112, 0
    v_dot2_f32_bf16 v50, v113, s66, 0
    v_dot2_f32_bf16 v51, v113, v113, 0
    v_dot2_f32_bf16 v48, v114, s66, v48
    v_dot2_f32_bf16 v49, v114, v114, v49
    v_dot2_f32_bf16 v50, v115, s66, v50
    v_dot2_f32_bf16 v51, v115, v115, v51
    v_dot2_f32_bf16 v48, v116, s66, v48
    v_dot2_f32_bf16 v49, v116, v116, v49
    v_dot2_f32_bf16 v50, v117, s66, v50
    v_dot2_f32_bf16 v51, v117, v117, v51
    v_dot2_f32_bf16 v48, v118, s66, v48
    v_dot2_f32_bf16 v49, v118, v118, v49
    v_dot2_f32_bf16 v50, v119, s66, v50
    v_dot2_f32_bf16 v51, v119, v119, v51
    v_dot2_f32_bf16 v48, v120, s66, v48
    v_dot2_f32_bf16 v49, v120, v120, v49
    v_dot2_f32_bf16 v50, v121, s66, v50
    v_dot2_f32_bf16 v51, v121, v121, v51
    v_dot2_f32_bf16 v48, v122, s66, v48
    v_dot2_f32_bf16 v49, v122, v122, v49
    v_dot2_f32_bf16 v50, v123, s66, v50
    v_dot2_f32_bf16 v51, v123, v123, v51
    v_dot2_f32_bf16 v48, v124, s66, v48
    v_dot2_f32_bf16 v49, v124, v124, v49
    v_dot2_f32_bf16 v50, v125, s66, v50
    v_dot2_f32_bf16 v51, v125, v125, v51
    v_dot2_f32_bf16 v48, v126, s66, v48
    v_dot2_f32_bf16 v49, v126, v126, v49
    v_dot2_f32_bf16 v50, v127, s66, v50
    v_dot2_f32_bf16 v51, v127, v127, v51
    s_waitcnt vmcnt(16)
    ds_read_b128 v[144:147], v60 offset:8192
    ds_read_b128 v[148:151], v61 offset:8192
    ds_read_b128 v[152:155], v62 offset:8192
    ds_read_b128 v[156:159], v63 offset:8192
    v_add_u32 v58, s51, v56
    v_add_u32 v59, s51, v57
    s_add_u32 s51, s51, 128
    buffer_load_dwordx4 v[224:227], v58, s[12:15], s68 offen offset:0
    buffer_load_dwordx4 v[228:231], v59, s[12:15], s69 offen offset:1024
    buffer_load_dwordx4 v[232:235], v58, s[12:15], s70 offen offset:2048
    buffer_load_dwordx4 v[236:239], v59, s[12:15], s71 offen offset:3072
    s_cmp_eq_u32 s51, 1152
    s_cselect_b32 s51, 0, s51
    s_waitcnt lgkmcnt(4)
.p2align 3
    v_dot2_f32_bf16 v48, v128, s66, v48
    v_dot2_f32_bf16 v49, v128, v128, v49
    v_dot2_f32_bf16 v50, v129, s66, v50
    v_dot2_f32_bf16 v51, v129, v129, v51
    v_dot2_f32_bf16 v48, v130, s66, v48
    v_dot2_f32_bf16 v49, v130, v130, v49
    v_dot2_f32_bf16 v50, v131, s66, v50
    v_dot2_f32_bf16 v51, v131, v131, v51
    v_dot2_f32_bf16 v48, v132, s66, v48
    v_dot2_f32_bf16 v49, v132, v132, v49
    v_dot2_f32_bf16 v50, v133, s66, v50
    v_dot2_f32_bf16 v51, v133, v133, v51
    v_dot2_f32_bf16 v48, v134, s66, v48
    v_dot2_f32_bf16 v49, v134, v134, v49
    v_dot2_f32_bf16 v50, v135, s66, v50
    v_dot2_f32_bf16 v51, v135, v135, v51
    v_dot2_f32_bf16 v48, v136, s66, v48
    v_dot2_f32_bf16 v49, v136, v136, v49
    v_dot2_f32_bf16 v50, v137, s66, v50
    v_dot2_f32_bf16 v51, v137, v137, v51
    v_dot2_f32_bf16 v48, v138, s66, v48
    v_dot2_f32_bf16 v49, v138, v138, v49
    v_dot2_f32_bf16 v50, v139, s66, v50
    v_dot2_f32_bf16 v51, v139, v139, v51
    v_dot2_f32_bf16 v48, v140, s66, v48
    v_dot2_f32_bf16 v49, v140, v140, v49
    v_dot2_f32_bf16 v50, v141, s66, v50
    v_dot2_f32_bf16 v51, v141, v141, v51
    v_dot2_f32_bf16 v48, v142, s66, v48
    v_dot2_f32_bf16 v49, v142, v142, v49
    v_dot2_f32_bf16 v50, v143, s66, v50
    v_dot2_f32_bf16 v51, v143, v143, v51
    s_waitcnt vmcnt(16)
    ds_read_b128 v[160:163], v60 offset:12288
    ds_read_b128 v[164:167], v61 offset:12288
    ds_read_b128 v[168:171], v62 offset:12288
    ds_read_b128 v[172:175], v63 offset:12288
    v_add_u32 v58, s51, v56
    v_add_u32 v59, s51, v57
    s_add_u32 s51, s51, 128
    buffer_load_dwordx4 v[240:243], v58, s[12:15], s68 offen offset:0
    buffer_load_dwordx4 v[244:247], v59, s[12:15], s69 offen offset:1024
    buffer_load_dwordx4 v[248:251], v58, s[12:15], s70 offen offset:2048
    buffer_load_dwordx4 v[252:255], v59, s[12:15], s71 offen offset:3072
    s_cmp_eq_u32 s51, 1152
    s_cselect_b32 s51, 0, s51
    s_waitcnt lgkmcnt(4)
.p2align 3
    v_dot2_f32_bf16 v48, v144, s66, v48
    v_dot2_f32_bf16 v49, v144, v144, v49
    v_dot2_f32_bf16 v50, v145, s66, v50
    v_dot2_f32_bf16 v51, v145, v145, v51
    v_dot2_f32_bf16 v48, v146, s66, v48
    v_dot2_f32_bf16 v49, v146, v146, v49
    v_dot2_f32_bf16 v50, v147, s66, v50
    v_dot2_f32_bf16 v51, v147, v147, v51
    v_dot2_f32_bf16 v48, v148, s66, v48
    v_dot2_f32_bf16 v49, v148, v148, v49
    v_dot2_f32_bf16 v50, v149, s66, v50
    v_dot2_f32_bf16 v51, v149, v149, v51
    v_dot2_f32_bf16 v48, v150, s66, v48
    v_dot2_f32_bf16 v49, v150, v150, v49
    v_dot2_f32_bf16 v50, v151, s66, v50
    v_dot2_f32_bf16 v51, v151, v151, v51
    v_dot2_f32_bf16 v48, v152, s66, v48
    v_dot2_f32_bf16 v49, v152, v152, v49
    v_dot2_f32_bf16 v50, v153, s66, v50
    v_dot2_f32_bf16 v51, v153, v153, v51
    v_dot2_f32_bf16 v48, v154, s66, v48
    v_dot2_f32_bf16 v49, v154, v154, v49
    v_dot2_f32_bf16 v50, v155, s66, v50
    v_dot2_f32_bf16 v51, v155, v155, v51
    v_dot2_f32_bf16 v48, v156, s66, v48
    v_dot2_f32_bf16 v49, v156, v156, v49
    v_dot2_f32_bf16 v50, v157, s66, v50
    v_dot2_f32_bf16 v51, v157, v157, v51
    v_dot2_f32_bf16 v48, v158, s66, v48
    v_dot2_f32_bf16 v49, v158, v158, v49
    v_dot2_f32_bf16 v50, v159, s66, v50
    v_dot2_f32_bf16 v51, v159, v159, v51
    s_waitcnt vmcnt(16)
    ds_read_b128 v[176:179], v64
    ds_read_b128 v[180:183], v65
    ds_read_b128 v[184:187], v66
    ds_read_b128 v[188:191], v67
    s_waitcnt lgkmcnt(4)
.p2align 3
    v_dot2_f32_bf16 v48, v160, s66, v48
    v_dot2_f32_bf16 v49, v160, v160, v49
    v_dot2_f32_bf16 v50, v161, s66, v50
    v_dot2_f32_bf16 v51, v161, v161, v51
    v_dot2_f32_bf16 v48, v162, s66, v48
    v_dot2_f32_bf16 v49, v162, v162, v49
    v_dot2_f32_bf16 v50, v163, s66, v50
    v_dot2_f32_bf16 v51, v163, v163, v51
    v_dot2_f32_bf16 v48, v164, s66, v48
    v_dot2_f32_bf16 v49, v164, v164, v49
    v_dot2_f32_bf16 v50, v165, s66, v50
    v_dot2_f32_bf16 v51, v165, v165, v51
    v_dot2_f32_bf16 v48, v166, s66, v48
    v_dot2_f32_bf16 v49, v166, v166, v49
    v_dot2_f32_bf16 v50, v167, s66, v50
    v_dot2_f32_bf16 v51, v167, v167, v51
    v_dot2_f32_bf16 v48, v168, s66, v48
    v_dot2_f32_bf16 v49, v168, v168, v49
    v_dot2_f32_bf16 v50, v169, s66, v50
    v_dot2_f32_bf16 v51, v169, v169, v51
    v_dot2_f32_bf16 v48, v170, s66, v48
    v_dot2_f32_bf16 v49, v170, v170, v49
    v_dot2_f32_bf16 v50, v171, s66, v50
    v_dot2_f32_bf16 v51, v171, v171, v51
    v_dot2_f32_bf16 v48, v172, s66, v48
    v_dot2_f32_bf16 v49, v172, v172, v49
    v_dot2_f32_bf16 v50, v173, s66, v50
    v_dot2_f32_bf16 v51, v173, v173, v51
    v_dot2_f32_bf16 v48, v174, s66, v48
    v_dot2_f32_bf16 v49, v174, v174, v49
    v_dot2_f32_bf16 v50, v175, s66, v50
    v_dot2_f32_bf16 v51, v175, v175, v51
    s_waitcnt vmcnt(12)
    ds_write_b128 v68, v[192:195] offset:0
    ds_write_b128 v68, v[196:199] offset:1024
    ds_write_b128 v68, v[200:203] offset:2048
    ds_write_b128 v68, v[204:207] offset:3072
    ds_read_b128 v[192:195], v60 offset:0
    ds_read_b128 v[196:199], v61 offset:0
    ds_read_b128 v[200:203], v62 offset:0
    ds_read_b128 v[204:207], v63 offset:0
    s_waitcnt lgkmcnt(8)
.p2align 3
    v_dot2_f32_bf16 v48, v176, s66, v48
    v_dot2_f32_bf16 v49, v176, v176, v49
    v_dot2_f32_bf16 v50, v177, s66, v50
    v_dot2_f32_bf16 v51, v177, v177, v51
    v_dot2_f32_bf16 v48, v178, s66, v48
    v_dot2_f32_bf16 v49, v178, v178, v49
    v_dot2_f32_bf16 v50, v179, s66, v50
    v_dot2_f32_bf16 v51, v179, v179, v51
    v_dot2_f32_bf16 v48, v180, s66, v48
    v_dot2_f32_bf16 v49, v180, v180, v49
    v_dot2_f32_bf16 v50, v181, s66, v50
    v_dot2_f32_bf16 v51, v181, v181, v51
    v_dot2_f32_bf16 v48, v182, s66, v48
    v_dot2_f32_bf16 v49, v182, v182, v49
    v_dot2_f32_bf16 v50, v183, s66, v50
    v_dot2_f32_bf16 v51, v183, v183, v51
    v_dot2_f32_bf16 v48, v184, s66, v48
    v_dot2_f32_bf16 v49, v184, v184, v49
    v_dot2_f32_bf16 v50, v185, s66, v50
    v_dot2_f32_bf16 v51, v185, v185, v51
    v_dot2_f32_bf16 v48, v186, s66, v48
    v_dot2_f32_bf16 v49, v186, v186, v49
    v_dot2_f32_bf16 v50, v187, s66, v50
    v_dot2_f32_bf16 v51, v187, v187, v51
    v_dot2_f32_bf16 v48, v188, s66, v48
    v_dot2_f32_bf16 v49, v188, v188, v49
    v_dot2_f32_bf16 v50, v189, s66, v50
    v_dot2_f32_bf16 v51, v189, v189, v51
    v_dot2_f32_bf16 v48, v190, s66, v48
    v_dot2_f32_bf16 v49, v190, v190, v49
    v_dot2_f32_bf16 v50, v191, s66, v50
    v_dot2_f32_bf16 v51, v191, v191, v51
    s_waitcnt vmcnt(8)
    ds_write_b128 v68, v[208:211] offset:4096
    ds_write_b128 v68, v[212:215] offset:5120
    ds_write_b128 v68, v[216:219] offset:6144
    ds_write_b128 v68, v[220:223] offset:7168
    ds_read_b128 v[208:211], v60 offset:4096
    ds_read_b128 v[212:215], v61 offset:4096
    ds_read_b128 v[216:219], v62 offset:4096
    ds_read_b128 v[220:223], v63 offset:4096
    s_waitcnt lgkmcnt(8)
.p2align 3
    v_dot2_f32_bf16 v48, v192, s66, v48
    v_dot2_f32_bf16 v49, v192, v192, v49
    v_dot2_f32_bf16 v50, v193, s66, v50
    v_dot2_f32_bf16 v51, v193, v193, v51
    v_dot2_f32_bf16 v48, v194, s66, v48
    v_dot2_f32_bf16 v49, v194, v194, v49
    v_dot2_f32_bf16 v50, v195, s66, v50
    v_dot2_f32_bf16 v51, v195, v195, v51
    v_dot2_f32_bf16 v48, v196, s66, v48
    v_dot2_f32_bf16 v49, v196, v196, v49
    v_dot2_f32_bf16 v50, v197, s66, v50
    v_dot2_f32_bf16 v51, v197, v197, v51
    v_dot2_f32_bf16 v48, v198, s66, v48
    v_dot2_f32_bf16 v49, v198, v198, v49
    v_dot2_f32_bf16 v50, v199, s66, v50
    v_dot2_f32_bf16 v51, v199, v199, v51
    v_dot2_f32_bf16 v48, v200, s66, v48
    v_dot2_f32_bf16 v49, v200, v200, v49
    v_dot2_f32_bf16 v50, v201, s66, v50
    v_dot2_f32_bf16 v51, v201, v201, v51
    v_dot2_f32_bf16 v48, v202, s66, v48
    v_dot2_f32_bf16 v49, v202, v202, v49
    v_dot2_f32_bf16 v50, v203, s66, v50
    v_dot2_f32_bf16 v51, v203, v203, v51
    v_dot2_f32_bf16 v48, v204, s66, v48
    v_dot2_f32_bf16 v49, v204, v204, v49
    v_dot2_f32_bf16 v50, v205, s66, v50
    v_dot2_f32_bf16 v51, v205, v205, v51
    v_dot2_f32_bf16 v48, v206, s66, v48
    v_dot2_f32_bf16 v49, v206, v206, v49
    v_dot2_f32_bf16 v50, v207, s66, v50
    v_dot2_f32_bf16 v51, v207, v207, v51
    s_waitcnt vmcnt(4)
    ds_write_b128 v68, v[224:227] offset:8192
    ds_write_b128 v68, v[228:231] offset:9216
    ds_write_b128 v68, v[232:235] offset:10240
    ds_write_b128 v68, v[236:239] offset:11264
    ds_read_b128 v[224:227], v60 offset:8192
    ds_read_b128 v[228:231], v61 offset:8192
    ds_read_b128 v[232:235], v62 offset:8192
    ds_read_b128 v[236:239], v63 offset:8192
    s_waitcnt lgkmcnt(8)
.p2align 3
    v_dot2_f32_bf16 v48, v208, s66, v48
    v_dot2_f32_bf16 v49, v208, v208, v49
    v_dot2_f32_bf16 v50, v209, s66, v50
    v_dot2_f32_bf16 v51, v209, v209, v51
    v_dot2_f32_bf16 v48, v210, s66, v48
    v_dot2_f32_bf16 v49, v210, v210, v49
    v_dot2_f32_bf16 v50, v211, s66, v50
    v_dot2_f32_bf16 v51, v211, v211, v51
    v_dot2_f32_bf16 v48, v212, s66, v48
    v_dot2_f32_bf16 v49, v212, v212, v49
    v_dot2_f32_bf16 v50, v213, s66, v50
    v_dot2_f32_bf16 v51, v213, v213, v51
    v_dot2_f32_bf16 v48, v214, s66, v48
    v_dot2_f32_bf16 v49, v214, v214, v49
    v_dot2_f32_bf16 v50, v215, s66, v50
    v_dot2_f32_bf16 v51, v215, v215, v51
    v_dot2_f32_bf16 v48, v216, s66, v48
    v_dot2_f32_bf16 v49, v216, v216, v49
    v_dot2_f32_bf16 v50, v217, s66, v50
    v_dot2_f32_bf16 v51, v217, v217, v51
    v_dot2_f32_bf16 v48, v218, s66, v48
    v_dot2_f32_bf16 v49, v218, v218, v49
    v_dot2_f32_bf16 v50, v219, s66, v50
    v_dot2_f32_bf16 v51, v219, v219, v51
    v_dot2_f32_bf16 v48, v220, s66, v48
    v_dot2_f32_bf16 v49, v220, v220, v49
    v_dot2_f32_bf16 v50, v221, s66, v50
    v_dot2_f32_bf16 v51, v221, v221, v51
    v_dot2_f32_bf16 v48, v222, s66, v48
    v_dot2_f32_bf16 v49, v222, v222, v49
    v_dot2_f32_bf16 v50, v223, s66, v50
    v_dot2_f32_bf16 v51, v223, v223, v51
    s_waitcnt vmcnt(0)
    ds_write_b128 v68, v[240:243] offset:12288
    ds_write_b128 v68, v[244:247] offset:13312
    ds_write_b128 v68, v[248:251] offset:14336
    ds_write_b128 v68, v[252:255] offset:15360
    ds_read_b128 v[240:243], v60 offset:12288
    ds_read_b128 v[244:247], v61 offset:12288
    ds_read_b128 v[248:251], v62 offset:12288
    ds_read_b128 v[252:255], v63 offset:12288
    s_waitcnt lgkmcnt(8)
.p2align 3
    v_dot2_f32_bf16 v48, v224, s66, v48
    v_dot2_f32_bf16 v49, v224, v224, v49
    v_dot2_f32_bf16 v50, v225, s66, v50
    v_dot2_f32_bf16 v51, v225, v225, v51
    v_dot2_f32_bf16 v48, v226, s66, v48
    v_dot2_f32_bf16 v49, v226, v226, v49
    v_dot2_f32_bf16 v50, v227, s66, v50
    v_dot2_f32_bf16 v51, v227, v227, v51
    v_dot2_f32_bf16 v48, v228, s66, v48
    v_dot2_f32_bf16 v49, v228, v228, v49
    v_dot2_f32_bf16 v50, v229, s66, v50
    v_dot2_f32_bf16 v51, v229, v229, v51
    v_dot2_f32_bf16 v48, v230, s66, v48
    v_dot2_f32_bf16 v49, v230, v230, v49
    v_dot2_f32_bf16 v50, v231, s66, v50
    v_dot2_f32_bf16 v51, v231, v231, v51
    v_dot2_f32_bf16 v48, v232, s66, v48
    v_dot2_f32_bf16 v49, v232, v232, v49
    v_dot2_f32_bf16 v50, v233, s66, v50
    v_dot2_f32_bf16 v51, v233, v233, v51
    v_dot2_f32_bf16 v48, v234, s66, v48
    v_dot2_f32_bf16 v49, v234, v234, v49
    v_dot2_f32_bf16 v50, v235, s66, v50
    v_dot2_f32_bf16 v51, v235, v235, v51
    v_dot2_f32_bf16 v48, v236, s66, v48
    v_dot2_f32_bf16 v49, v236, v236, v49
    v_dot2_f32_bf16 v50, v237, s66, v50
    v_dot2_f32_bf16 v51, v237, v237, v51
    v_dot2_f32_bf16 v48, v238, s66, v48
    v_dot2_f32_bf16 v49, v238, v238, v49
    v_dot2_f32_bf16 v50, v239, s66, v50
    v_dot2_f32_bf16 v51, v239, v239, v51
    s_waitcnt lgkmcnt(0)
.p2align 3
    v_dot2_f32_bf16 v48, v240, s66, v48
    v_dot2_f32_bf16 v49, v240, v240, v49
    v_dot2_f32_bf16 v50, v241, s66, v50
    v_dot2_f32_bf16 v51, v241, v241, v51
    v_dot2_f32_bf16 v48, v242, s66, v48
    v_dot2_f32_bf16 v49, v242, v242, v49
    v_dot2_f32_bf16 v50, v243, s66, v50
    v_dot2_f32_bf16 v51, v243, v243, v51
    v_dot2_f32_bf16 v48, v244, s66, v48
    v_dot2_f32_bf16 v49, v244, v244, v49
    v_dot2_f32_bf16 v50, v245, s66, v50
    v_dot2_f32_bf16 v51, v245, v245, v51
    v_dot2_f32_bf16 v48, v246, s66, v48
    v_dot2_f32_bf16 v49, v246, v246, v49
    v_dot2_f32_bf16 v50, v247, s66, v50
    v_dot2_f32_bf16 v51, v247, v247, v51
    v_dot2_f32_bf16 v48, v248, s66, v48
    v_dot2_f32_bf16 v49, v248, v248, v49
    v_dot2_f32_bf16 v50, v249, s66, v50
    v_dot2_f32_bf16 v51, v249, v249, v51
    v_dot2_f32_bf16 v48, v250, s66, v48
    v_dot2_f32_bf16 v49, v250, v250, v49
    v_dot2_f32_bf16 v50, v251, s66, v50
    v_dot2_f32_bf16 v51, v251, v251, v51
    v_dot2_f32_bf16 v48, v252, s66, v48
    v_dot2_f32_bf16 v49, v252, v252, v49
    v_dot2_f32_bf16 v50, v253, s66, v50
    v_dot2_f32_bf16 v51, v253, v253, v51
    v_dot2_f32_bf16 v48, v254, s66, v48
    v_dot2_f32_bf16 v49, v254, v254, v49
    v_dot2_f32_bf16 v50, v255, s66, v50
    v_dot2_f32_bf16 v51, v255, v255, v51
    s_nop 1
    v_add_f32 v48, v48, v50
    v_add_f32 v49, v49, v51
    s_mov_b32 s72, 0xbae38e39
    s_mov_b32 s73, 0x3ae38e39
    s_mov_b32 s74, 0xbeeff558
    v_mov_b32 v50, v48
    v_mov_b32 v51, v49
    s_nop 0
    v_permlane32_swap_b32 v48, v50
    v_permlane32_swap_b32 v49, v51
    v_add_f32 v48, v48, v50
    v_add_f32 v49, v49, v51
    v_mul_f32 v8, s72, v48
    v_mul_f32 v49, s73, v49
    v_fma_f32 v49, -v8, v8, v49
    v_max_f32 v49, 0, v49
    v_add_f32 v49, 0x3727c5ac, v49
    v_rsq_f32 v49, v49
    s_mov_b32 s45, 0
    s_mov_b32 s58, s59
    s_mov_b32 s57, s59
    v_mul_f32 v9, s74, v49
.p2align 3
    v_dot2_f32_bf16 v48, v112, s64, v8
    v_dot2_f32_bf16 v49, v112, s65, v8
    v_dot2_f32_bf16 v50, v113, s64, v8
    v_dot2_f32_bf16 v51, v113, s65, v8
    v_dot2_f32_bf16 v52, v114, s64, v8
    v_dot2_f32_bf16 v53, v114, s65, v8
    v_dot2_f32_bf16 v54, v115, s64, v8
    v_dot2_f32_bf16 v55, v115, s65, v8
    v_cvt_pk_bf16_f32 v112, v48, v49
    v_cvt_pk_bf16_f32 v113, v50, v51
    v_cvt_pk_bf16_f32 v114, v52, v53
    v_cvt_pk_bf16_f32 v115, v54, v55
    v_dot2_f32_bf16 v48, v116, s64, v8
    v_dot2_f32_bf16 v49, v116, s65, v8
    v_dot2_f32_bf16 v50, v117, s64, v8
    v_dot2_f32_bf16 v51, v117, s65, v8
    v_dot2_f32_bf16 v52, v118, s64, v8
    v_dot2_f32_bf16 v53, v118, s65, v8
    v_dot2_f32_bf16 v54, v119, s64, v8
    v_dot2_f32_bf16 v55, v119, s65, v8
    v_cvt_pk_bf16_f32 v116, v48, v49
    v_cvt_pk_bf16_f32 v117, v50, v51
    v_cvt_pk_bf16_f32 v118, v52, v53
    v_cvt_pk_bf16_f32 v119, v54, v55
    v_dot2_f32_bf16 v48, v120, s64, v8
    v_dot2_f32_bf16 v49, v120, s65, v8
    v_dot2_f32_bf16 v50, v121, s64, v8
    v_dot2_f32_bf16 v51, v121, s65, v8
    v_dot2_f32_bf16 v52, v122, s64, v8
    v_dot2_f32_bf16 v53, v122, s65, v8
    v_dot2_f32_bf16 v54, v123, s64, v8
    v_dot2_f32_bf16 v55, v123, s65, v8
    v_cvt_pk_bf16_f32 v120, v48, v49
    v_cvt_pk_bf16_f32 v121, v50, v51
    v_cvt_pk_bf16_f32 v122, v52, v53
    v_cvt_pk_bf16_f32 v123, v54, v55
    v_dot2_f32_bf16 v48, v124, s64, v8
    v_dot2_f32_bf16 v49, v124, s65, v8
    v_dot2_f32_bf16 v50, v125, s64, v8
    v_dot2_f32_bf16 v51, v125, s65, v8
    v_dot2_f32_bf16 v52, v126, s64, v8
    v_dot2_f32_bf16 v53, v126, s65, v8
    v_dot2_f32_bf16 v54, v127, s64, v8
    v_dot2_f32_bf16 v55, v127, s65, v8
    v_cvt_pk_bf16_f32 v124, v48, v49
    v_cvt_pk_bf16_f32 v125, v50, v51
    v_cvt_pk_bf16_f32 v126, v52, v53
    v_cvt_pk_bf16_f32 v127, v54, v55
    v_dot2_f32_bf16 v48, v128, s64, v8
    v_dot2_f32_bf16 v49, v128, s65, v8
    v_dot2_f32_bf16 v50, v129, s64, v8
    v_dot2_f32_bf16 v51, v129, s65, v8
    v_dot2_f32_bf16 v52, v130, s64, v8
    v_dot2_f32_bf16 v53, v130, s65, v8
    v_dot2_f32_bf16 v54, v131, s64, v8
    v_dot2_f32_bf16 v55, v131, s65, v8
    v_cvt_pk_bf16_f32 v128, v48, v49
    v_cvt_pk_bf16_f32 v129, v50, v51
    v_cvt_pk_bf16_f32 v130, v52, v53
    v_cvt_pk_bf16_f32 v131, v54, v55
    v_dot2_f32_bf16 v48, v132, s64, v8
    v_dot2_f32_bf16 v49, v132, s65, v8
    v_dot2_f32_bf16 v50, v133, s64, v8
    v_dot2_f32_bf16 v51, v133, s65, v8
    v_dot2_f32_bf16 v52, v134, s64, v8
    v_dot2_f32_bf16 v53, v134, s65, v8
    v_dot2_f32_bf16 v54, v135, s64, v8
    v_dot2_f32_bf16 v55, v135, s65, v8
    v_cvt_pk_bf16_f32 v132, v48, v49
    v_cvt_pk_bf16_f32 v133, v50, v51
    v_cvt_pk_bf16_f32 v134, v52, v53
    v_cvt_pk_bf16_f32 v135, v54, v55
    v_dot2_f32_bf16 v48, v136, s64, v8
    v_dot2_f32_bf16 v49, v136, s65, v8
    v_dot2_f32_bf16 v50, v137, s64, v8
    v_dot2_f32_bf16 v51, v137, s65, v8
    v_dot2_f32_bf16 v52, v138, s64, v8
    v_dot2_f32_bf16 v53, v138, s65, v8
    v_dot2_f32_bf16 v54, v139, s64, v8
    v_dot2_f32_bf16 v55, v139, s65, v8
    v_cvt_pk_bf16_f32 v136, v48, v49
    v_cvt_pk_bf16_f32 v137, v50, v51
    v_cvt_pk_bf16_f32 v138, v52, v53
    v_cvt_pk_bf16_f32 v139, v54, v55
    v_dot2_f32_bf16 v48, v140, s64, v8
    v_dot2_f32_bf16 v49, v140, s65, v8
    v_dot2_f32_bf16 v50, v141, s64, v8
    v_dot2_f32_bf16 v51, v141, s65, v8
    v_dot2_f32_bf16 v52, v142, s64, v8
    v_dot2_f32_bf16 v53, v142, s65, v8
    v_dot2_f32_bf16 v54, v143, s64, v8
    v_dot2_f32_bf16 v55, v143, s65, v8
    v_cvt_pk_bf16_f32 v140, v48, v49
    v_cvt_pk_bf16_f32 v141, v50, v51
    v_cvt_pk_bf16_f32 v142, v52, v53
    v_cvt_pk_bf16_f32 v143, v54, v55
    v_dot2_f32_bf16 v48, v144, s64, v8
    v_dot2_f32_bf16 v49, v144, s65, v8
    v_dot2_f32_bf16 v50, v145, s64, v8
    v_dot2_f32_bf16 v51, v145, s65, v8
    v_dot2_f32_bf16 v52, v146, s64, v8
    v_dot2_f32_bf16 v53, v146, s65, v8
    v_dot2_f32_bf16 v54, v147, s64, v8
    v_dot2_f32_bf16 v55, v147, s65, v8
    v_cvt_pk_bf16_f32 v144, v48, v49
    v_cvt_pk_bf16_f32 v145, v50, v51
    v_cvt_pk_bf16_f32 v146, v52, v53
    v_cvt_pk_bf16_f32 v147, v54, v55
    v_dot2_f32_bf16 v48, v148, s64, v8
    v_dot2_f32_bf16 v49, v148, s65, v8
    v_dot2_f32_bf16 v50, v149, s64, v8
    v_dot2_f32_bf16 v51, v149, s65, v8
    v_dot2_f32_bf16 v52, v150, s64, v8
    v_dot2_f32_bf16 v53, v150, s65, v8
    v_dot2_f32_bf16 v54, v151, s64, v8
    v_dot2_f32_bf16 v55, v151, s65, v8
    v_cvt_pk_bf16_f32 v148, v48, v49
    v_cvt_pk_bf16_f32 v149, v50, v51
    v_cvt_pk_bf16_f32 v150, v52, v53
    v_cvt_pk_bf16_f32 v151, v54, v55
    v_dot2_f32_bf16 v48, v152, s64, v8
    v_dot2_f32_bf16 v49, v152, s65, v8
    v_dot2_f32_bf16 v50, v153, s64, v8
    v_dot2_f32_bf16 v51, v153, s65, v8
    v_dot2_f32_bf16 v52, v154, s64, v8
    v_dot2_f32_bf16 v53, v154, s65, v8
    v_dot2_f32_bf16 v54, v155, s64, v8
    v_dot2_f32_bf16 v55, v155, s65, v8
    v_cvt_pk_bf16_f32 v152, v48, v49
    v_cvt_pk_bf16_f32 v153, v50, v51
    v_cvt_pk_bf16_f32 v154, v52, v53
    v_cvt_pk_bf16_f32 v155, v54, v55
    v_dot2_f32_bf16 v48, v156, s64, v8
    v_dot2_f32_bf16 v49, v156, s65, v8
    v_dot2_f32_bf16 v50, v157, s64, v8
    v_dot2_f32_bf16 v51, v157, s65, v8
    v_dot2_f32_bf16 v52, v158, s64, v8
    v_dot2_f32_bf16 v53, v158, s65, v8
    v_dot2_f32_bf16 v54, v159, s64, v8
    v_dot2_f32_bf16 v55, v159, s65, v8
    v_cvt_pk_bf16_f32 v156, v48, v49
    v_cvt_pk_bf16_f32 v157, v50, v51
    v_cvt_pk_bf16_f32 v158, v52, v53
    v_cvt_pk_bf16_f32 v159, v54, v55
    v_dot2_f32_bf16 v48, v160, s64, v8
    v_dot2_f32_bf16 v49, v160, s65, v8
    v_dot2_f32_bf16 v50, v161, s64, v8
    v_dot2_f32_bf16 v51, v161, s65, v8
    v_dot2_f32_bf16 v52, v162, s64, v8
    v_dot2_f32_bf16 v53, v162, s65, v8
    v_dot2_f32_bf16 v54, v163, s64, v8
    v_dot2_f32_bf16 v55, v163, s65, v8
    v_cvt_pk_bf16_f32 v160, v48, v49
    v_cvt_pk_bf16_f32 v161, v50, v51
    v_cvt_pk_bf16_f32 v162, v52, v53
    v_cvt_pk_bf16_f32 v163, v54, v55
    v_dot2_f32_bf16 v48, v164, s64, v8
    v_dot2_f32_bf16 v49, v164, s65, v8
    v_dot2_f32_bf16 v50, v165, s64, v8
    v_dot2_f32_bf16 v51, v165, s65, v8
    v_dot2_f32_bf16 v52, v166, s64, v8
    v_dot2_f32_bf16 v53, v166, s65, v8
    v_dot2_f32_bf16 v54, v167, s64, v8
    v_dot2_f32_bf16 v55, v167, s65, v8
    v_cvt_pk_bf16_f32 v164, v48, v49
    v_cvt_pk_bf16_f32 v165, v50, v51
    v_cvt_pk_bf16_f32 v166, v52, v53
    v_cvt_pk_bf16_f32 v167, v54, v55
    v_dot2_f32_bf16 v48, v168, s64, v8
    v_dot2_f32_bf16 v49, v168, s65, v8
    v_dot2_f32_bf16 v50, v169, s64, v8
    v_dot2_f32_bf16 v51, v169, s65, v8
    v_dot2_f32_bf16 v52, v170, s64, v8
    v_dot2_f32_bf16 v53, v170, s65, v8
    v_dot2_f32_bf16 v54, v171, s64, v8
    v_dot2_f32_bf16 v55, v171, s65, v8
    v_cvt_pk_bf16_f32 v168, v48, v49
    v_cvt_pk_bf16_f32 v169, v50, v51
    v_cvt_pk_bf16_f32 v170, v52, v53
    v_cvt_pk_bf16_f32 v171, v54, v55
    v_dot2_f32_bf16 v48, v172, s64, v8
    v_dot2_f32_bf16 v49, v172, s65, v8
    v_dot2_f32_bf16 v50, v173, s64, v8
    v_dot2_f32_bf16 v51, v173, s65, v8
    v_dot2_f32_bf16 v52, v174, s64, v8
    v_dot2_f32_bf16 v53, v174, s65, v8
    v_dot2_f32_bf16 v54, v175, s64, v8
    v_dot2_f32_bf16 v55, v175, s65, v8
    v_cvt_pk_bf16_f32 v172, v48, v49
    v_cvt_pk_bf16_f32 v173, v50, v51
    v_cvt_pk_bf16_f32 v174, v52, v53
    v_cvt_pk_bf16_f32 v175, v54, v55
    v_dot2_f32_bf16 v48, v176, s64, v8
    v_dot2_f32_bf16 v49, v176, s65, v8
    v_dot2_f32_bf16 v50, v177, s64, v8
    v_dot2_f32_bf16 v51, v177, s65, v8
    v_dot2_f32_bf16 v52, v178, s64, v8
    v_dot2_f32_bf16 v53, v178, s65, v8
    v_dot2_f32_bf16 v54, v179, s64, v8
    v_dot2_f32_bf16 v55, v179, s65, v8
    v_cvt_pk_bf16_f32 v176, v48, v49
    v_cvt_pk_bf16_f32 v177, v50, v51
    v_cvt_pk_bf16_f32 v178, v52, v53
    v_cvt_pk_bf16_f32 v179, v54, v55
    v_dot2_f32_bf16 v48, v180, s64, v8
    v_dot2_f32_bf16 v49, v180, s65, v8
    v_dot2_f32_bf16 v50, v181, s64, v8
    v_dot2_f32_bf16 v51, v181, s65, v8
    v_dot2_f32_bf16 v52, v182, s64, v8
    v_dot2_f32_bf16 v53, v182, s65, v8
    v_dot2_f32_bf16 v54, v183, s64, v8
    v_dot2_f32_bf16 v55, v183, s65, v8
    v_cvt_pk_bf16_f32 v180, v48, v49
    v_cvt_pk_bf16_f32 v181, v50, v51
    v_cvt_pk_bf16_f32 v182, v52, v53
    v_cvt_pk_bf16_f32 v183, v54, v55
    v_dot2_f32_bf16 v48, v184, s64, v8
    v_dot2_f32_bf16 v49, v184, s65, v8
    v_dot2_f32_bf16 v50, v185, s64, v8
    v_dot2_f32_bf16 v51, v185, s65, v8
    v_dot2_f32_bf16 v52, v186, s64, v8
    v_dot2_f32_bf16 v53, v186, s65, v8
    v_dot2_f32_bf16 v54, v187, s64, v8
    v_dot2_f32_bf16 v55, v187, s65, v8
    v_cvt_pk_bf16_f32 v184, v48, v49
    v_cvt_pk_bf16_f32 v185, v50, v51
    v_cvt_pk_bf16_f32 v186, v52, v53
    v_cvt_pk_bf16_f32 v187, v54, v55
    v_dot2_f32_bf16 v48, v188, s64, v8
    v_dot2_f32_bf16 v49, v188, s65, v8
    v_dot2_f32_bf16 v50, v189, s64, v8
    v_dot2_f32_bf16 v51, v189, s65, v8
    v_dot2_f32_bf16 v52, v190, s64, v8
    v_dot2_f32_bf16 v53, v190, s65, v8
    v_dot2_f32_bf16 v54, v191, s64, v8
    v_dot2_f32_bf16 v55, v191, s65, v8
    v_cvt_pk_bf16_f32 v188, v48, v49
    v_cvt_pk_bf16_f32 v189, v50, v51
    v_cvt_pk_bf16_f32 v190, v52, v53
    v_cvt_pk_bf16_f32 v191, v54, v55
    v_dot2_f32_bf16 v48, v192, s64, v8
    v_dot2_f32_bf16 v49, v192, s65, v8
    v_dot2_f32_bf16 v50, v193, s64, v8
    v_dot2_f32_bf16 v51, v193, s65, v8
    v_dot2_f32_bf16 v52, v194, s64, v8
    v_dot2_f32_bf16 v53, v194, s65, v8
    v_dot2_f32_bf16 v54, v195, s64, v8
    v_dot2_f32_bf16 v55, v195, s65, v8
    v_cvt_pk_bf16_f32 v192, v48, v49
    v_cvt_pk_bf16_f32 v193, v50, v51
    v_cvt_pk_bf16_f32 v194, v52, v53
    v_cvt_pk_bf16_f32 v195, v54, v55
    v_dot2_f32_bf16 v48, v196, s64, v8
    v_dot2_f32_bf16 v49, v196, s65, v8
    v_dot2_f32_bf16 v50, v197, s64, v8
    v_dot2_f32_bf16 v51, v197, s65, v8
    v_dot2_f32_bf16 v52, v198, s64, v8
    v_dot2_f32_bf16 v53, v198, s65, v8
    v_dot2_f32_bf16 v54, v199, s64, v8
    v_dot2_f32_bf16 v55, v199, s65, v8
    v_cvt_pk_bf16_f32 v196, v48, v49
    v_cvt_pk_bf16_f32 v197, v50, v51
    v_cvt_pk_bf16_f32 v198, v52, v53
    v_cvt_pk_bf16_f32 v199, v54, v55
    v_dot2_f32_bf16 v48, v200, s64, v8
    v_dot2_f32_bf16 v49, v200, s65, v8
    v_dot2_f32_bf16 v50, v201, s64, v8
    v_dot2_f32_bf16 v51, v201, s65, v8
    v_dot2_f32_bf16 v52, v202, s64, v8
    v_dot2_f32_bf16 v53, v202, s65, v8
    v_dot2_f32_bf16 v54, v203, s64, v8
    v_dot2_f32_bf16 v55, v203, s65, v8
    v_cvt_pk_bf16_f32 v200, v48, v49
    v_cvt_pk_bf16_f32 v201, v50, v51
    v_cvt_pk_bf16_f32 v202, v52, v53
    v_cvt_pk_bf16_f32 v203, v54, v55
    v_dot2_f32_bf16 v48, v204, s64, v8
    v_dot2_f32_bf16 v49, v204, s65, v8
    v_dot2_f32_bf16 v50, v205, s64, v8
    v_dot2_f32_bf16 v51, v205, s65, v8
    v_dot2_f32_bf16 v52, v206, s64, v8
    v_dot2_f32_bf16 v53, v206, s65, v8
    v_dot2_f32_bf16 v54, v207, s64, v8
    v_dot2_f32_bf16 v55, v207, s65, v8
    v_cvt_pk_bf16_f32 v204, v48, v49
    v_cvt_pk_bf16_f32 v205, v50, v51
    v_cvt_pk_bf16_f32 v206, v52, v53
    v_cvt_pk_bf16_f32 v207, v54, v55
    v_dot2_f32_bf16 v48, v208, s64, v8
    v_dot2_f32_bf16 v49, v208, s65, v8
    v_dot2_f32_bf16 v50, v209, s64, v8
    v_dot2_f32_bf16 v51, v209, s65, v8
    v_dot2_f32_bf16 v52, v210, s64, v8
    v_dot2_f32_bf16 v53, v210, s65, v8
    v_dot2_f32_bf16 v54, v211, s64, v8
    v_dot2_f32_bf16 v55, v211, s65, v8
    v_cvt_pk_bf16_f32 v208, v48, v49
    v_cvt_pk_bf16_f32 v209, v50, v51
    v_cvt_pk_bf16_f32 v210, v52, v53
    v_cvt_pk_bf16_f32 v211, v54, v55
    v_dot2_f32_bf16 v48, v212, s64, v8
    v_dot2_f32_bf16 v49, v212, s65, v8
    v_dot2_f32_bf16 v50, v213, s64, v8
    v_dot2_f32_bf16 v51, v213, s65, v8
    v_dot2_f32_bf16 v52, v214, s64, v8
    v_dot2_f32_bf16 v53, v214, s65, v8
    v_dot2_f32_bf16 v54, v215, s64, v8
    v_dot2_f32_bf16 v55, v215, s65, v8
    v_cvt_pk_bf16_f32 v212, v48, v49
    v_cvt_pk_bf16_f32 v213, v50, v51
    v_cvt_pk_bf16_f32 v214, v52, v53
    v_cvt_pk_bf16_f32 v215, v54, v55
    s_barrier
    ds_read_b64_tr_b16 v[24:25], v2 offset:0
    ds_read_b64_tr_b16 v[26:27], v2 offset:512
    ds_read_b64_tr_b16 v[28:29], v3 offset:0
    ds_read_b64_tr_b16 v[30:31], v3 offset:512
    ds_read_b64_tr_b16 v[32:33], v2 offset:2048
    ds_read_b64_tr_b16 v[34:35], v2 offset:2560
    ds_read_b64_tr_b16 v[36:37], v3 offset:2048
    ds_read_b64_tr_b16 v[38:39], v3 offset:2560
recurrent_scan__sliding_local_dilated__mixer_gmlp__prompt_kernel_F0:
    s_waitcnt lgkmcnt(4)
    v_mfma_f32_32x32x16_bf16 v[80:95], v[24:27], v[112:115], 0
    s_add_u32 s46, s45, 1
    ds_read_b64_tr_b16 v[40:41], v2 offset:4096
    ds_read_b64_tr_b16 v[42:43], v2 offset:4608
    v_lshlrev_b32 v48, 16, v216
    v_and_b32 v49, 0xffff0000, v216
    v_add_f32 v48, v8, v48
    v_mfma_f32_32x32x16_bf16 v[96:111], v[28:31], v[112:115], 0
    ds_read_b64_tr_b16 v[44:45], v3 offset:4096
    ds_read_b64_tr_b16 v[46:47], v3 offset:4608
    v_add_f32 v49, v8, v49
    v_cvt_pk_bf16_f32 v216, v48, v49
    v_lshlrev_b32 v50, 16, v217
    v_and_b32 v51, 0xffff0000, v217
    s_waitcnt lgkmcnt(4)
    v_mfma_f32_32x32x16_bf16 v[80:95], v[32:35], v[116:119], v[80:95]
    ds_read_b64_tr_b16 v[24:25], v2 offset:6144
    ds_read_b64_tr_b16 v[26:27], v2 offset:6656
    v_add_f32 v50, v8, v50
    v_add_f32 v51, v8, v51
    v_cvt_pk_bf16_f32 v217, v50, v51
    v_lshlrev_b32 v52, 16, v218
    v_mfma_f32_32x32x16_bf16 v[96:111], v[36:39], v[116:119], v[96:111]
    ds_read_b64_tr_b16 v[28:29], v3 offset:6144
    ds_read_b64_tr_b16 v[30:31], v3 offset:6656
    v_and_b32 v53, 0xffff0000, v218
    v_add_f32 v52, v8, v52
    v_add_f32 v53, v8, v53
    v_cvt_pk_bf16_f32 v218, v52, v53
    s_waitcnt lgkmcnt(4)
    v_mfma_f32_32x32x16_bf16 v[80:95], v[40:43], v[120:123], v[80:95]
    ds_read_b64_tr_b16 v[32:33], v2 offset:8192
    ds_read_b64_tr_b16 v[34:35], v2 offset:8704
    v_lshlrev_b32 v54, 16, v219
    v_and_b32 v55, 0xffff0000, v219
    v_add_f32 v54, v8, v54
    v_add_f32 v55, v8, v55
    v_mfma_f32_32x32x16_bf16 v[96:111], v[44:47], v[120:123], v[96:111]
    ds_read_b64_tr_b16 v[36:37], v3 offset:8192
    ds_read_b64_tr_b16 v[38:39], v3 offset:8704
    v_cvt_pk_bf16_f32 v219, v54, v55
    v_lshlrev_b32 v48, 16, v220
    v_and_b32 v49, 0xffff0000, v220
    v_add_f32 v48, v8, v48
    s_waitcnt lgkmcnt(4)
    v_mfma_f32_32x32x16_bf16 v[80:95], v[24:27], v[124:127], v[80:95]
    ds_read_b64_tr_b16 v[40:41], v2 offset:10240
    ds_read_b64_tr_b16 v[42:43], v2 offset:10752
    v_add_f32 v49, v8, v49
    v_cvt_pk_bf16_f32 v220, v48, v49
    v_lshlrev_b32 v50, 16, v221
    v_and_b32 v51, 0xffff0000, v221
    v_mfma_f32_32x32x16_bf16 v[96:111], v[28:31], v[124:127], v[96:111]
    ds_read_b64_tr_b16 v[44:45], v3 offset:10240
    ds_read_b64_tr_b16 v[46:47], v3 offset:10752
    v_add_f32 v50, v8, v50
    v_add_f32 v51, v8, v51
    v_cvt_pk_bf16_f32 v221, v50, v51
    v_lshlrev_b32 v52, 16, v222
    s_waitcnt lgkmcnt(4)
    v_mfma_f32_32x32x16_bf16 v[80:95], v[32:35], v[128:131], v[80:95]
    ds_read_b64_tr_b16 v[24:25], v2 offset:12288
    ds_read_b64_tr_b16 v[26:27], v2 offset:12800
    v_and_b32 v53, 0xffff0000, v222
    v_add_f32 v52, v8, v52
    v_add_f32 v53, v8, v53
    v_cvt_pk_bf16_f32 v222, v52, v53
    v_mfma_f32_32x32x16_bf16 v[96:111], v[36:39], v[128:131], v[96:111]
    ds_read_b64_tr_b16 v[28:29], v3 offset:12288
    ds_read_b64_tr_b16 v[30:31], v3 offset:12800
    v_lshlrev_b32 v54, 16, v223
    v_and_b32 v55, 0xffff0000, v223
    v_add_f32 v54, v8, v54
    v_add_f32 v55, v8, v55
    v_cvt_pk_bf16_f32 v223, v54, v55
    s_waitcnt lgkmcnt(4)
    v_mfma_f32_32x32x16_bf16 v[80:95], v[40:43], v[132:135], v[80:95]
    ds_read_b64_tr_b16 v[32:33], v2 offset:14336
    ds_read_b64_tr_b16 v[34:35], v2 offset:14848
    v_lshlrev_b32 v48, 16, v224
    v_and_b32 v49, 0xffff0000, v224
    v_add_f32 v48, v8, v48
    v_mfma_f32_32x32x16_bf16 v[96:111], v[44:47], v[132:135], v[96:111]
    ds_read_b64_tr_b16 v[36:37], v3 offset:14336
    ds_read_b64_tr_b16 v[38:39], v3 offset:14848
    v_add_f32 v49, v8, v49
    v_cvt_pk_bf16_f32 v224, v48, v49
    v_lshlrev_b32 v50, 16, v225
    v_and_b32 v51, 0xffff0000, v225
    v_add_f32 v50, v8, v50
    s_waitcnt lgkmcnt(4)
    v_mfma_f32_32x32x16_bf16 v[80:95], v[24:27], v[136:139], v[80:95]
    ds_read_b64_tr_b16 v[40:41], v2 offset:16384
    ds_read_b64_tr_b16 v[42:43], v2 offset:16896
    v_add_f32 v51, v8, v51
    v_cvt_pk_bf16_f32 v225, v50, v51
    v_lshlrev_b32 v52, 16, v226
    v_mfma_f32_32x32x16_bf16 v[96:111], v[28:31], v[136:139], v[96:111]
    ds_read_b64_tr_b16 v[44:45], v3 offset:16384
    ds_read_b64_tr_b16 v[46:47], v3 offset:16896
    v_and_b32 v53, 0xffff0000, v226
    v_add_f32 v52, v8, v52
    v_add_f32 v53, v8, v53
    v_cvt_pk_bf16_f32 v226, v52, v53
    v_lshlrev_b32 v54, 16, v227
    s_waitcnt lgkmcnt(4)
    v_mfma_f32_32x32x16_bf16 v[80:95], v[32:35], v[140:143], v[80:95]
    ds_read_b64_tr_b16 v[24:25], v2 offset:18432
    ds_read_b64_tr_b16 v[26:27], v2 offset:18944
    v_and_b32 v55, 0xffff0000, v227
    v_add_f32 v54, v8, v54
    v_add_f32 v55, v8, v55
    v_mfma_f32_32x32x16_bf16 v[96:111], v[36:39], v[140:143], v[96:111]
    ds_read_b64_tr_b16 v[28:29], v3 offset:18432
    ds_read_b64_tr_b16 v[30:31], v3 offset:18944
    v_cvt_pk_bf16_f32 v227, v54, v55
    v_lshlrev_b32 v48, 16, v228
    v_and_b32 v49, 0xffff0000, v228
    v_add_f32 v48, v8, v48
    v_add_f32 v49, v8, v49
    s_waitcnt lgkmcnt(4)
    v_mfma_f32_32x32x16_bf16 v[80:95], v[40:43], v[144:147], v[80:95]
    ds_read_b64_tr_b16 v[32:33], v2 offset:20480
    ds_read_b64_tr_b16 v[34:35], v2 offset:20992
    v_cvt_pk_bf16_f32 v228, v48, v49
    v_lshlrev_b32 v50, 16, v229
    v_and_b32 v51, 0xffff0000, v229
    v_add_f32 v50, v8, v50
    v_mfma_f32_32x32x16_bf16 v[96:111], v[44:47], v[144:147], v[96:111]
    ds_read_b64_tr_b16 v[36:37], v3 offset:20480
    ds_read_b64_tr_b16 v[38:39], v3 offset:20992
    v_add_f32 v51, v8, v51
    v_cvt_pk_bf16_f32 v229, v50, v51
    v_lshlrev_b32 v52, 16, v230
    v_and_b32 v53, 0xffff0000, v230
    s_waitcnt lgkmcnt(4)
    v_mfma_f32_32x32x16_bf16 v[80:95], v[24:27], v[148:151], v[80:95]
    ds_read_b64_tr_b16 v[40:41], v2 offset:22528
    ds_read_b64_tr_b16 v[42:43], v2 offset:23040
    v_add_f32 v52, v8, v52
    v_add_f32 v53, v8, v53
    v_cvt_pk_bf16_f32 v230, v52, v53
    v_lshlrev_b32 v54, 16, v231
    v_mfma_f32_32x32x16_bf16 v[96:111], v[28:31], v[148:151], v[96:111]
    ds_read_b64_tr_b16 v[44:45], v3 offset:22528
    ds_read_b64_tr_b16 v[46:47], v3 offset:23040
    v_and_b32 v55, 0xffff0000, v231
    v_add_f32 v54, v8, v54
    v_add_f32 v55, v8, v55
    v_cvt_pk_bf16_f32 v231, v54, v55
    s_waitcnt lgkmcnt(4)
    v_mfma_f32_32x32x16_bf16 v[80:95], v[32:35], v[152:155], v[80:95]
    ds_read_b64_tr_b16 v[24:25], v2 offset:24576
    ds_read_b64_tr_b16 v[26:27], v2 offset:25088
    v_lshlrev_b32 v48, 16, v232
    v_and_b32 v49, 0xffff0000, v232
    v_add_f32 v48, v8, v48
    v_add_f32 v49, v8, v49
    v_mfma_f32_32x32x16_bf16 v[96:111], v[36:39], v[152:155], v[96:111]
    ds_read_b64_tr_b16 v[28:29], v3 offset:24576
    ds_read_b64_tr_b16 v[30:31], v3 offset:25088
    v_cvt_pk_bf16_f32 v232, v48, v49
    v_lshlrev_b32 v50, 16, v233
    v_and_b32 v51, 0xffff0000, v233
    v_add_f32 v50, v8, v50
    s_waitcnt lgkmcnt(4)
    v_mfma_f32_32x32x16_bf16 v[80:95], v[40:43], v[156:159], v[80:95]
    ds_read_b64_tr_b16 v[32:33], v2 offset:26624
    ds_read_b64_tr_b16 v[34:35], v2 offset:27136
    v_add_f32 v51, v8, v51
    v_cvt_pk_bf16_f32 v233, v50, v51
    v_lshlrev_b32 v52, 16, v234
    v_and_b32 v53, 0xffff0000, v234
    v_mfma_f32_32x32x16_bf16 v[96:111], v[44:47], v[156:159], v[96:111]
    ds_read_b64_tr_b16 v[36:37], v3 offset:26624
    ds_read_b64_tr_b16 v[38:39], v3 offset:27136
    v_add_f32 v52, v8, v52
    v_add_f32 v53, v8, v53
    v_cvt_pk_bf16_f32 v234, v52, v53
    v_lshlrev_b32 v54, 16, v235
    s_waitcnt lgkmcnt(4)
    v_mfma_f32_32x32x16_bf16 v[80:95], v[24:27], v[160:163], v[80:95]
    ds_read_b64_tr_b16 v[40:41], v2 offset:28672
    ds_read_b64_tr_b16 v[42:43], v2 offset:29184
    v_and_b32 v55, 0xffff0000, v235
    v_add_f32 v54, v8, v54
    v_add_f32 v55, v8, v55
    v_cvt_pk_bf16_f32 v235, v54, v55
    v_mfma_f32_32x32x16_bf16 v[96:111], v[28:31], v[160:163], v[96:111]
    ds_read_b64_tr_b16 v[44:45], v3 offset:28672
    ds_read_b64_tr_b16 v[46:47], v3 offset:29184
    v_lshlrev_b32 v48, 16, v236
    v_and_b32 v49, 0xffff0000, v236
    v_add_f32 v48, v8, v48
    v_add_f32 v49, v8, v49
    v_cvt_pk_bf16_f32 v236, v48, v49
    s_waitcnt lgkmcnt(4)
    v_mfma_f32_32x32x16_bf16 v[80:95], v[32:35], v[164:167], v[80:95]
    ds_read_b64_tr_b16 v[24:25], v2 offset:30720
    ds_read_b64_tr_b16 v[26:27], v2 offset:31232
    v_lshlrev_b32 v50, 16, v237
    v_and_b32 v51, 0xffff0000, v237
    v_add_f32 v50, v8, v50
    v_mfma_f32_32x32x16_bf16 v[96:111], v[36:39], v[164:167], v[96:111]
    ds_read_b64_tr_b16 v[28:29], v3 offset:30720
    ds_read_b64_tr_b16 v[30:31], v3 offset:31232
    v_add_f32 v51, v8, v51
    v_cvt_pk_bf16_f32 v237, v50, v51
    v_lshlrev_b32 v52, 16, v238
    v_and_b32 v53, 0xffff0000, v238
    v_add_f32 v52, v8, v52
    s_waitcnt lgkmcnt(4)
    v_mfma_f32_32x32x16_bf16 v[80:95], v[40:43], v[168:171], v[80:95]
    ds_read_b64_tr_b16 v[32:33], v2 offset:32768
    ds_read_b64_tr_b16 v[34:35], v2 offset:33280
    v_add_f32 v53, v8, v53
    v_cvt_pk_bf16_f32 v238, v52, v53
    v_lshlrev_b32 v54, 16, v239
    v_mfma_f32_32x32x16_bf16 v[96:111], v[44:47], v[168:171], v[96:111]
    ds_read_b64_tr_b16 v[36:37], v3 offset:32768
    ds_read_b64_tr_b16 v[38:39], v3 offset:33280
    v_and_b32 v55, 0xffff0000, v239
    v_add_f32 v54, v8, v54
    v_add_f32 v55, v8, v55
    v_cvt_pk_bf16_f32 v239, v54, v55
    v_lshlrev_b32 v48, 16, v240
    s_waitcnt lgkmcnt(4)
    v_mfma_f32_32x32x16_bf16 v[80:95], v[24:27], v[172:175], v[80:95]
    ds_read_b64_tr_b16 v[40:41], v2 offset:34816
    ds_read_b64_tr_b16 v[42:43], v2 offset:35328
    v_and_b32 v49, 0xffff0000, v240
    v_add_f32 v48, v8, v48
    v_add_f32 v49, v8, v49
    v_mfma_f32_32x32x16_bf16 v[96:111], v[28:31], v[172:175], v[96:111]
    ds_read_b64_tr_b16 v[44:45], v3 offset:34816
    ds_read_b64_tr_b16 v[46:47], v3 offset:35328
    v_cvt_pk_bf16_f32 v240, v48, v49
    v_lshlrev_b32 v50, 16, v241
    v_and_b32 v51, 0xffff0000, v241
    v_add_f32 v50, v8, v50
    v_add_f32 v51, v8, v51
    s_waitcnt lgkmcnt(4)
    v_mfma_f32_32x32x16_bf16 v[80:95], v[32:35], v[176:179], v[80:95]
    v_add_u32 v2, 36864, v2
    v_add_u32 v3, 36864, v3
    ds_read_b64_tr_b16 v[24:25], v2 offset:0
    ds_read_b64_tr_b16 v[26:27], v2 offset:512
    v_cvt_pk_bf16_f32 v241, v50, v51
    v_mfma_f32_32x32x16_bf16 v[96:111], v[36:39], v[176:179], v[96:111]
    ds_read_b64_tr_b16 v[28:29], v3 offset:0
    ds_read_b64_tr_b16 v[30:31], v3 offset:512
    v_lshlrev_b32 v52, 16, v242
    v_and_b32 v53, 0xffff0000, v242
    v_add_f32 v52, v8, v52
    v_add_f32 v53, v8, v53
    v_cvt_pk_bf16_f32 v242, v52, v53
    s_waitcnt lgkmcnt(4)
    v_mfma_f32_32x32x16_bf16 v[80:95], v[40:43], v[180:183], v[80:95]
    ds_read_b64_tr_b16 v[32:33], v2 offset:2048
    ds_read_b64_tr_b16 v[34:35], v2 offset:2560
    v_lshlrev_b32 v54, 16, v243
    v_and_b32 v55, 0xffff0000, v243
    v_add_f32 v54, v8, v54
    v_add_f32 v55, v8, v55
    v_mfma_f32_32x32x16_bf16 v[96:111], v[44:47], v[180:183], v[96:111]
    ds_read_b64_tr_b16 v[36:37], v3 offset:2048
    ds_read_b64_tr_b16 v[38:39], v3 offset:2560
    v_cvt_pk_bf16_f32 v243, v54, v55
    v_lshlrev_b32 v48, 16, v244
    v_and_b32 v49, 0xffff0000, v244
    v_add_f32 v48, v8, v48
    s_waitcnt lgkmcnt(4)
    v_mfma_f32_32x32x16_bf16 v[80:95], v[24:27], v[184:187], v[80:95]
    ds_read_b64_tr_b16 v[40:41], v2 offset:4096
    ds_read_b64_tr_b16 v[42:43], v2 offset:4608
    v_add_f32 v49, v8, v49
    v_cvt_pk_bf16_f32 v244, v48, v49
    v_lshlrev_b32 v50, 16, v245
    v_and_b32 v51, 0xffff0000, v245
    v_mfma_f32_32x32x16_bf16 v[96:111], v[28:31], v[184:187], v[96:111]
    ds_read_b64_tr_b16 v[44:45], v3 offset:4096
    ds_read_b64_tr_b16 v[46:47], v3 offset:4608
    v_add_f32 v50, v8, v50
    v_add_f32 v51, v8, v51
    v_cvt_pk_bf16_f32 v245, v50, v51
    v_lshlrev_b32 v52, 16, v246
    s_waitcnt lgkmcnt(4)
    v_mfma_f32_32x32x16_bf16 v[80:95], v[32:35], v[188:191], v[80:95]
    ds_read_b64_tr_b16 v[24:25], v2 offset:6144
    ds_read_b64_tr_b16 v[26:27], v2 offset:6656
    v_and_b32 v53, 0xffff0000, v246
    v_add_f32 v52, v8, v52
    v_add_f32 v53, v8, v53
    v_cvt_pk_bf16_f32 v246, v52, v53
    v_mfma_f32_32x32x16_bf16 v[96:111], v[36:39], v[188:191], v[96:111]
    ds_read_b64_tr_b16 v[28:29], v3 offset:6144
    ds_read_b64_tr_b16 v[30:31], v3 offset:6656
    v_lshlrev_b32 v54, 16, v247
    v_and_b32 v55, 0xffff0000, v247
    v_add_f32 v54, v8, v54
    v_add_f32 v55, v8, v55
    s_waitcnt lgkmcnt(4)
    v_mfma_f32_32x32x16_bf16 v[80:95], v[40:43], v[192:195], v[80:95]
    ds_read_b64_tr_b16 v[32:33], v2 offset:8192
    ds_read_b64_tr_b16 v[34:35], v2 offset:8704
    v_cvt_pk_bf16_f32 v247, v54, v55
    v_lshlrev_b32 v48, 16, v248
    v_and_b32 v49, 0xffff0000, v248
    v_add_f32 v48, v8, v48
    v_mfma_f32_32x32x16_bf16 v[96:111], v[44:47], v[192:195], v[96:111]
    ds_read_b64_tr_b16 v[36:37], v3 offset:8192
    ds_read_b64_tr_b16 v[38:39], v3 offset:8704
    v_add_f32 v49, v8, v49
    v_cvt_pk_bf16_f32 v248, v48, v49
    v_lshlrev_b32 v50, 16, v249
    v_and_b32 v51, 0xffff0000, v249
    v_add_f32 v50, v8, v50
    s_waitcnt lgkmcnt(4)
    v_mfma_f32_32x32x16_bf16 v[80:95], v[24:27], v[196:199], v[80:95]
    ds_read_b64_tr_b16 v[40:41], v2 offset:10240
    ds_read_b64_tr_b16 v[42:43], v2 offset:10752
    v_add_f32 v51, v8, v51
    v_cvt_pk_bf16_f32 v249, v50, v51
    v_lshlrev_b32 v52, 16, v250
    v_mfma_f32_32x32x16_bf16 v[96:111], v[28:31], v[196:199], v[96:111]
    ds_read_b64_tr_b16 v[44:45], v3 offset:10240
    ds_read_b64_tr_b16 v[46:47], v3 offset:10752
    v_and_b32 v53, 0xffff0000, v250
    v_add_f32 v52, v8, v52
    v_add_f32 v53, v8, v53
    v_cvt_pk_bf16_f32 v250, v52, v53
    v_lshlrev_b32 v54, 16, v251
    s_waitcnt lgkmcnt(4)
    v_mfma_f32_32x32x16_bf16 v[80:95], v[32:35], v[200:203], v[80:95]
    ds_read_b64_tr_b16 v[24:25], v2 offset:12288
    ds_read_b64_tr_b16 v[26:27], v2 offset:12800
    v_and_b32 v55, 0xffff0000, v251
    v_add_f32 v54, v8, v54
    v_add_f32 v55, v8, v55
    v_mfma_f32_32x32x16_bf16 v[96:111], v[36:39], v[200:203], v[96:111]
    ds_read_b64_tr_b16 v[28:29], v3 offset:12288
    ds_read_b64_tr_b16 v[30:31], v3 offset:12800
    v_cvt_pk_bf16_f32 v251, v54, v55
    v_lshlrev_b32 v48, 16, v252
    v_and_b32 v49, 0xffff0000, v252
    v_add_f32 v48, v8, v48
    v_add_f32 v49, v8, v49
    s_waitcnt lgkmcnt(4)
    v_mfma_f32_32x32x16_bf16 v[80:95], v[40:43], v[204:207], v[80:95]
    ds_read_b64_tr_b16 v[32:33], v2 offset:14336
    ds_read_b64_tr_b16 v[34:35], v2 offset:14848
    v_cvt_pk_bf16_f32 v252, v48, v49
    v_lshlrev_b32 v50, 16, v253
    v_and_b32 v51, 0xffff0000, v253
    v_mfma_f32_32x32x16_bf16 v[96:111], v[44:47], v[204:207], v[96:111]
    ds_read_b64_tr_b16 v[36:37], v3 offset:14336
    ds_read_b64_tr_b16 v[38:39], v3 offset:14848
    v_add_f32 v50, v8, v50
    v_add_f32 v51, v8, v51
    v_cvt_pk_bf16_f32 v253, v50, v51
    v_lshlrev_b32 v52, 16, v254
    v_and_b32 v53, 0xffff0000, v254
    s_waitcnt lgkmcnt(4)
    v_mfma_f32_32x32x16_bf16 v[80:95], v[24:27], v[208:211], v[80:95]
    ds_read_b64_tr_b16 v[40:41], v2 offset:16384
    ds_read_b64_tr_b16 v[42:43], v2 offset:16896
    v_add_f32 v52, v8, v52
    v_add_f32 v53, v8, v53
    v_cvt_pk_bf16_f32 v254, v52, v53
    v_mfma_f32_32x32x16_bf16 v[96:111], v[28:31], v[208:211], v[96:111]
    ds_read_b64_tr_b16 v[44:45], v3 offset:16384
    ds_read_b64_tr_b16 v[46:47], v3 offset:16896
    v_lshlrev_b32 v54, 16, v255
    v_and_b32 v55, 0xffff0000, v255
    v_add_f32 v54, v8, v54
    v_add_f32 v55, v8, v55
    v_cvt_pk_bf16_f32 v255, v54, v55
    s_waitcnt lgkmcnt(4)
    v_mfma_f32_32x32x16_bf16 v[80:95], v[32:35], v[212:215], v[80:95]
    ds_read_b64_tr_b16 v[24:25], v2 offset:18432
    ds_read_b64_tr_b16 v[26:27], v2 offset:18944
    s_add_u32 s72, s42, s46
    v_mfma_f32_32x32x16_bf16 v[96:111], v[36:39], v[212:215], v[96:111]
    ds_read_b64_tr_b16 v[28:29], v3 offset:18432
    ds_read_b64_tr_b16 v[30:31], v3 offset:18944
    s_waitcnt lgkmcnt(4)
    v_mfma_f32_32x32x16_bf16 v[80:95], v[40:43], v[216:219], v[80:95]
    ds_read_b64_tr_b16 v[32:33], v2 offset:20480
    ds_read_b64_tr_b16 v[34:35], v2 offset:20992
    s_add_u32 s74, s44, s46
    v_mfma_f32_32x32x16_bf16 v[96:111], v[44:47], v[216:219], v[96:111]
    ds_read_b64_tr_b16 v[36:37], v3 offset:20480
    ds_read_b64_tr_b16 v[38:39], v3 offset:20992
    s_waitcnt lgkmcnt(4)
    v_mfma_f32_32x32x16_bf16 v[80:95], v[24:27], v[220:223], v[80:95]
    ds_read_b64_tr_b16 v[40:41], v2 offset:22528
    ds_read_b64_tr_b16 v[42:43], v2 offset:23040
    v_mfma_f32_32x32x16_bf16 v[96:111], v[28:31], v[220:223], v[96:111]
    ds_read_b64_tr_b16 v[44:45], v3 offset:22528
    ds_read_b64_tr_b16 v[46:47], v3 offset:23040
    s_min_u32 s74, s74, 26
    s_waitcnt lgkmcnt(4)
    v_mfma_f32_32x32x16_bf16 v[80:95], v[32:35], v[224:227], v[80:95]
    ds_read_b64_tr_b16 v[24:25], v2 offset:24576
    ds_read_b64_tr_b16 v[26:27], v2 offset:25088
    v_mfma_f32_32x32x16_bf16 v[96:111], v[36:39], v[224:227], v[96:111]
    ds_read_b64_tr_b16 v[28:29], v3 offset:24576
    ds_read_b64_tr_b16 v[30:31], v3 offset:25088
    s_waitcnt lgkmcnt(4)
    v_mfma_f32_32x32x16_bf16 v[80:95], v[40:43], v[228:231], v[80:95]
    ds_read_b64_tr_b16 v[32:33], v2 offset:26624
    ds_read_b64_tr_b16 v[34:35], v2 offset:27136
    s_add_u32 s74, s74, 72
    v_mfma_f32_32x32x16_bf16 v[96:111], v[44:47], v[228:231], v[96:111]
    ds_read_b64_tr_b16 v[36:37], v3 offset:26624
    ds_read_b64_tr_b16 v[38:39], v3 offset:27136
    s_waitcnt lgkmcnt(4)
    v_mfma_f32_32x32x16_bf16 v[80:95], v[24:27], v[232:235], v[80:95]
    ds_read_b64_tr_b16 v[40:41], v2 offset:28672
    ds_read_b64_tr_b16 v[42:43], v2 offset:29184
    s_cmp_lt_u32 s46, s39
    s_cselect_b32 s47, s72, s74
    s_cselect_b32 s48, -1, 0
    v_mfma_f32_32x32x16_bf16 v[96:111], v[28:31], v[232:235], v[96:111]
    ds_read_b64_tr_b16 v[44:45], v3 offset:28672
    ds_read_b64_tr_b16 v[46:47], v3 offset:29184
    s_waitcnt lgkmcnt(4)
    v_mfma_f32_32x32x16_bf16 v[80:95], v[32:35], v[236:239], v[80:95]
    ds_read_b64_tr_b16 v[24:25], v2 offset:30720
    ds_read_b64_tr_b16 v[26:27], v2 offset:31232
    v_mfma_f32_32x32x16_bf16 v[96:111], v[36:39], v[236:239], v[96:111]
    ds_read_b64_tr_b16 v[28:29], v3 offset:30720
    ds_read_b64_tr_b16 v[30:31], v3 offset:31232
    s_lshl_b32 s59, s47, 18
    s_waitcnt lgkmcnt(4)
    v_mfma_f32_32x32x16_bf16 v[80:95], v[40:43], v[240:243], v[80:95]
    ds_read_b64_tr_b16 v[32:33], v2 offset:32768
    ds_read_b64_tr_b16 v[34:35], v2 offset:33280
    v_mfma_f32_32x32x16_bf16 v[96:111], v[44:47], v[240:243], v[96:111]
    ds_read_b64_tr_b16 v[36:37], v3 offset:32768
    ds_read_b64_tr_b16 v[38:39], v3 offset:33280
    s_waitcnt lgkmcnt(4)
    v_mfma_f32_32x32x16_bf16 v[80:95], v[24:27], v[244:247], v[80:95]
    ds_read_b64_tr_b16 v[40:41], v2 offset:34816
    ds_read_b64_tr_b16 v[42:43], v2 offset:35328
    v_mfma_f32_32x32x16_bf16 v[96:111], v[28:31], v[244:247], v[96:111]
    ds_read_b64_tr_b16 v[44:45], v3 offset:34816
    ds_read_b64_tr_b16 v[46:47], v3 offset:35328
    v_and_b32 v23, s48, v5
    v_xor_b32 v2, v23, v4
    v_add_u32 v2, 73728, v2
    v_xor_b32 v3, 64, v2
    s_waitcnt lgkmcnt(4)
    v_mfma_f32_32x32x16_bf16 v[80:95], v[32:35], v[248:251], v[80:95]
    s_barrier
    ds_read_b64_tr_b16 v[24:25], v2 offset:0
    ds_read_b64_tr_b16 v[26:27], v2 offset:512
    v_mfma_f32_32x32x16_bf16 v[96:111], v[36:39], v[248:251], v[96:111]
    ds_read_b64_tr_b16 v[28:29], v3 offset:0
    ds_read_b64_tr_b16 v[30:31], v3 offset:512
    s_waitcnt lgkmcnt(4)
    v_mfma_f32_32x32x16_bf16 v[80:95], v[40:43], v[252:255], v[80:95]
    ds_read_b64_tr_b16 v[32:33], v2 offset:2048
    ds_read_b64_tr_b16 v[34:35], v2 offset:2560
    v_mfma_f32_32x32x16_bf16 v[96:111], v[44:47], v[252:255], v[96:111]
    ds_read_b64_tr_b16 v[36:37], v3 offset:2048
    ds_read_b64_tr_b16 v[38:39], v3 offset:2560
    s_mov_b32 s57, s58
    s_mov_b32 s58, s59
    s_mov_b32 s45, s46
recurrent_scan__sliding_local_dilated__mixer_gmlp__prompt_kernel_G1:
    s_waitcnt lgkmcnt(4)
    v_mfma_f32_32x32x16_bf16 v[48:63], v[24:27], v[112:115], 0
    s_add_u32 s46, s45, 1
    ds_read_b64_tr_b16 v[40:41], v2 offset:4096
    ds_read_b64_tr_b16 v[42:43], v2 offset:4608
    v_mfma_f32_32x32x16_bf16 v[64:79], v[28:31], v[112:115], 0
    ds_read_b64_tr_b16 v[44:45], v3 offset:4096
    ds_read_b64_tr_b16 v[46:47], v3 offset:4608
    s_add_u32 s72, s42, s46
    s_add_u32 s74, s44, s46
    s_min_u32 s74, s74, 26
    s_add_u32 s74, s74, 72
    s_waitcnt lgkmcnt(4)
    v_mfma_f32_32x32x16_bf16 v[48:63], v[32:35], v[116:119], v[48:63]
    s_barrier
    ds_read_b64_tr_b16 v[24:25], v2 offset:6144
    ds_read_b64_tr_b16 v[26:27], v2 offset:6656
    s_cmp_lt_u32 s46, s39
    s_cselect_b32 s47, s72, s74
    s_cselect_b32 s48, -1, 0
    s_lshl_b32 s59, s47, 18
    v_mul_f32 v80, v9, v80
    v_mfma_f32_32x32x16_bf16 v[64:79], v[36:39], v[116:119], v[64:79]
    ds_read_b64_tr_b16 v[28:29], v3 offset:6144
    ds_read_b64_tr_b16 v[30:31], v3 offset:6656
    v_mul_f32 v81, v9, v81
    v_fma_f32 v16, v80, v80, s63
    v_mul_f32 v82, v9, v82
    v_fma_f32 v17, v81, v81, s63
    v_mul_f32 v16, v16, v80
    s_waitcnt lgkmcnt(4)
    v_mfma_f32_32x32x16_bf16 v[48:63], v[40:43], v[120:123], v[48:63]
    ds_read_b64_tr_b16 v[32:33], v2 offset:8192
    ds_read_b64_tr_b16 v[34:35], v2 offset:8704
    v_exp_f32 v16, v16
    v_mul_f32 v83, v9, v83
    v_fma_f32 v18, v82, v82, s63
    v_mul_f32 v17, v17, v81
    v_mfma_f32_32x32x16_bf16 v[64:79], v[44:47], v[120:123], v[64:79]
    ds_read_b64_tr_b16 v[36:37], v3 offset:8192
    ds_read_b64_tr_b16 v[38:39], v3 offset:8704
    v_exp_f32 v17, v17
    v_mul_f32 v84, v9, v84
    v_add_f32 v16, 1.0, v16
    v_fma_f32 v19, v83, v83, s63
    s_waitcnt lgkmcnt(4)
    v_mfma_f32_32x32x16_bf16 v[48:63], v[24:27], v[124:127], v[48:63]
    ds_read_b64_tr_b16 v[40:41], v2 offset:10240
    ds_read_b64_tr_b16 v[42:43], v2 offset:10752
    v_mul_f32 v18, v18, v82
    v_exp_f32 v18, v18
    v_mul_f32 v85, v9, v85
    v_mfma_f32_32x32x16_bf16 v[64:79], v[28:31], v[124:127], v[64:79]
    ds_read_b64_tr_b16 v[44:45], v3 offset:10240
    ds_read_b64_tr_b16 v[46:47], v3 offset:10752
    v_add_f32 v17, 1.0, v17
    v_fma_f32 v20, v84, v84, s63
    v_rcp_f32 v16, v16
    v_mul_f32 v19, v19, v83
    v_mul_f32 v80, v16, v80
    s_waitcnt lgkmcnt(4)
    v_mfma_f32_32x32x16_bf16 v[48:63], v[32:35], v[128:131], v[48:63]
    ds_read_b64_tr_b16 v[24:25], v2 offset:12288
    ds_read_b64_tr_b16 v[26:27], v2 offset:12800
    v_exp_f32 v19, v19
    v_mul_f32 v86, v9, v86
    v_add_f32 v18, 1.0, v18
    v_mfma_f32_32x32x16_bf16 v[64:79], v[36:39], v[128:131], v[64:79]
    ds_read_b64_tr_b16 v[28:29], v3 offset:12288
    ds_read_b64_tr_b16 v[30:31], v3 offset:12800
    v_fma_f32 v21, v85, v85, s63
    v_rcp_f32 v17, v17
    v_mul_f32 v20, v20, v84
    v_mul_f32 v81, v17, v81
    s_waitcnt lgkmcnt(4)
    v_mfma_f32_32x32x16_bf16 v[48:63], v[40:43], v[132:135], v[48:63]
    ds_read_b64_tr_b16 v[32:33], v2 offset:14336
    ds_read_b64_tr_b16 v[34:35], v2 offset:14848
    v_exp_f32 v20, v20
    v_mul_f32 v87, v9, v87
    v_add_f32 v19, 1.0, v19
    v_fma_f32 v16, v86, v86, s63
    v_mfma_f32_32x32x16_bf16 v[64:79], v[44:47], v[132:135], v[64:79]
    ds_read_b64_tr_b16 v[36:37], v3 offset:14336
    ds_read_b64_tr_b16 v[38:39], v3 offset:14848
    v_rcp_f32 v18, v18
    v_mul_f32 v21, v21, v85
    v_mul_f32 v82, v18, v82
    v_exp_f32 v21, v21
    s_waitcnt lgkmcnt(4)
    v_mfma_f32_32x32x16_bf16 v[48:63], v[24:27], v[136:139], v[48:63]
    ds_read_b64_tr_b16 v[40:41], v2 offset:16384
    ds_read_b64_tr_b16 v[42:43], v2 offset:16896
    v_mul_f32 v88, v9, v88
    v_add_f32 v20, 1.0, v20
    v_fma_f32 v17, v87, v87, s63
    v_mfma_f32_32x32x16_bf16 v[64:79], v[28:31], v[136:139], v[64:79]
    ds_read_b64_tr_b16 v[44:45], v3 offset:16384
    ds_read_b64_tr_b16 v[46:47], v3 offset:16896
    v_rcp_f32 v19, v19
    v_mul_f32 v16, v16, v86
    v_cvt_pk_bf16_f32 v80, v80, v81
    v_mul_f32 v83, v19, v83
    v_exp_f32 v16, v16
    s_waitcnt lgkmcnt(4)
    v_mfma_f32_32x32x16_bf16 v[48:63], v[32:35], v[140:143], v[48:63]
    ds_read_b64_tr_b16 v[24:25], v2 offset:18432
    ds_read_b64_tr_b16 v[26:27], v2 offset:18944
    v_mul_f32 v89, v9, v89
    v_add_f32 v21, 1.0, v21
    v_fma_f32 v18, v88, v88, s63
    v_mfma_f32_32x32x16_bf16 v[64:79], v[36:39], v[140:143], v[64:79]
    ds_read_b64_tr_b16 v[28:29], v3 offset:18432
    ds_read_b64_tr_b16 v[30:31], v3 offset:18944
    v_rcp_f32 v20, v20
    v_mul_f32 v17, v17, v87
    v_mul_f32 v84, v20, v84
    v_exp_f32 v17, v17
    s_waitcnt lgkmcnt(4)
    v_mfma_f32_32x32x16_bf16 v[48:63], v[40:43], v[144:147], v[48:63]
    ds_read_b64_tr_b16 v[32:33], v2 offset:20480
    ds_read_b64_tr_b16 v[34:35], v2 offset:20992
    v_mul_f32 v90, v9, v90
    v_add_f32 v16, 1.0, v16
    v_fma_f32 v19, v89, v89, s63
    v_rcp_f32 v21, v21
    v_mfma_f32_32x32x16_bf16 v[64:79], v[44:47], v[144:147], v[64:79]
    ds_read_b64_tr_b16 v[36:37], v3 offset:20480
    ds_read_b64_tr_b16 v[38:39], v3 offset:20992
    v_mul_f32 v18, v18, v88
    v_cvt_pk_bf16_f32 v81, v82, v83
    v_mul_f32 v85, v21, v85
    v_exp_f32 v18, v18
    s_waitcnt lgkmcnt(4)
    v_mfma_f32_32x32x16_bf16 v[48:63], v[24:27], v[148:151], v[48:63]
    ds_read_b64_tr_b16 v[40:41], v2 offset:22528
    ds_read_b64_tr_b16 v[42:43], v2 offset:23040
    v_mul_f32 v91, v9, v91
    v_add_f32 v17, 1.0, v17
    v_fma_f32 v20, v90, v90, s63
    v_rcp_f32 v16, v16
    v_mfma_f32_32x32x16_bf16 v[64:79], v[28:31], v[148:151], v[64:79]
    ds_read_b64_tr_b16 v[44:45], v3 offset:22528
    ds_read_b64_tr_b16 v[46:47], v3 offset:23040
    v_mul_f32 v19, v19, v89
    v_mul_f32 v86, v16, v86
    v_exp_f32 v19, v19
    v_mul_f32 v92, v9, v92
    s_waitcnt lgkmcnt(4)
    v_mfma_f32_32x32x16_bf16 v[48:63], v[32:35], v[152:155], v[48:63]
    ds_read_b64_tr_b16 v[24:25], v2 offset:24576
    ds_read_b64_tr_b16 v[26:27], v2 offset:25088
    v_add_f32 v18, 1.0, v18
    v_fma_f32 v21, v91, v91, s63
    v_rcp_f32 v17, v17
    v_mfma_f32_32x32x16_bf16 v[64:79], v[36:39], v[152:155], v[64:79]
    ds_read_b64_tr_b16 v[28:29], v3 offset:24576
    ds_read_b64_tr_b16 v[30:31], v3 offset:25088
    v_mul_f32 v20, v20, v90
    v_cvt_pk_bf16_f32 v82, v84, v85
    v_mul_f32 v87, v17, v87
    v_exp_f32 v20, v20
    s_waitcnt lgkmcnt(4)
    v_mfma_f32_32x32x16_bf16 v[48:63], v[40:43], v[156:159], v[48:63]
    ds_read_b64_tr_b16 v[32:33], v2 offset:26624
    ds_read_b64_tr_b16 v[34:35], v2 offset:27136
    v_mul_f32 v93, v9, v93
    v_add_f32 v19, 1.0, v19
    v_fma_f32 v16, v92, v92, s63
    v_rcp_f32 v18, v18
    v_mfma_f32_32x32x16_bf16 v[64:79], v[44:47], v[156:159], v[64:79]
    ds_read_b64_tr_b16 v[36:37], v3 offset:26624
    ds_read_b64_tr_b16 v[38:39], v3 offset:27136
    v_mul_f32 v21, v21, v91
    v_mul_f32 v88, v18, v88
    v_exp_f32 v21, v21
    v_mul_f32 v94, v9, v94
    s_waitcnt lgkmcnt(4)
    v_mfma_f32_32x32x16_bf16 v[48:63], v[24:27], v[160:163], v[48:63]
    ds_read_b64_tr_b16 v[40:41], v2 offset:28672
    ds_read_b64_tr_b16 v[42:43], v2 offset:29184
    v_add_f32 v20, 1.0, v20
    v_fma_f32 v17, v93, v93, s63
    v_rcp_f32 v19, v19
    v_mul_f32 v16, v16, v92
    v_mfma_f32_32x32x16_bf16 v[64:79], v[28:31], v[160:163], v[64:79]
    ds_read_b64_tr_b16 v[44:45], v3 offset:28672
    ds_read_b64_tr_b16 v[46:47], v3 offset:29184
    v_cvt_pk_bf16_f32 v83, v86, v87
    v_mul_f32 v89, v19, v89
    v_exp_f32 v16, v16
    v_mul_f32 v95, v9, v95
    s_waitcnt lgkmcnt(4)
    v_mfma_f32_32x32x16_bf16 v[48:63], v[32:35], v[164:167], v[48:63]
    ds_read_b64_tr_b16 v[24:25], v2 offset:30720
    ds_read_b64_tr_b16 v[26:27], v2 offset:31232
    v_add_f32 v21, 1.0, v21
    v_fma_f32 v18, v94, v94, s63
    v_rcp_f32 v20, v20
    v_mfma_f32_32x32x16_bf16 v[64:79], v[36:39], v[164:167], v[64:79]
    ds_read_b64_tr_b16 v[28:29], v3 offset:30720
    ds_read_b64_tr_b16 v[30:31], v3 offset:31232
    v_mul_f32 v17, v17, v93
    v_mul_f32 v90, v20, v90
    v_exp_f32 v17, v17
    v_mul_f32 v96, v9, v96
    v_add_f32 v16, 1.0, v16
    s_waitcnt lgkmcnt(4)
    v_mfma_f32_32x32x16_bf16 v[48:63], v[40:43], v[168:171], v[48:63]
    ds_read_b64_tr_b16 v[32:33], v2 offset:32768
    ds_read_b64_tr_b16 v[34:35], v2 offset:33280
    v_fma_f32 v19, v95, v95, s63
    v_rcp_f32 v21, v21
    v_mul_f32 v18, v18, v94
    v_mfma_f32_32x32x16_bf16 v[64:79], v[44:47], v[168:171], v[64:79]
    ds_read_b64_tr_b16 v[36:37], v3 offset:32768
    ds_read_b64_tr_b16 v[38:39], v3 offset:33280
    v_cvt_pk_bf16_f32 v88, v88, v89
    v_mul_f32 v91, v21, v91
    v_exp_f32 v18, v18
    v_mul_f32 v97, v9, v97
    v_add_f32 v17, 1.0, v17
    s_waitcnt lgkmcnt(4)
    v_mfma_f32_32x32x16_bf16 v[48:63], v[24:27], v[172:175], v[48:63]
    ds_read_b64_tr_b16 v[40:41], v2 offset:34816
    ds_read_b64_tr_b16 v[42:43], v2 offset:35328
    v_fma_f32 v20, v96, v96, s63
    v_rcp_f32 v16, v16
    v_mul_f32 v19, v19, v95
    v_mfma_f32_32x32x16_bf16 v[64:79], v[28:31], v[172:175], v[64:79]
    ds_read_b64_tr_b16 v[44:45], v3 offset:34816
    ds_read_b64_tr_b16 v[46:47], v3 offset:35328
    v_mul_f32 v92, v16, v92
    v_exp_f32 v19, v19
    v_mul_f32 v98, v9, v98
    v_add_f32 v18, 1.0, v18
    s_waitcnt lgkmcnt(4)
    v_mfma_f32_32x32x16_bf16 v[48:63], v[32:35], v[176:179], v[48:63]
    v_add_u32 v2, 36864, v2
    v_add_u32 v3, 36864, v3
    ds_read_b64_tr_b16 v[24:25], v2 offset:0
    ds_read_b64_tr_b16 v[26:27], v2 offset:512
    v_fma_f32 v21, v97, v97, s63
    v_rcp_f32 v17, v17
    v_mfma_f32_32x32x16_bf16 v[64:79], v[36:39], v[176:179], v[64:79]
    ds_read_b64_tr_b16 v[28:29], v3 offset:0
    ds_read_b64_tr_b16 v[30:31], v3 offset:512
    v_mul_f32 v20, v20, v96
    v_cvt_pk_bf16_f32 v89, v90, v91
    v_mul_f32 v93, v17, v93
    v_exp_f32 v20, v20
    s_waitcnt lgkmcnt(4)
    v_mfma_f32_32x32x16_bf16 v[48:63], v[40:43], v[180:183], v[48:63]
    ds_read_b64_tr_b16 v[32:33], v2 offset:2048
    ds_read_b64_tr_b16 v[34:35], v2 offset:2560
    v_mul_f32 v99, v9, v99
    v_add_f32 v19, 1.0, v19
    v_fma_f32 v16, v98, v98, s63
    v_rcp_f32 v18, v18
    v_mfma_f32_32x32x16_bf16 v[64:79], v[44:47], v[180:183], v[64:79]
    ds_read_b64_tr_b16 v[36:37], v3 offset:2048
    ds_read_b64_tr_b16 v[38:39], v3 offset:2560
    v_mul_f32 v21, v21, v97
    v_mul_f32 v94, v18, v94
    v_exp_f32 v21, v21
    v_mul_f32 v100, v9, v100
    s_waitcnt lgkmcnt(4)
    v_mfma_f32_32x32x16_bf16 v[48:63], v[24:27], v[184:187], v[48:63]
    ds_read_b64_tr_b16 v[40:41], v2 offset:4096
    ds_read_b64_tr_b16 v[42:43], v2 offset:4608
    v_add_f32 v20, 1.0, v20
    v_fma_f32 v17, v99, v99, s63
    v_rcp_f32 v19, v19
    v_mfma_f32_32x32x16_bf16 v[64:79], v[28:31], v[184:187], v[64:79]
    ds_read_b64_tr_b16 v[44:45], v3 offset:4096
    ds_read_b64_tr_b16 v[46:47], v3 offset:4608
    v_mul_f32 v16, v16, v98
    v_cvt_pk_bf16_f32 v90, v92, v93
    v_mul_f32 v95, v19, v95
    v_exp_f32 v16, v16
    v_mul_f32 v101, v9, v101
    s_waitcnt lgkmcnt(4)
    v_mfma_f32_32x32x16_bf16 v[48:63], v[32:35], v[188:191], v[48:63]
    ds_read_b64_tr_b16 v[24:25], v2 offset:6144
    ds_read_b64_tr_b16 v[26:27], v2 offset:6656
    v_add_f32 v21, 1.0, v21
    v_fma_f32 v18, v100, v100, s63
    v_rcp_f32 v20, v20
    v_mfma_f32_32x32x16_bf16 v[64:79], v[36:39], v[188:191], v[64:79]
    ds_read_b64_tr_b16 v[28:29], v3 offset:6144
    ds_read_b64_tr_b16 v[30:31], v3 offset:6656
    v_mul_f32 v17, v17, v99
    v_mul_f32 v96, v20, v96
    v_exp_f32 v17, v17
    v_mul_f32 v102, v9, v102
    v_add_f32 v16, 1.0, v16
    s_waitcnt lgkmcnt(4)
    v_mfma_f32_32x32x16_bf16 v[48:63], v[40:43], v[192:195], v[48:63]
    ds_read_b64_tr_b16 v[32:33], v2 offset:8192
    ds_read_b64_tr_b16 v[34:35], v2 offset:8704
    v_fma_f32 v19, v101, v101, s63
    v_rcp_f32 v21, v21
    v_mul_f32 v18, v18, v100
    v_mfma_f32_32x32x16_bf16 v[64:79], v[44:47], v[192:195], v[64:79]
    ds_read_b64_tr_b16 v[36:37], v3 offset:8192
    ds_read_b64_tr_b16 v[38:39], v3 offset:8704
    v_cvt_pk_bf16_f32 v91, v94, v95
    v_mul_f32 v97, v21, v97
    v_exp_f32 v18, v18
    v_mul_f32 v103, v9, v103
    s_waitcnt lgkmcnt(4)
    v_mfma_f32_32x32x16_bf16 v[48:63], v[24:27], v[196:199], v[48:63]
    ds_read_b64_tr_b16 v[40:41], v2 offset:10240
    ds_read_b64_tr_b16 v[42:43], v2 offset:10752
    v_add_f32 v17, 1.0, v17
    v_fma_f32 v20, v102, v102, s63
    v_rcp_f32 v16, v16
    v_mul_f32 v19, v19, v101
    v_mfma_f32_32x32x16_bf16 v[64:79], v[28:31], v[196:199], v[64:79]
    ds_read_b64_tr_b16 v[44:45], v3 offset:10240
    ds_read_b64_tr_b16 v[46:47], v3 offset:10752
    v_mul_f32 v98, v16, v98
    v_exp_f32 v19, v19
    v_mul_f32 v104, v9, v104
    v_add_f32 v18, 1.0, v18
    s_waitcnt lgkmcnt(4)
    v_mfma_f32_32x32x16_bf16 v[48:63], v[32:35], v[200:203], v[48:63]
    ds_read_b64_tr_b16 v[24:25], v2 offset:12288
    ds_read_b64_tr_b16 v[26:27], v2 offset:12800
    v_fma_f32 v21, v103, v103, s63
    v_rcp_f32 v17, v17
    v_mul_f32 v20, v20, v102
    v_cvt_pk_bf16_f32 v96, v96, v97
    v_mfma_f32_32x32x16_bf16 v[64:79], v[36:39], v[200:203], v[64:79]
    ds_read_b64_tr_b16 v[28:29], v3 offset:12288
    ds_read_b64_tr_b16 v[30:31], v3 offset:12800
    v_mul_f32 v99, v17, v99
    v_exp_f32 v20, v20
    v_mul_f32 v105, v9, v105
    v_add_f32 v19, 1.0, v19
    s_waitcnt lgkmcnt(4)
    v_mfma_f32_32x32x16_bf16 v[48:63], v[40:43], v[204:207], v[48:63]
    ds_read_b64_tr_b16 v[32:33], v2 offset:14336
    ds_read_b64_tr_b16 v[34:35], v2 offset:14848
    v_fma_f32 v16, v104, v104, s63
    v_rcp_f32 v18, v18
    v_mul_f32 v21, v21, v103
    v_mfma_f32_32x32x16_bf16 v[64:79], v[44:47], v[204:207], v[64:79]
    ds_read_b64_tr_b16 v[36:37], v3 offset:14336
    ds_read_b64_tr_b16 v[38:39], v3 offset:14848
    v_mul_f32 v100, v18, v100
    v_exp_f32 v21, v21
    v_mul_f32 v106, v9, v106
    v_add_f32 v20, 1.0, v20
    v_fma_f32 v17, v105, v105, s63
    s_waitcnt lgkmcnt(4)
    v_mfma_f32_32x32x16_bf16 v[48:63], v[24:27], v[208:211], v[48:63]
    ds_read_b64_tr_b16 v[40:41], v2 offset:16384
    ds_read_b64_tr_b16 v[42:43], v2 offset:16896
    v_rcp_f32 v19, v19
    v_mul_f32 v16, v16, v104
    v_cvt_pk_bf16_f32 v97, v98, v99
    v_mfma_f32_32x32x16_bf16 v[64:79], v[28:31], v[208:211], v[64:79]
    ds_read_b64_tr_b16 v[44:45], v3 offset:16384
    ds_read_b64_tr_b16 v[46:47], v3 offset:16896
    v_mul_f32 v101, v19, v101
    v_exp_f32 v16, v16
    v_mul_f32 v107, v9, v107
    v_add_f32 v21, 1.0, v21
    v_fma_f32 v18, v106, v106, s63
    s_waitcnt lgkmcnt(4)
    v_mfma_f32_32x32x16_bf16 v[48:63], v[32:35], v[212:215], v[48:63]
    ds_read_b64_tr_b16 v[24:25], v2 offset:18432
    ds_read_b64_tr_b16 v[26:27], v2 offset:18944
    v_rcp_f32 v20, v20
    v_mul_f32 v17, v17, v105
    v_mul_f32 v102, v20, v102
    v_mfma_f32_32x32x16_bf16 v[64:79], v[36:39], v[212:215], v[64:79]
    ds_read_b64_tr_b16 v[28:29], v3 offset:18432
    ds_read_b64_tr_b16 v[30:31], v3 offset:18944
    v_exp_f32 v17, v17
    v_mul_f32 v108, v9, v108
    v_add_f32 v16, 1.0, v16
    v_fma_f32 v19, v107, v107, s63
    s_waitcnt lgkmcnt(4)
    v_mfma_f32_32x32x16_bf16 v[48:63], v[40:43], v[216:219], v[48:63]
    ds_read_b64_tr_b16 v[32:33], v2 offset:20480
    ds_read_b64_tr_b16 v[34:35], v2 offset:20992
    v_rcp_f32 v21, v21
    v_mul_f32 v18, v18, v106
    v_cvt_pk_bf16_f32 v98, v100, v101
    v_mul_f32 v103, v21, v103
    v_mfma_f32_32x32x16_bf16 v[64:79], v[44:47], v[216:219], v[64:79]
    ds_read_b64_tr_b16 v[36:37], v3 offset:20480
    ds_read_b64_tr_b16 v[38:39], v3 offset:20992
    v_exp_f32 v18, v18
    v_mul_f32 v109, v9, v109
    v_add_f32 v17, 1.0, v17
    v_fma_f32 v20, v108, v108, s63
    s_waitcnt lgkmcnt(4)
    v_mfma_f32_32x32x16_bf16 v[48:63], v[24:27], v[220:223], v[48:63]
    ds_read_b64_tr_b16 v[40:41], v2 offset:22528
    ds_read_b64_tr_b16 v[42:43], v2 offset:23040
    v_rcp_f32 v16, v16
    v_mul_f32 v19, v19, v107
    v_mul_f32 v104, v16, v104
    v_mfma_f32_32x32x16_bf16 v[64:79], v[28:31], v[220:223], v[64:79]
    ds_read_b64_tr_b16 v[44:45], v3 offset:22528
    ds_read_b64_tr_b16 v[46:47], v3 offset:23040
    v_exp_f32 v19, v19
    v_mul_f32 v110, v9, v110
    v_add_f32 v18, 1.0, v18
    v_fma_f32 v21, v109, v109, s63
    v_rcp_f32 v17, v17
    s_waitcnt lgkmcnt(4)
    v_mfma_f32_32x32x16_bf16 v[48:63], v[32:35], v[224:227], v[48:63]
    ds_read_b64_tr_b16 v[24:25], v2 offset:24576
    ds_read_b64_tr_b16 v[26:27], v2 offset:25088
    v_mul_f32 v20, v20, v108
    v_cvt_pk_bf16_f32 v99, v102, v103
    v_mul_f32 v105, v17, v105
    v_mfma_f32_32x32x16_bf16 v[64:79], v[36:39], v[224:227], v[64:79]
    ds_read_b64_tr_b16 v[28:29], v3 offset:24576
    ds_read_b64_tr_b16 v[30:31], v3 offset:25088
    v_exp_f32 v20, v20
    v_mul_f32 v111, v9, v111
    v_add_f32 v19, 1.0, v19
    v_fma_f32 v16, v110, v110, s63
    s_waitcnt lgkmcnt(4)
    v_mfma_f32_32x32x16_bf16 v[48:63], v[40:43], v[228:231], v[48:63]
    ds_read_b64_tr_b16 v[32:33], v2 offset:26624
    ds_read_b64_tr_b16 v[34:35], v2 offset:27136
    v_rcp_f32 v18, v18
    v_mul_f32 v21, v21, v109
    v_mul_f32 v106, v18, v106
    v_exp_f32 v21, v21
    v_mfma_f32_32x32x16_bf16 v[64:79], v[44:47], v[228:231], v[64:79]
    ds_read_b64_tr_b16 v[36:37], v3 offset:26624
    ds_read_b64_tr_b16 v[38:39], v3 offset:27136
    v_add_f32 v20, 1.0, v20
    v_fma_f32 v17, v111, v111, s63
    v_rcp_f32 v19, v19
    v_mul_f32 v16, v16, v110
    s_waitcnt lgkmcnt(4)
    v_mfma_f32_32x32x16_bf16 v[48:63], v[24:27], v[232:235], v[48:63]
    ds_read_b64_tr_b16 v[40:41], v2 offset:28672
    ds_read_b64_tr_b16 v[42:43], v2 offset:29184
    v_cvt_pk_bf16_f32 v104, v104, v105
    v_mul_f32 v107, v19, v107
    v_exp_f32 v16, v16
    v_mfma_f32_32x32x16_bf16 v[64:79], v[28:31], v[232:235], v[64:79]
    ds_read_b64_tr_b16 v[44:45], v3 offset:28672
    ds_read_b64_tr_b16 v[46:47], v3 offset:29184
    v_add_f32 v21, 1.0, v21
    v_rcp_f32 v20, v20
    v_mul_f32 v17, v17, v111
    v_mul_f32 v108, v20, v108
    s_waitcnt lgkmcnt(4)
    v_mfma_f32_32x32x16_bf16 v[48:63], v[32:35], v[236:239], v[48:63]
    ds_read_b64_tr_b16 v[24:25], v2 offset:30720
    ds_read_b64_tr_b16 v[26:27], v2 offset:31232
    s_add_u32 s76, s57, 0
    buffer_store_dwordx4 v[80:83], v6, s[24:27], s76 offen sc1
    v_exp_f32 v17, v17
    v_add_f32 v16, 1.0, v16
    v_mfma_f32_32x32x16_bf16 v[64:79], v[36:39], v[236:239], v[64:79]
    ds_read_b64_tr_b16 v[28:29], v3 offset:30720
    ds_read_b64_tr_b16 v[30:31], v3 offset:31232
    v_rcp_f32 v21, v21
    v_cvt_pk_bf16_f32 v105, v106, v107
    v_mul_f32 v109, v21, v109
    v_add_f32 v17, 1.0, v17
    s_waitcnt lgkmcnt(4)
    v_mfma_f32_32x32x16_bf16 v[48:63], v[40:43], v[240:243], v[48:63]
    ds_read_b64_tr_b16 v[32:33], v2 offset:32768
    ds_read_b64_tr_b16 v[34:35], v2 offset:33280
    s_add_u32 s76, s57, 65536
    buffer_store_dwordx4 v[88:91], v6, s[24:27], s76 offen sc1
    v_rcp_f32 v16, v16
    s_nop 0
    v_mul_f32 v110, v16, v110
    v_mfma_f32_32x32x16_bf16 v[64:79], v[44:47], v[240:243], v[64:79]
    ds_read_b64_tr_b16 v[36:37], v3 offset:32768
    ds_read_b64_tr_b16 v[38:39], v3 offset:33280
    v_rcp_f32 v17, v17
    v_cvt_pk_bf16_f32 v106, v108, v109
    v_mul_f32 v111, v17, v111
    v_cvt_pk_bf16_f32 v107, v110, v111
    s_waitcnt lgkmcnt(4)
    v_mfma_f32_32x32x16_bf16 v[48:63], v[24:27], v[244:247], v[48:63]
    ds_read_b64_tr_b16 v[40:41], v2 offset:34816
    ds_read_b64_tr_b16 v[42:43], v2 offset:35328
    s_add_u32 s76, s57, 131072
    buffer_store_dwordx4 v[96:99], v6, s[24:27], s76 offen sc1
    v_mfma_f32_32x32x16_bf16 v[64:79], v[28:31], v[244:247], v[64:79]
    ds_read_b64_tr_b16 v[44:45], v3 offset:34816
    ds_read_b64_tr_b16 v[46:47], v3 offset:35328
    v_and_b32 v23, s48, v5
    v_xor_b32 v2, v23, v4
    v_xor_b32 v3, 64, v2
    s_waitcnt lgkmcnt(4)
    v_mfma_f32_32x32x16_bf16 v[48:63], v[32:35], v[248:251], v[48:63]
    s_barrier
    ds_read_b64_tr_b16 v[24:25], v2 offset:0
    ds_read_b64_tr_b16 v[26:27], v2 offset:512
    s_add_u32 s76, s57, 196608
    buffer_store_dwordx4 v[104:107], v6, s[24:27], s76 offen sc1
    v_mfma_f32_32x32x16_bf16 v[64:79], v[36:39], v[248:251], v[64:79]
    ds_read_b64_tr_b16 v[28:29], v3 offset:0
    ds_read_b64_tr_b16 v[30:31], v3 offset:512
    s_waitcnt lgkmcnt(4)
    v_mfma_f32_32x32x16_bf16 v[48:63], v[40:43], v[252:255], v[48:63]
    ds_read_b64_tr_b16 v[32:33], v2 offset:2048
    ds_read_b64_tr_b16 v[34:35], v2 offset:2560
    v_mfma_f32_32x32x16_bf16 v[64:79], v[44:47], v[252:255], v[64:79]
    ds_read_b64_tr_b16 v[36:37], v3 offset:2048
    ds_read_b64_tr_b16 v[38:39], v3 offset:2560
.p2align 3
    v_dot2_f32_bf16 v10, v80, s66, v10
    v_dot2_f32_bf16 v11, v80, v80, v11
    v_dot2_f32_bf16 v10, v81, s66, v10
    v_dot2_f32_bf16 v11, v81, v81, v11
    v_dot2_f32_bf16 v10, v82, s66, v10
    v_dot2_f32_bf16 v11, v82, v82, v11
    v_dot2_f32_bf16 v10, v83, s66, v10
    v_dot2_f32_bf16 v11, v83, v83, v11
    v_dot2_f32_bf16 v10, v88, s66, v10
    v_dot2_f32_bf16 v11, v88, v88, v11
    v_dot2_f32_bf16 v10, v89, s66, v10
    v_dot2_f32_bf16 v11, v89, v89, v11
    v_dot2_f32_bf16 v10, v90, s66, v10
    v_dot2_f32_bf16 v11, v90, v90, v11
    v_dot2_f32_bf16 v10, v91, s66, v10
    v_dot2_f32_bf16 v11, v91, v91, v11
    v_dot2_f32_bf16 v10, v96, s66, v10
    v_dot2_f32_bf16 v11, v96, v96, v11
    v_dot2_f32_bf16 v10, v97, s66, v10
    v_dot2_f32_bf16 v11, v97, v97, v11
    v_dot2_f32_bf16 v10, v98, s66, v10
    v_dot2_f32_bf16 v11, v98, v98, v11
    v_dot2_f32_bf16 v10, v99, s66, v10
    v_dot2_f32_bf16 v11, v99, v99, v11
    v_dot2_f32_bf16 v10, v104, s66, v10
    v_dot2_f32_bf16 v11, v104, v104, v11
    v_dot2_f32_bf16 v10, v105, s66, v10
    v_dot2_f32_bf16 v11, v105, v105, v11
    v_dot2_f32_bf16 v10, v106, s66, v10
    v_dot2_f32_bf16 v11, v106, v106, v11
    v_dot2_f32_bf16 v10, v107, s66, v10
    v_dot2_f32_bf16 v11, v107, v107, v11
    s_nop 2
    ds_write_b64 v7, v[10:11]
    s_mov_b32 s57, s58
    s_mov_b32 s58, s59
    s_mov_b32 s45, s46
recurrent_scan__sliding_local_dilated__mixer_gmlp__prompt_kernel_G0:
    s_waitcnt lgkmcnt(4)
    v_mfma_f32_32x32x16_bf16 v[80:95], v[24:27], v[112:115], 0
    s_add_u32 s46, s45, 1
    ds_read_b64_tr_b16 v[40:41], v2 offset:4096
    ds_read_b64_tr_b16 v[42:43], v2 offset:4608
    v_mfma_f32_32x32x16_bf16 v[96:111], v[28:31], v[112:115], 0
    ds_read_b64_tr_b16 v[44:45], v3 offset:4096
    ds_read_b64_tr_b16 v[46:47], v3 offset:4608
    s_add_u32 s72, s42, s46
    s_add_u32 s74, s44, s46
    s_min_u32 s74, s74, 26
    s_add_u32 s74, s74, 72
    s_waitcnt lgkmcnt(4)
    v_mfma_f32_32x32x16_bf16 v[80:95], v[32:35], v[116:119], v[80:95]
    s_barrier
    ds_read_b64_tr_b16 v[24:25], v2 offset:6144
    ds_read_b64_tr_b16 v[26:27], v2 offset:6656
    s_cmp_lt_u32 s46, s39
    s_cselect_b32 s47, s72, s74
    s_cselect_b32 s48, -1, 0
    s_lshl_b32 s59, s47, 18
    v_mul_f32 v48, v9, v48
    v_mfma_f32_32x32x16_bf16 v[96:111], v[36:39], v[116:119], v[96:111]
    ds_read_b64_tr_b16 v[28:29], v3 offset:6144
    ds_read_b64_tr_b16 v[30:31], v3 offset:6656
    v_mul_f32 v49, v9, v49
    v_fma_f32 v16, v48, v48, s63
    v_mul_f32 v50, v9, v50
    v_fma_f32 v17, v49, v49, s63
    v_mul_f32 v16, v16, v48
    s_waitcnt lgkmcnt(4)
    v_mfma_f32_32x32x16_bf16 v[80:95], v[40:43], v[120:123], v[80:95]
    ds_read_b64_tr_b16 v[32:33], v2 offset:8192
    ds_read_b64_tr_b16 v[34:35], v2 offset:8704
    v_exp_f32 v16, v16
    v_mul_f32 v51, v9, v51
    v_fma_f32 v18, v50, v50, s63
    v_mul_f32 v17, v17, v49
    v_mfma_f32_32x32x16_bf16 v[96:111], v[44:47], v[120:123], v[96:111]
    ds_read_b64_tr_b16 v[36:37], v3 offset:8192
    ds_read_b64_tr_b16 v[38:39], v3 offset:8704
    v_exp_f32 v17, v17
    v_mul_f32 v52, v9, v52
    v_add_f32 v16, 1.0, v16
    v_fma_f32 v19, v51, v51, s63
    s_waitcnt lgkmcnt(4)
    v_mfma_f32_32x32x16_bf16 v[80:95], v[24:27], v[124:127], v[80:95]
    ds_read_b64_tr_b16 v[40:41], v2 offset:10240
    ds_read_b64_tr_b16 v[42:43], v2 offset:10752
    v_mul_f32 v18, v18, v50
    v_exp_f32 v18, v18
    v_mul_f32 v53, v9, v53
    v_mfma_f32_32x32x16_bf16 v[96:111], v[28:31], v[124:127], v[96:111]
    ds_read_b64_tr_b16 v[44:45], v3 offset:10240
    ds_read_b64_tr_b16 v[46:47], v3 offset:10752
    v_add_f32 v17, 1.0, v17
    v_fma_f32 v20, v52, v52, s63
    v_rcp_f32 v16, v16
    v_mul_f32 v19, v19, v51
    v_mul_f32 v48, v16, v48
    s_waitcnt lgkmcnt(4)
    v_mfma_f32_32x32x16_bf16 v[80:95], v[32:35], v[128:131], v[80:95]
    ds_read_b64_tr_b16 v[24:25], v2 offset:12288
    ds_read_b64_tr_b16 v[26:27], v2 offset:12800
    v_exp_f32 v19, v19
    v_mul_f32 v54, v9, v54
    v_add_f32 v18, 1.0, v18
    v_mfma_f32_32x32x16_bf16 v[96:111], v[36:39], v[128:131], v[96:111]
    ds_read_b64_tr_b16 v[28:29], v3 offset:12288
    ds_read_b64_tr_b16 v[30:31], v3 offset:12800
    v_fma_f32 v21, v53, v53, s63
    v_rcp_f32 v17, v17
    v_mul_f32 v20, v20, v52
    v_mul_f32 v49, v17, v49
    s_waitcnt lgkmcnt(4)
    v_mfma_f32_32x32x16_bf16 v[80:95], v[40:43], v[132:135], v[80:95]
    ds_read_b64_tr_b16 v[32:33], v2 offset:14336
    ds_read_b64_tr_b16 v[34:35], v2 offset:14848
    v_exp_f32 v20, v20
    v_mul_f32 v55, v9, v55
    v_add_f32 v19, 1.0, v19
    v_fma_f32 v16, v54, v54, s63
    v_mfma_f32_32x32x16_bf16 v[96:111], v[44:47], v[132:135], v[96:111]
    ds_read_b64_tr_b16 v[36:37], v3 offset:14336
    ds_read_b64_tr_b16 v[38:39], v3 offset:14848
    v_rcp_f32 v18, v18
    v_mul_f32 v21, v21, v53
    v_mul_f32 v50, v18, v50
    v_exp_f32 v21, v21
    s_waitcnt lgkmcnt(4)
    v_mfma_f32_32x32x16_bf16 v[80:95], v[24:27], v[136:139], v[80:95]
    ds_read_b64_tr_b16 v[40:41], v2 offset:16384
    ds_read_b64_tr_b16 v[42:43], v2 offset:16896
    v_mul_f32 v56, v9, v56
    v_add_f32 v20, 1.0, v20
    v_fma_f32 v17, v55, v55, s63
    v_mfma_f32_32x32x16_bf16 v[96:111], v[28:31], v[136:139], v[96:111]
    ds_read_b64_tr_b16 v[44:45], v3 offset:16384
    ds_read_b64_tr_b16 v[46:47], v3 offset:16896
    v_rcp_f32 v19, v19
    v_mul_f32 v16, v16, v54
    v_cvt_pk_bf16_f32 v48, v48, v49
    v_mul_f32 v51, v19, v51
    v_exp_f32 v16, v16
    s_waitcnt lgkmcnt(4)
    v_mfma_f32_32x32x16_bf16 v[80:95], v[32:35], v[140:143], v[80:95]
    ds_read_b64_tr_b16 v[24:25], v2 offset:18432
    ds_read_b64_tr_b16 v[26:27], v2 offset:18944
    v_mul_f32 v57, v9, v57
    v_add_f32 v21, 1.0, v21
    v_fma_f32 v18, v56, v56, s63
    v_mfma_f32_32x32x16_bf16 v[96:111], v[36:39], v[140:143], v[96:111]
    ds_read_b64_tr_b16 v[28:29], v3 offset:18432
    ds_read_b64_tr_b16 v[30:31], v3 offset:18944
    v_rcp_f32 v20, v20
    v_mul_f32 v17, v17, v55
    v_mul_f32 v52, v20, v52
    v_exp_f32 v17, v17
    s_waitcnt lgkmcnt(4)
    v_mfma_f32_32x32x16_bf16 v[80:95], v[40:43], v[144:147], v[80:95]
    ds_read_b64_tr_b16 v[32:33], v2 offset:20480
    ds_read_b64_tr_b16 v[34:35], v2 offset:20992
    v_mul_f32 v58, v9, v58
    v_add_f32 v16, 1.0, v16
    v_fma_f32 v19, v57, v57, s63
    v_rcp_f32 v21, v21
    v_mfma_f32_32x32x16_bf16 v[96:111], v[44:47], v[144:147], v[96:111]
    ds_read_b64_tr_b16 v[36:37], v3 offset:20480
    ds_read_b64_tr_b16 v[38:39], v3 offset:20992
    v_mul_f32 v18, v18, v56
    v_cvt_pk_bf16_f32 v49, v50, v51
    v_mul_f32 v53, v21, v53
    v_exp_f32 v18, v18
    s_waitcnt lgkmcnt(4)
    v_mfma_f32_32x32x16_bf16 v[80:95], v[24:27], v[148:151], v[80:95]
    ds_read_b64_tr_b16 v[40:41], v2 offset:22528
    ds_read_b64_tr_b16 v[42:43], v2 offset:23040
    v_mul_f32 v59, v9, v59
    v_add_f32 v17, 1.0, v17
    v_fma_f32 v20, v58, v58, s63
    v_rcp_f32 v16, v16
    v_mfma_f32_32x32x16_bf16 v[96:111], v[28:31], v[148:151], v[96:111]
    ds_read_b64_tr_b16 v[44:45], v3 offset:22528
    ds_read_b64_tr_b16 v[46:47], v3 offset:23040
    v_mul_f32 v19, v19, v57
    v_mul_f32 v54, v16, v54
    v_exp_f32 v19, v19
    v_mul_f32 v60, v9, v60
    s_waitcnt lgkmcnt(4)
    v_mfma_f32_32x32x16_bf16 v[80:95], v[32:35], v[152:155], v[80:95]
    ds_read_b64_tr_b16 v[24:25], v2 offset:24576
    ds_read_b64_tr_b16 v[26:27], v2 offset:25088
    v_add_f32 v18, 1.0, v18
    v_fma_f32 v21, v59, v59, s63
    v_rcp_f32 v17, v17
    v_mfma_f32_32x32x16_bf16 v[96:111], v[36:39], v[152:155], v[96:111]
    ds_read_b64_tr_b16 v[28:29], v3 offset:24576
    ds_read_b64_tr_b16 v[30:31], v3 offset:25088
    v_mul_f32 v20, v20, v58
    v_cvt_pk_bf16_f32 v50, v52, v53
    v_mul_f32 v55, v17, v55
    v_exp_f32 v20, v20
    s_waitcnt lgkmcnt(4)
    v_mfma_f32_32x32x16_bf16 v[80:95], v[40:43], v[156:159], v[80:95]
    ds_read_b64_tr_b16 v[32:33], v2 offset:26624
    ds_read_b64_tr_b16 v[34:35], v2 offset:27136
    v_mul_f32 v61, v9, v61
    v_add_f32 v19, 1.0, v19
    v_fma_f32 v16, v60, v60, s63
    v_rcp_f32 v18, v18
    v_mfma_f32_32x32x16_bf16 v[96:111], v[44:47], v[156:159], v[96:111]
    ds_read_b64_tr_b16 v[36:37], v3 offset:26624
    ds_read_b64_tr_b16 v[38:39], v3 offset:27136
    v_mul_f32 v21, v21, v59
    v_mul_f32 v56, v18, v56
    v_exp_f32 v21, v21
    v_mul_f32 v62, v9, v62
    s_waitcnt lgkmcnt(4)
    v_mfma_f32_32x32x16_bf16 v[80:95], v[24:27], v[160:163], v[80:95]
    ds_read_b64_tr_b16 v[40:41], v2 offset:28672
    ds_read_b64_tr_b16 v[42:43], v2 offset:29184
    v_add_f32 v20, 1.0, v20
    v_fma_f32 v17, v61, v61, s63
    v_rcp_f32 v19, v19
    v_mul_f32 v16, v16, v60
    v_mfma_f32_32x32x16_bf16 v[96:111], v[28:31], v[160:163], v[96:111]
    ds_read_b64_tr_b16 v[44:45], v3 offset:28672
    ds_read_b64_tr_b16 v[46:47], v3 offset:29184
    v_cvt_pk_bf16_f32 v51, v54, v55
    v_mul_f32 v57, v19, v57
    v_exp_f32 v16, v16
    v_mul_f32 v63, v9, v63
    s_waitcnt lgkmcnt(4)
    v_mfma_f32_32x32x16_bf16 v[80:95], v[32:35], v[164:167], v[80:95]
    ds_read_b64_tr_b16 v[24:25], v2 offset:30720
    ds_read_b64_tr_b16 v[26:27], v2 offset:31232
    v_add_f32 v21, 1.0, v21
    v_fma_f32 v18, v62, v62, s63
    v_rcp_f32 v20, v20
    v_mfma_f32_32x32x16_bf16 v[96:111], v[36:39], v[164:167], v[96:111]
    ds_read_b64_tr_b16 v[28:29], v3 offset:30720
    ds_read_b64_tr_b16 v[30:31], v3 offset:31232
    v_mul_f32 v17, v17, v61
    v_mul_f32 v58, v20, v58
    v_exp_f32 v17, v17
    v_mul_f32 v64, v9, v64
    v_add_f32 v16, 1.0, v16
    s_waitcnt lgkmcnt(4)
    v_mfma_f32_32x32x16_bf16 v[80:95], v[40:43], v[168:171], v[80:95]
    ds_read_b64_tr_b16 v[32:33], v2 offset:32768
    ds_read_b64_tr_b16 v[34:35], v2 offset:33280
    v_fma_f32 v19, v63, v63, s63
    v_rcp_f32 v21, v21
    v_mul_f32 v18, v18, v62
    v_mfma_f32_32x32x16_bf16 v[96:111], v[44:47], v[168:171], v[96:111]
    ds_read_b64_tr_b16 v[36:37], v3 offset:32768
    ds_read_b64_tr_b16 v[38:39], v3 offset:33280
    v_cvt_pk_bf16_f32 v56, v56, v57
    v_mul_f32 v59, v21, v59
    v_exp_f32 v18, v18
    v_mul_f32 v65, v9, v65
    v_add_f32 v17, 1.0, v17
    s_waitcnt lgkmcnt(4)
    v_mfma_f32_32x32x16_bf16 v[80:95], v[24:27], v[172:175], v[80:95]
    ds_read_b64_tr_b16 v[40:41], v2 offset:34816
    ds_read_b64_tr_b16 v[42:43], v2 offset:35328
    v_fma_f32 v20, v64, v64, s63
    v_rcp_f32 v16, v16
    v_mul_f32 v19, v19, v63
    v_mfma_f32_32x32x16_bf16 v[96:111], v[28:31], v[172:175], v[96:111]
    ds_read_b64_tr_b16 v[44:45], v3 offset:34816
    ds_read_b64_tr_b16 v[46:47], v3 offset:35328
    v_mul_f32 v60, v16, v60
    v_exp_f32 v19, v19
    v_mul_f32 v66, v9, v66
    v_add_f32 v18, 1.0, v18
    s_waitcnt lgkmcnt(4)
    v_mfma_f32_32x32x16_bf16 v[80:95], v[32:35], v[176:179], v[80:95]
    v_add_u32 v2, 36864, v2
    v_add_u32 v3, 36864, v3
    ds_read_b64_tr_b16 v[24:25], v2 offset:0
    ds_read_b64_tr_b16 v[26:27], v2 offset:512
    v_fma_f32 v21, v65, v65, s63
    v_rcp_f32 v17, v17
    v_mfma_f32_32x32x16_bf16 v[96:111], v[36:39], v[176:179], v[96:111]
    ds_read_b64_tr_b16 v[28:29], v3 offset:0
    ds_read_b64_tr_b16 v[30:31], v3 offset:512
    v_mul_f32 v20, v20, v64
    v_cvt_pk_bf16_f32 v57, v58, v59
    v_mul_f32 v61, v17, v61
    v_exp_f32 v20, v20
    s_waitcnt lgkmcnt(4)
    v_mfma_f32_32x32x16_bf16 v[80:95], v[40:43], v[180:183], v[80:95]
    ds_read_b64_tr_b16 v[32:33], v2 offset:2048
    ds_read_b64_tr_b16 v[34:35], v2 offset:2560
    v_mul_f32 v67, v9, v67
    v_add_f32 v19, 1.0, v19
    v_fma_f32 v16, v66, v66, s63
    v_rcp_f32 v18, v18
    v_mfma_f32_32x32x16_bf16 v[96:111], v[44:47], v[180:183], v[96:111]
    ds_read_b64_tr_b16 v[36:37], v3 offset:2048
    ds_read_b64_tr_b16 v[38:39], v3 offset:2560
    v_mul_f32 v21, v21, v65
    v_mul_f32 v62, v18, v62
    v_exp_f32 v21, v21
    v_mul_f32 v68, v9, v68
    s_waitcnt lgkmcnt(4)
    v_mfma_f32_32x32x16_bf16 v[80:95], v[24:27], v[184:187], v[80:95]
    ds_read_b64_tr_b16 v[40:41], v2 offset:4096
    ds_read_b64_tr_b16 v[42:43], v2 offset:4608
    v_add_f32 v20, 1.0, v20
    v_fma_f32 v17, v67, v67, s63
    v_rcp_f32 v19, v19
    v_mfma_f32_32x32x16_bf16 v[96:111], v[28:31], v[184:187], v[96:111]
    ds_read_b64_tr_b16 v[44:45], v3 offset:4096
    ds_read_b64_tr_b16 v[46:47], v3 offset:4608
    v_mul_f32 v16, v16, v66
    v_cvt_pk_bf16_f32 v58, v60, v61
    v_mul_f32 v63, v19, v63
    v_exp_f32 v16, v16
    v_mul_f32 v69, v9, v69
    s_waitcnt lgkmcnt(4)
    v_mfma_f32_32x32x16_bf16 v[80:95], v[32:35], v[188:191], v[80:95]
    ds_read_b64_tr_b16 v[24:25], v2 offset:6144
    ds_read_b64_tr_b16 v[26:27], v2 offset:6656
    v_add_f32 v21, 1.0, v21
    v_fma_f32 v18, v68, v68, s63
    v_rcp_f32 v20, v20
    v_mfma_f32_32x32x16_bf16 v[96:111], v[36:39], v[188:191], v[96:111]
    ds_read_b64_tr_b16 v[28:29], v3 offset:6144
    ds_read_b64_tr_b16 v[30:31], v3 offset:6656
    v_mul_f32 v17, v17, v67
    v_mul_f32 v64, v20, v64
    v_exp_f32 v17, v17
    v_mul_f32 v70, v9, v70
    v_add_f32 v16, 1.0, v16
    s_waitcnt lgkmcnt(4)
    v_mfma_f32_32x32x16_bf16 v[80:95], v[40:43], v[192:195], v[80:95]
    ds_read_b64_tr_b16 v[32:33], v2 offset:8192
    ds_read_b64_tr_b16 v[34:35], v2 offset:8704
    v_fma_f32 v19, v69, v69, s63
    v_rcp_f32 v21, v21
    v_mul_f32 v18, v18, v68
    v_mfma_f32_32x32x16_bf16 v[96:111], v[44:47], v[192:195], v[96:111]
    ds_read_b64_tr_b16 v[36:37], v3 offset:8192
    ds_read_b64_tr_b16 v[38:39], v3 offset:8704
    v_cvt_pk_bf16_f32 v59, v62, v63
    v_mul_f32 v65, v21, v65
    v_exp_f32 v18, v18
    v_mul_f32 v71, v9, v71
    s_waitcnt lgkmcnt(4)
    v_mfma_f32_32x32x16_bf16 v[80:95], v[24:27], v[196:199], v[80:95]
    ds_read_b64_tr_b16 v[40:41], v2 offset:10240
    ds_read_b64_tr_b16 v[42:43], v2 offset:10752
    v_add_f32 v17, 1.0, v17
    v_fma_f32 v20, v70, v70, s63
    v_rcp_f32 v16, v16
    v_mul_f32 v19, v19, v69
    v_mfma_f32_32x32x16_bf16 v[96:111], v[28:31], v[196:199], v[96:111]
    ds_read_b64_tr_b16 v[44:45], v3 offset:10240
    ds_read_b64_tr_b16 v[46:47], v3 offset:10752
    v_mul_f32 v66, v16, v66
    v_exp_f32 v19, v19
    v_mul_f32 v72, v9, v72
    v_add_f32 v18, 1.0, v18
    s_waitcnt lgkmcnt(4)
    v_mfma_f32_32x32x16_bf16 v[80:95], v[32:35], v[200:203], v[80:95]
    ds_read_b64_tr_b16 v[24:25], v2 offset:12288
    ds_read_b64_tr_b16 v[26:27], v2 offset:12800
    v_fma_f32 v21, v71, v71, s63
    v_rcp_f32 v17, v17
    v_mul_f32 v20, v20, v70
    v_cvt_pk_bf16_f32 v64, v64, v65
    v_mfma_f32_32x32x16_bf16 v[96:111], v[36:39], v[200:203], v[96:111]
    ds_read_b64_tr_b16 v[28:29], v3 offset:12288
    ds_read_b64_tr_b16 v[30:31], v3 offset:12800
    v_mul_f32 v67, v17, v67
    v_exp_f32 v20, v20
    v_mul_f32 v73, v9, v73
    v_add_f32 v19, 1.0, v19
    s_waitcnt lgkmcnt(4)
    v_mfma_f32_32x32x16_bf16 v[80:95], v[40:43], v[204:207], v[80:95]
    ds_read_b64_tr_b16 v[32:33], v2 offset:14336
    ds_read_b64_tr_b16 v[34:35], v2 offset:14848
    v_fma_f32 v16, v72, v72, s63
    v_rcp_f32 v18, v18
    v_mul_f32 v21, v21, v71
    v_mfma_f32_32x32x16_bf16 v[96:111], v[44:47], v[204:207], v[96:111]
    ds_read_b64_tr_b16 v[36:37], v3 offset:14336
    ds_read_b64_tr_b16 v[38:39], v3 offset:14848
    v_mul_f32 v68, v18, v68
    v_exp_f32 v21, v21
    v_mul_f32 v74, v9, v74
    v_add_f32 v20, 1.0, v20
    v_fma_f32 v17, v73, v73, s63
    s_waitcnt lgkmcnt(4)
    v_mfma_f32_32x32x16_bf16 v[80:95], v[24:27], v[208:211], v[80:95]
    ds_read_b64_tr_b16 v[40:41], v2 offset:16384
    ds_read_b64_tr_b16 v[42:43], v2 offset:16896
    v_rcp_f32 v19, v19
    v_mul_f32 v16, v16, v72
    v_cvt_pk_bf16_f32 v65, v66, v67
    v_mfma_f32_32x32x16_bf16 v[96:111], v[28:31], v[208:211], v[96:111]
    ds_read_b64_tr_b16 v[44:45], v3 offset:16384
    ds_read_b64_tr_b16 v[46:47], v3 offset:16896
    v_mul_f32 v69, v19, v69
    v_exp_f32 v16, v16
    v_mul_f32 v75, v9, v75
    v_add_f32 v21, 1.0, v21
    v_fma_f32 v18, v74, v74, s63
    s_waitcnt lgkmcnt(4)
    v_mfma_f32_32x32x16_bf16 v[80:95], v[32:35], v[212:215], v[80:95]
    ds_read_b64_tr_b16 v[24:25], v2 offset:18432
    ds_read_b64_tr_b16 v[26:27], v2 offset:18944
    v_rcp_f32 v20, v20
    v_mul_f32 v17, v17, v73
    v_mul_f32 v70, v20, v70
    v_mfma_f32_32x32x16_bf16 v[96:111], v[36:39], v[212:215], v[96:111]
    ds_read_b64_tr_b16 v[28:29], v3 offset:18432
    ds_read_b64_tr_b16 v[30:31], v3 offset:18944
    v_exp_f32 v17, v17
    v_mul_f32 v76, v9, v76
    v_add_f32 v16, 1.0, v16
    v_fma_f32 v19, v75, v75, s63
    s_waitcnt lgkmcnt(4)
    v_mfma_f32_32x32x16_bf16 v[80:95], v[40:43], v[216:219], v[80:95]
    ds_read_b64_tr_b16 v[32:33], v2 offset:20480
    ds_read_b64_tr_b16 v[34:35], v2 offset:20992
    v_rcp_f32 v21, v21
    v_mul_f32 v18, v18, v74
    v_cvt_pk_bf16_f32 v66, v68, v69
    v_mul_f32 v71, v21, v71
    v_mfma_f32_32x32x16_bf16 v[96:111], v[44:47], v[216:219], v[96:111]
    ds_read_b64_tr_b16 v[36:37], v3 offset:20480
    ds_read_b64_tr_b16 v[38:39], v3 offset:20992
    v_exp_f32 v18, v18
    v_mul_f32 v77, v9, v77
    v_add_f32 v17, 1.0, v17
    v_fma_f32 v20, v76, v76, s63
    s_waitcnt lgkmcnt(4)
    v_mfma_f32_32x32x16_bf16 v[80:95], v[24:27], v[220:223], v[80:95]
    ds_read_b64_tr_b16 v[40:41], v2 offset:22528
    ds_read_b64_tr_b16 v[42:43], v2 offset:23040
    v_rcp_f32 v16, v16
    v_mul_f32 v19, v19, v75
    v_mul_f32 v72, v16, v72
    v_mfma_f32_32x32x16_bf16 v[96:111], v[28:31], v[220:223], v[96:111]
    ds_read_b64_tr_b16 v[44:45], v3 offset:22528
    ds_read_b64_tr_b16 v[46:47], v3 offset:23040
    v_exp_f32 v19, v19
    v_mul_f32 v78, v9, v78
    v_add_f32 v18, 1.0, v18
    v_fma_f32 v21, v77, v77, s63
    v_rcp_f32 v17, v17
    s_waitcnt lgkmcnt(4)
    v_mfma_f32_32x32x16_bf16 v[80:95], v[32:35], v[224:227], v[80:95]
    ds_read_b64_tr_b16 v[24:25], v2 offset:24576
    ds_read_b64_tr_b16 v[26:27], v2 offset:25088
    v_mul_f32 v20, v20, v76
    v_cvt_pk_bf16_f32 v67, v70, v71
    v_mul_f32 v73, v17, v73
    v_mfma_f32_32x32x16_bf16 v[96:111], v[36:39], v[224:227], v[96:111]
    ds_read_b64_tr_b16 v[28:29], v3 offset:24576
    ds_read_b64_tr_b16 v[30:31], v3 offset:25088
    v_exp_f32 v20, v20
    v_mul_f32 v79, v9, v79
    v_add_f32 v19, 1.0, v19
    v_fma_f32 v16, v78, v78, s63
    s_waitcnt lgkmcnt(4)
    v_mfma_f32_32x32x16_bf16 v[80:95], v[40:43], v[228:231], v[80:95]
    ds_read_b64_tr_b16 v[32:33], v2 offset:26624
    ds_read_b64_tr_b16 v[34:35], v2 offset:27136
    v_rcp_f32 v18, v18
    v_mul_f32 v21, v21, v77
    v_mul_f32 v74, v18, v74
    v_exp_f32 v21, v21
    v_mfma_f32_32x32x16_bf16 v[96:111], v[44:47], v[228:231], v[96:111]
    ds_read_b64_tr_b16 v[36:37], v3 offset:26624
    ds_read_b64_tr_b16 v[38:39], v3 offset:27136
    v_add_f32 v20, 1.0, v20
    v_fma_f32 v17, v79, v79, s63
    v_rcp_f32 v19, v19
    v_mul_f32 v16, v16, v78
    s_waitcnt lgkmcnt(4)
    v_mfma_f32_32x32x16_bf16 v[80:95], v[24:27], v[232:235], v[80:95]
    ds_read_b64_tr_b16 v[40:41], v2 offset:28672
    ds_read_b64_tr_b16 v[42:43], v2 offset:29184
    v_cvt_pk_bf16_f32 v72, v72, v73
    v_mul_f32 v75, v19, v75
    v_exp_f32 v16, v16
    v_mfma_f32_32x32x16_bf16 v[96:111], v[28:31], v[232:235], v[96:111]
    ds_read_b64_tr_b16 v[44:45], v3 offset:28672
    ds_read_b64_tr_b16 v[46:47], v3 offset:29184
    v_add_f32 v21, 1.0, v21
    v_rcp_f32 v20, v20
    v_mul_f32 v17, v17, v79
    v_mul_f32 v76, v20, v76
    s_waitcnt lgkmcnt(4)
    v_mfma_f32_32x32x16_bf16 v[80:95], v[32:35], v[236:239], v[80:95]
    ds_read_b64_tr_b16 v[24:25], v2 offset:30720
    ds_read_b64_tr_b16 v[26:27], v2 offset:31232
    s_add_u32 s76, s57, 0
    buffer_store_dwordx4 v[48:51], v6, s[24:27], s76 offen sc1
    v_exp_f32 v17, v17
    v_add_f32 v16, 1.0, v16
    v_mfma_f32_32x32x16_bf16 v[96:111], v[36:39], v[236:239], v[96:111]
    ds_read_b64_tr_b16 v[28:29], v3 offset:30720
    ds_read_b64_tr_b16 v[30:31], v3 offset:31232
    v_rcp_f32 v21, v21
    v_cvt_pk_bf16_f32 v73, v74, v75
    v_mul_f32 v77, v21, v77
    v_add_f32 v17, 1.0, v17
    s_waitcnt lgkmcnt(4)
    v_mfma_f32_32x32x16_bf16 v[80:95], v[40:43], v[240:243], v[80:95]
    ds_read_b64_tr_b16 v[32:33], v2 offset:32768
    ds_read_b64_tr_b16 v[34:35], v2 offset:33280
    s_add_u32 s76, s57, 65536
    buffer_store_dwordx4 v[56:59], v6, s[24:27], s76 offen sc1
    v_rcp_f32 v16, v16
    s_nop 0
    v_mul_f32 v78, v16, v78
    v_mfma_f32_32x32x16_bf16 v[96:111], v[44:47], v[240:243], v[96:111]
    ds_read_b64_tr_b16 v[36:37], v3 offset:32768
    ds_read_b64_tr_b16 v[38:39], v3 offset:33280
    v_rcp_f32 v17, v17
    v_cvt_pk_bf16_f32 v74, v76, v77
    v_mul_f32 v79, v17, v79
    v_cvt_pk_bf16_f32 v75, v78, v79
    s_waitcnt lgkmcnt(4)
    v_mfma_f32_32x32x16_bf16 v[80:95], v[24:27], v[244:247], v[80:95]
    ds_read_b64_tr_b16 v[40:41], v2 offset:34816
    ds_read_b64_tr_b16 v[42:43], v2 offset:35328
    s_add_u32 s76, s57, 131072
    buffer_store_dwordx4 v[64:67], v6, s[24:27], s76 offen sc1
    v_mfma_f32_32x32x16_bf16 v[96:111], v[28:31], v[244:247], v[96:111]
    ds_read_b64_tr_b16 v[44:45], v3 offset:34816
    ds_read_b64_tr_b16 v[46:47], v3 offset:35328
    v_and_b32 v23, s48, v5
    v_xor_b32 v2, v23, v4
    v_add_u32 v2, 73728, v2
    v_xor_b32 v3, 64, v2
    s_waitcnt lgkmcnt(4)
    v_mfma_f32_32x32x16_bf16 v[80:95], v[32:35], v[248:251], v[80:95]
    s_barrier
    ds_read_b64_tr_b16 v[24:25], v2 offset:0
    ds_read_b64_tr_b16 v[26:27], v2 offset:512
    s_add_u32 s76, s57, 196608
    buffer_store_dwordx4 v[72:75], v6, s[24:27], s76 offen sc1
    v_mfma_f32_32x32x16_bf16 v[96:111], v[36:39], v[248:251], v[96:111]
    ds_read_b64_tr_b16 v[28:29], v3 offset:0
    ds_read_b64_tr_b16 v[30:31], v3 offset:512
    s_waitcnt lgkmcnt(4)
    v_mfma_f32_32x32x16_bf16 v[80:95], v[40:43], v[252:255], v[80:95]
    ds_read_b64_tr_b16 v[32:33], v2 offset:2048
    ds_read_b64_tr_b16 v[34:35], v2 offset:2560
    v_mfma_f32_32x32x16_bf16 v[96:111], v[44:47], v[252:255], v[96:111]
    ds_read_b64_tr_b16 v[36:37], v3 offset:2048
    ds_read_b64_tr_b16 v[38:39], v3 offset:2560
.p2align 3
    v_dot2_f32_bf16 v10, v48, s66, v10
    v_dot2_f32_bf16 v11, v48, v48, v11
    v_dot2_f32_bf16 v10, v49, s66, v10
    v_dot2_f32_bf16 v11, v49, v49, v11
    v_dot2_f32_bf16 v10, v50, s66, v10
    v_dot2_f32_bf16 v11, v50, v50, v11
    v_dot2_f32_bf16 v10, v51, s66, v10
    v_dot2_f32_bf16 v11, v51, v51, v11
    v_dot2_f32_bf16 v10, v56, s66, v10
    v_dot2_f32_bf16 v11, v56, v56, v11
    v_dot2_f32_bf16 v10, v57, s66, v10
    v_dot2_f32_bf16 v11, v57, v57, v11
    v_dot2_f32_bf16 v10, v58, s66, v10
    v_dot2_f32_bf16 v11, v58, v58, v11
    v_dot2_f32_bf16 v10, v59, s66, v10
    v_dot2_f32_bf16 v11, v59, v59, v11
    v_dot2_f32_bf16 v10, v64, s66, v10
    v_dot2_f32_bf16 v11, v64, v64, v11
    v_dot2_f32_bf16 v10, v65, s66, v10
    v_dot2_f32_bf16 v11, v65, v65, v11
    v_dot2_f32_bf16 v10, v66, s66, v10
    v_dot2_f32_bf16 v11, v66, v66, v11
    v_dot2_f32_bf16 v10, v67, s66, v10
    v_dot2_f32_bf16 v11, v67, v67, v11
    v_dot2_f32_bf16 v10, v72, s66, v10
    v_dot2_f32_bf16 v11, v72, v72, v11
    v_dot2_f32_bf16 v10, v73, s66, v10
    v_dot2_f32_bf16 v11, v73, v73, v11
    v_dot2_f32_bf16 v10, v74, s66, v10
    v_dot2_f32_bf16 v11, v74, v74, v11
    v_dot2_f32_bf16 v10, v75, s66, v10
    v_dot2_f32_bf16 v11, v75, v75, v11
    s_nop 2
    ds_write_b64 v7, v[10:11]
    s_mov_b32 s57, s58
    s_mov_b32 s58, s59
    s_mov_b32 s45, s46
    s_cmp_lt_u32 s39, 3
    s_cbranch_scc1 recurrent_scan__sliding_local_dilated__mixer_gmlp__prompt_kernel_P1
    s_nop 7
    v_mul_f32 v80, v9, v80
    v_mul_f32 v81, v9, v81
    v_fma_f32 v16, v80, v80, s63
    v_mul_f32 v82, v9, v82
    v_fma_f32 v17, v81, v81, s63
    v_mul_f32 v16, v16, v80
    v_exp_f32 v16, v16
    v_mul_f32 v83, v9, v83
    v_fma_f32 v18, v82, v82, s63
    v_mul_f32 v17, v17, v81
    v_exp_f32 v17, v17
    v_mul_f32 v84, v9, v84
    v_add_f32 v16, 1.0, v16
    v_fma_f32 v19, v83, v83, s63
    v_mul_f32 v18, v18, v82
    v_exp_f32 v18, v18
    v_mul_f32 v85, v9, v85
    v_add_f32 v17, 1.0, v17
    v_fma_f32 v20, v84, v84, s63
    v_rcp_f32 v16, v16
    v_mul_f32 v19, v19, v83
    v_mul_f32 v80, v16, v80
    v_exp_f32 v19, v19
    v_mul_f32 v86, v9, v86
    v_add_f32 v18, 1.0, v18
    v_fma_f32 v21, v85, v85, s63
    v_rcp_f32 v17, v17
    v_mul_f32 v20, v20, v84
    v_mul_f32 v81, v17, v81
    v_exp_f32 v20, v20
    v_mul_f32 v87, v9, v87
    v_add_f32 v19, 1.0, v19
    v_fma_f32 v16, v86, v86, s63
    v_rcp_f32 v18, v18
    v_mul_f32 v21, v21, v85
    v_mul_f32 v82, v18, v82
    v_exp_f32 v21, v21
    v_mul_f32 v88, v9, v88
    v_add_f32 v20, 1.0, v20
    v_fma_f32 v17, v87, v87, s63
    v_rcp_f32 v19, v19
    v_mul_f32 v16, v16, v86
    v_cvt_pk_bf16_f32 v80, v80, v81
    v_mul_f32 v83, v19, v83
    v_exp_f32 v16, v16
    v_mul_f32 v89, v9, v89
    v_add_f32 v21, 1.0, v21
    v_fma_f32 v18, v88, v88, s63
    v_rcp_f32 v20, v20
    v_mul_f32 v17, v17, v87
    v_mul_f32 v84, v20, v84
    v_exp_f32 v17, v17
    v_mul_f32 v90, v9, v90
    v_add_f32 v16, 1.0, v16
    v_fma_f32 v19, v89, v89, s63
    v_rcp_f32 v21, v21
    v_mul_f32 v18, v18, v88
    v_cvt_pk_bf16_f32 v81, v82, v83
    v_mul_f32 v85, v21, v85
    v_exp_f32 v18, v18
    v_mul_f32 v91, v9, v91
    v_add_f32 v17, 1.0, v17
    v_fma_f32 v20, v90, v90, s63
    v_rcp_f32 v16, v16
    v_mul_f32 v19, v19, v89
    v_mul_f32 v86, v16, v86
    v_exp_f32 v19, v19
    v_mul_f32 v92, v9, v92
    v_add_f32 v18, 1.0, v18
    v_fma_f32 v21, v91, v91, s63
    v_rcp_f32 v17, v17
    v_mul_f32 v20, v20, v90
    v_cvt_pk_bf16_f32 v82, v84, v85
    v_mul_f32 v87, v17, v87
    v_exp_f32 v20, v20
    v_mul_f32 v93, v9, v93
    v_add_f32 v19, 1.0, v19
    v_fma_f32 v16, v92, v92, s63
    v_rcp_f32 v18, v18
    v_mul_f32 v21, v21, v91
    v_mul_f32 v88, v18, v88
    v_exp_f32 v21, v21
    v_mul_f32 v94, v9, v94
    v_add_f32 v20, 1.0, v20
    v_fma_f32 v17, v93, v93, s63
    v_rcp_f32 v19, v19
    v_mul_f32 v16, v16, v92
    v_cvt_pk_bf16_f32 v83, v86, v87
    s_add_u32 s76, s57, 0
    buffer_store_dwordx4 v[80:83], v6, s[24:27], s76 offen sc1
    v_mul_f32 v89, v19, v89
    v_exp_f32 v16, v16
    v_mul_f32 v95, v9, v95
    v_add_f32 v21, 1.0, v21
    v_fma_f32 v18, v94, v94, s63
    v_rcp_f32 v20, v20
    v_mul_f32 v17, v17, v93
    v_mul_f32 v90, v20, v90
    v_exp_f32 v17, v17
    v_mul_f32 v96, v9, v96
    v_add_f32 v16, 1.0, v16
    v_fma_f32 v19, v95, v95, s63
    v_rcp_f32 v21, v21
    v_mul_f32 v18, v18, v94
    v_cvt_pk_bf16_f32 v88, v88, v89
    v_mul_f32 v91, v21, v91
    v_exp_f32 v18, v18
    v_mul_f32 v97, v9, v97
    v_add_f32 v17, 1.0, v17
    v_fma_f32 v20, v96, v96, s63
    v_rcp_f32 v16, v16
    v_mul_f32 v19, v19, v95
    v_mul_f32 v92, v16, v92
    v_exp_f32 v19, v19
    v_mul_f32 v98, v9, v98
    v_add_f32 v18, 1.0, v18
    v_fma_f32 v21, v97, v97, s63
    v_rcp_f32 v17, v17
    v_mul_f32 v20, v20, v96
    v_cvt_pk_bf16_f32 v89, v90, v91
    v_mul_f32 v93, v17, v93
    v_exp_f32 v20, v20
    v_mul_f32 v99, v9, v99
    v_add_f32 v19, 1.0, v19
    v_fma_f32 v16, v98, v98, s63
    v_rcp_f32 v18, v18
    v_mul_f32 v21, v21, v97
    v_mul_f32 v94, v18, v94
    v_exp_f32 v21, v21
    v_mul_f32 v100, v9, v100
    v_add_f32 v20, 1.0, v20
    v_fma_f32 v17, v99, v99, s63
    v_rcp_f32 v19, v19
    v_mul_f32 v16, v16, v98
    v_cvt_pk_bf16_f32 v90, v92, v93
    v_mul_f32 v95, v19, v95
    v_exp_f32 v16, v16
    v_mul_f32 v101, v9, v101
    v_add_f32 v21, 1.0, v21
    v_fma_f32 v18, v100, v100, s63
    v_rcp_f32 v20, v20
    v_mul_f32 v17, v17, v99
    v_mul_f32 v96, v20, v96
    v_exp_f32 v17, v17
    v_mul_f32 v102, v9, v102
    v_add_f32 v16, 1.0, v16
    v_fma_f32 v19, v101, v101, s63
    v_rcp_f32 v21, v21
    v_mul_f32 v18, v18, v100
    v_cvt_pk_bf16_f32 v91, v94, v95
    s_add_u32 s76, s57, 65536
    buffer_store_dwordx4 v[88:91], v6, s[24:27], s76 offen sc1
    v_mul_f32 v97, v21, v97
    v_exp_f32 v18, v18
    v_mul_f32 v103, v9, v103
    v_add_f32 v17, 1.0, v17
    v_fma_f32 v20, v102, v102, s63
    v_rcp_f32 v16, v16
    v_mul_f32 v19, v19, v101
    v_mul_f32 v98, v16, v98
    v_exp_f32 v19, v19
    v_mul_f32 v104, v9, v104
    v_add_f32 v18, 1.0, v18
    v_fma_f32 v21, v103, v103, s63
    v_rcp_f32 v17, v17
    v_mul_f32 v20, v20, v102
    v_cvt_pk_bf16_f32 v96, v96, v97
    v_mul_f32 v99, v17, v99
    v_exp_f32 v20, v20
    v_mul_f32 v105, v9, v105
    v_add_f32 v19, 1.0, v19
    v_fma_f32 v16, v104, v104, s63
    v_rcp_f32 v18, v18
    v_mul_f32 v21, v21, v103
    v_mul_f32 v100, v18, v100
    v_exp_f32 v21, v21
    v_mul_f32 v106, v9, v106
    v_add_f32 v20, 1.0, v20
    v_fma_f32 v17, v105, v105, s63
    v_rcp_f32 v19, v19
    v_mul_f32 v16, v16, v104
    v_cvt_pk_bf16_f32 v97, v98, v99
    v_mul_f32 v101, v19, v101
    v_exp_f32 v16, v16
    v_mul_f32 v107, v9, v107
    v_add_f32 v21, 1.0, v21
    v_fma_f32 v18, v106, v106, s63
    v_rcp_f32 v20, v20
    v_mul_f32 v17, v17, v105
    v_mul_f32 v102, v20, v102
    v_exp_f32 v17, v17
    v_mul_f32 v108, v9, v108
    v_add_f32 v16, 1.0, v16
    v_fma_f32 v19, v107, v107, s63
    v_rcp_f32 v21, v21
    v_mul_f32 v18, v18, v106
    v_cvt_pk_bf16_f32 v98, v100, v101
    v_mul_f32 v103, v21, v103
    v_exp_f32 v18, v18
    v_mul_f32 v109, v9, v109
    v_add_f32 v17, 1.0, v17
    v_fma_f32 v20, v108, v108, s63
    v_rcp_f32 v16, v16
    v_mul_f32 v19, v19, v107
    v_mul_f32 v104, v16, v104
    v_exp_f32 v19, v19
    v_mul_f32 v110, v9, v110
    v_add_f32 v18, 1.0, v18
    v_fma_f32 v21, v109, v109, s63
    v_rcp_f32 v17, v17
    v_mul_f32 v20, v20, v108
    v_cvt_pk_bf16_f32 v99, v102, v103
    s_add_u32 s76, s57, 131072
    buffer_store_dwordx4 v[96:99], v6, s[24:27], s76 offen sc1
    v_mul_f32 v105, v17, v105
    v_exp_f32 v20, v20
    v_mul_f32 v111, v9, v111
    v_add_f32 v19, 1.0, v19
    v_fma_f32 v16, v110, v110, s63
    v_rcp_f32 v18, v18
    v_mul_f32 v21, v21, v109
    v_mul_f32 v106, v18, v106
    v_exp_f32 v21, v21
    v_add_f32 v20, 1.0, v20
    v_fma_f32 v17, v111, v111, s63
    v_rcp_f32 v19, v19
    v_mul_f32 v16, v16, v110
    v_cvt_pk_bf16_f32 v104, v104, v105
    v_mul_f32 v107, v19, v107
    v_exp_f32 v16, v16
    v_add_f32 v21, 1.0, v21
    v_rcp_f32 v20, v20
    v_mul_f32 v17, v17, v111
    v_mul_f32 v108, v20, v108
    v_exp_f32 v17, v17
    v_add_f32 v16, 1.0, v16
    v_rcp_f32 v21, v21
    v_cvt_pk_bf16_f32 v105, v106, v107
    v_mul_f32 v109, v21, v109
    v_add_f32 v17, 1.0, v17
    v_rcp_f32 v16, v16
    s_nop 0
    v_mul_f32 v110, v16, v110
    v_rcp_f32 v17, v17
    v_cvt_pk_bf16_f32 v106, v108, v109
    v_mul_f32 v111, v17, v111
    v_cvt_pk_bf16_f32 v107, v110, v111
    s_add_u32 s76, s57, 196608
    buffer_store_dwordx4 v[104:107], v6, s[24:27], s76 offen sc1
.p2align 3
    v_dot2_f32_bf16 v10, v80, s66, v10
    v_dot2_f32_bf16 v11, v80, v80, v11
    v_dot2_f32_bf16 v10, v81, s66, v10
    v_dot2_f32_bf16 v11, v81, v81, v11
    v_dot2_f32_bf16 v10, v82, s66, v10
    v_dot2_f32_bf16 v11, v82, v82, v11
    v_dot2_f32_bf16 v10, v83, s66, v10
    v_dot2_f32_bf16 v11, v83, v83, v11
    v_dot2_f32_bf16 v10, v88, s66, v10
    v_dot2_f32_bf16 v11, v88, v88, v11
    v_dot2_f32_bf16 v10, v89, s66, v10
    v_dot2_f32_bf16 v11, v89, v89, v11
    v_dot2_f32_bf16 v10, v90, s66, v10
    v_dot2_f32_bf16 v11, v90, v90, v11
    v_dot2_f32_bf16 v10, v91, s66, v10
    v_dot2_f32_bf16 v11, v91, v91, v11
    v_dot2_f32_bf16 v10, v96, s66, v10
    v_dot2_f32_bf16 v11, v96, v96, v11
    v_dot2_f32_bf16 v10, v97, s66, v10
    v_dot2_f32_bf16 v11, v97, v97, v11
    v_dot2_f32_bf16 v10, v98, s66, v10
    v_dot2_f32_bf16 v11, v98, v98, v11
    v_dot2_f32_bf16 v10, v99, s66, v10
    v_dot2_f32_bf16 v11, v99, v99, v11
    v_dot2_f32_bf16 v10, v104, s66, v10
    v_dot2_f32_bf16 v11, v104, v104, v11
    v_dot2_f32_bf16 v10, v105, s66, v10
    v_dot2_f32_bf16 v11, v105, v105, v11
    v_dot2_f32_bf16 v10, v106, s66, v10
    v_dot2_f32_bf16 v11, v106, v106, v11
    v_dot2_f32_bf16 v10, v107, s66, v10
    v_dot2_f32_bf16 v11, v107, v107, v11
    s_nop 2
    ds_write_b64 v7, v[10:11]
    s_waitcnt lgkmcnt(0)
recurrent_scan__sliding_local_dilated__mixer_gmlp__prompt_kernel_N1:
    s_waitcnt lgkmcnt(4)
    v_mfma_f32_32x32x16_bf16 v[48:63], v[24:27], v[112:115], 0
    s_add_u32 s46, s45, 1
    ds_read_b64_tr_b16 v[40:41], v2 offset:4096
    ds_read_b64_tr_b16 v[42:43], v2 offset:4608
    v_mfma_f32_32x32x16_bf16 v[64:79], v[28:31], v[112:115], 0
    ds_read_b64_tr_b16 v[44:45], v3 offset:4096
    ds_read_b64_tr_b16 v[46:47], v3 offset:4608
    s_add_u32 s72, s42, s46
    s_waitcnt lgkmcnt(4)
    v_mfma_f32_32x32x16_bf16 v[48:63], v[32:35], v[116:119], v[48:63]
    s_barrier
    ds_read_b64_tr_b16 v[24:25], v2 offset:6144
    ds_read_b64_tr_b16 v[26:27], v2 offset:6656
    v_mfma_f32_32x32x16_bf16 v[64:79], v[36:39], v[116:119], v[64:79]
    ds_read_b64_tr_b16 v[28:29], v3 offset:6144
    ds_read_b64_tr_b16 v[30:31], v3 offset:6656
    s_waitcnt lgkmcnt(4)
    v_mfma_f32_32x32x16_bf16 v[48:63], v[40:43], v[120:123], v[48:63]
    ds_read_b64_tr_b16 v[32:33], v2 offset:8192
    ds_read_b64_tr_b16 v[34:35], v2 offset:8704
    s_add_u32 s74, s44, s46
    v_mfma_f32_32x32x16_bf16 v[64:79], v[44:47], v[120:123], v[64:79]
    ds_read_b64_tr_b16 v[36:37], v3 offset:8192
    ds_read_b64_tr_b16 v[38:39], v3 offset:8704
    s_waitcnt lgkmcnt(4)
    v_mfma_f32_32x32x16_bf16 v[48:63], v[24:27], v[124:127], v[48:63]
    ds_read_b64_tr_b16 v[40:41], v2 offset:10240
    ds_read_b64_tr_b16 v[42:43], v2 offset:10752
    v_mfma_f32_32x32x16_bf16 v[64:79], v[28:31], v[124:127], v[64:79]
    ds_read_b64_tr_b16 v[44:45], v3 offset:10240
    ds_read_b64_tr_b16 v[46:47], v3 offset:10752
    s_min_u32 s74, s74, 26
    s_waitcnt lgkmcnt(4)
    v_mfma_f32_32x32x16_bf16 v[48:63], v[32:35], v[128:131], v[48:63]
    ds_read_b64_tr_b16 v[24:25], v2 offset:12288
    ds_read_b64_tr_b16 v[26:27], v2 offset:12800
    v_mfma_f32_32x32x16_bf16 v[64:79], v[36:39], v[128:131], v[64:79]
    ds_read_b64_tr_b16 v[28:29], v3 offset:12288
    ds_read_b64_tr_b16 v[30:31], v3 offset:12800
    s_waitcnt lgkmcnt(4)
    v_mfma_f32_32x32x16_bf16 v[48:63], v[40:43], v[132:135], v[48:63]
    ds_read_b64_tr_b16 v[32:33], v2 offset:14336
    ds_read_b64_tr_b16 v[34:35], v2 offset:14848
    s_add_u32 s74, s74, 72
    v_mfma_f32_32x32x16_bf16 v[64:79], v[44:47], v[132:135], v[64:79]
    ds_read_b64_tr_b16 v[36:37], v3 offset:14336
    ds_read_b64_tr_b16 v[38:39], v3 offset:14848
    s_waitcnt lgkmcnt(4)
    v_mfma_f32_32x32x16_bf16 v[48:63], v[24:27], v[136:139], v[48:63]
    ds_read_b64_tr_b16 v[40:41], v2 offset:16384
    ds_read_b64_tr_b16 v[42:43], v2 offset:16896
    v_mfma_f32_32x32x16_bf16 v[64:79], v[28:31], v[136:139], v[64:79]
    ds_read_b64_tr_b16 v[44:45], v3 offset:16384
    ds_read_b64_tr_b16 v[46:47], v3 offset:16896
    s_cmp_lt_u32 s46, s39
    s_cselect_b32 s47, s72, s74
    s_cselect_b32 s48, -1, 0
    s_waitcnt lgkmcnt(4)
    v_mfma_f32_32x32x16_bf16 v[48:63], v[32:35], v[140:143], v[48:63]
    ds_read_b64_tr_b16 v[24:25], v2 offset:18432
    ds_read_b64_tr_b16 v[26:27], v2 offset:18944
    v_mfma_f32_32x32x16_bf16 v[64:79], v[36:39], v[140:143], v[64:79]
    ds_read_b64_tr_b16 v[28:29], v3 offset:18432
    ds_read_b64_tr_b16 v[30:31], v3 offset:18944
    s_waitcnt lgkmcnt(4)
    v_mfma_f32_32x32x16_bf16 v[48:63], v[40:43], v[144:147], v[48:63]
    ds_read_b64_tr_b16 v[32:33], v2 offset:20480
    ds_read_b64_tr_b16 v[34:35], v2 offset:20992
    s_lshl_b32 s59, s47, 18
    v_mfma_f32_32x32x16_bf16 v[64:79], v[44:47], v[144:147], v[64:79]
    ds_read_b64_tr_b16 v[36:37], v3 offset:20480
    ds_read_b64_tr_b16 v[38:39], v3 offset:20992
    s_waitcnt lgkmcnt(4)
    v_mfma_f32_32x32x16_bf16 v[48:63], v[24:27], v[148:151], v[48:63]
    ds_read_b64_tr_b16 v[40:41], v2 offset:22528
    ds_read_b64_tr_b16 v[42:43], v2 offset:23040
    v_mfma_f32_32x32x16_bf16 v[64:79], v[28:31], v[148:151], v[64:79]
    ds_read_b64_tr_b16 v[44:45], v3 offset:22528
    ds_read_b64_tr_b16 v[46:47], v3 offset:23040
    s_waitcnt lgkmcnt(4)
    v_mfma_f32_32x32x16_bf16 v[48:63], v[32:35], v[152:155], v[48:63]
    ds_read_b64_tr_b16 v[24:25], v2 offset:24576
    ds_read_b64_tr_b16 v[26:27], v2 offset:25088
    v_mfma_f32_32x32x16_bf16 v[64:79], v[36:39], v[152:155], v[64:79]
    ds_read_b64_tr_b16 v[28:29], v3 offset:24576
    ds_read_b64_tr_b16 v[30:31], v3 offset:25088
    s_waitcnt lgkmcnt(4)
    v_mfma_f32_32x32x16_bf16 v[48:63], v[40:43], v[156:159], v[48:63]
    ds_read_b64_tr_b16 v[32:33], v2 offset:26624
    ds_read_b64_tr_b16 v[34:35], v2 offset:27136
    v_mfma_f32_32x32x16_bf16 v[64:79], v[44:47], v[156:159], v[64:79]
    ds_read_b64_tr_b16 v[36:37], v3 offset:26624
    ds_read_b64_tr_b16 v[38:39], v3 offset:27136
    s_waitcnt lgkmcnt(4)
    v_mfma_f32_32x32x16_bf16 v[48:63], v[24:27], v[160:163], v[48:63]
    ds_read_b64_tr_b16 v[40:41], v2 offset:28672
    ds_read_b64_tr_b16 v[42:43], v2 offset:29184
    v_mfma_f32_32x32x16_bf16 v[64:79], v[28:31], v[160:163], v[64:79]
    ds_read_b64_tr_b16 v[44:45], v3 offset:28672
    ds_read_b64_tr_b16 v[46:47], v3 offset:29184
    s_waitcnt lgkmcnt(4)
    v_mfma_f32_32x32x16_bf16 v[48:63], v[32:35], v[164:167], v[48:63]
    ds_read_b64_tr_b16 v[24:25], v2 offset:30720
    ds_read_b64_tr_b16 v[26:27], v2 offset:31232
    v_mfma_f32_32x32x16_bf16 v[64:79], v[36:39], v[164:167], v[64:79]
    ds_read_b64_tr_b16 v[28:29], v3 offset:30720
    ds_read_b64_tr_b16 v[30:31], v3 offset:31232
    s_waitcnt lgkmcnt(4)
    v_mfma_f32_32x32x16_bf16 v[48:63], v[40:43], v[168:171], v[48:63]
    ds_read_b64_tr_b16 v[32:33], v2 offset:32768
    ds_read_b64_tr_b16 v[34:35], v2 offset:33280
    v_mfma_f32_32x32x16_bf16 v[64:79], v[44:47], v[168:171], v[64:79]
    ds_read_b64_tr_b16 v[36:37], v3 offset:32768
    ds_read_b64_tr_b16 v[38:39], v3 offset:33280
    s_waitcnt lgkmcnt(4)
    v_mfma_f32_32x32x16_bf16 v[48:63], v[24:27], v[172:175], v[48:63]
    ds_read_b64_tr_b16 v[40:41], v2 offset:34816
    ds_read_b64_tr_b16 v[42:43], v2 offset:35328
    v_mfma_f32_32x32x16_bf16 v[64:79], v[28:31], v[172:175], v[64:79]
    ds_read_b64_tr_b16 v[44:45], v3 offset:34816
    ds_read_b64_tr_b16 v[46:47], v3 offset:35328
    s_waitcnt lgkmcnt(4)
    v_mfma_f32_32x32x16_bf16 v[48:63], v[32:35], v[176:179], v[48:63]
    v_add_u32 v2, 36864, v2
    v_add_u32 v3, 36864, v3
    ds_read_b64_tr_b16 v[24:25], v2 offset:0
    ds_read_b64_tr_b16 v[26:27], v2 offset:512
    v_mfma_f32_32x32x16_bf16 v[64:79], v[36:39], v[176:179], v[64:79]
    ds_read_b64_tr_b16 v[28:29], v3 offset:0
    ds_read_b64_tr_b16 v[30:31], v3 offset:512
    s_waitcnt lgkmcnt(4)
    v_mfma_f32_32x32x16_bf16 v[48:63], v[40:43], v[180:183], v[48:63]
    ds_read_b64_tr_b16 v[32:33], v2 offset:2048
    ds_read_b64_tr_b16 v[34:35], v2 offset:2560
    v_mfma_f32_32x32x16_bf16 v[64:79], v[44:47], v[180:183], v[64:79]
    ds_read_b64_tr_b16 v[36:37], v3 offset:2048
    ds_read_b64_tr_b16 v[38:39], v3 offset:2560
    s_waitcnt lgkmcnt(4)
    v_mfma_f32_32x32x16_bf16 v[48:63], v[24:27], v[184:187], v[48:63]
    ds_read_b64_tr_b16 v[40:41], v2 offset:4096
    ds_read_b64_tr_b16 v[42:43], v2 offset:4608
    v_mfma_f32_32x32x16_bf16 v[64:79], v[28:31], v[184:187], v[64:79]
    ds_read_b64_tr_b16 v[44:45], v3 offset:4096
    ds_read_b64_tr_b16 v[46:47], v3 offset:4608
    s_waitcnt lgkmcnt(4)
    v_mfma_f32_32x32x16_bf16 v[48:63], v[32:35], v[188:191], v[48:63]
    ds_read_b64_tr_b16 v[24:25], v2 offset:6144
    ds_read_b64_tr_b16 v[26:27], v2 offset:6656
    v_mfma_f32_32x32x16_bf16 v[64:79], v[36:39], v[188:191], v[64:79]
    ds_read_b64_tr_b16 v[28:29], v3 offset:6144
    ds_read_b64_tr_b16 v[30:31], v3 offset:6656
    s_waitcnt lgkmcnt(4)
    v_mfma_f32_32x32x16_bf16 v[48:63], v[40:43], v[192:195], v[48:63]
    ds_read_b64_tr_b16 v[32:33], v2 offset:8192
    ds_read_b64_tr_b16 v[34:35], v2 offset:8704
    v_mfma_f32_32x32x16_bf16 v[64:79], v[44:47], v[192:195], v[64:79]
    ds_read_b64_tr_b16 v[36:37], v3 offset:8192
    ds_read_b64_tr_b16 v[38:39], v3 offset:8704
    s_waitcnt lgkmcnt(4)
    v_mfma_f32_32x32x16_bf16 v[48:63], v[24:27], v[196:199], v[48:63]
    ds_read_b64_tr_b16 v[40:41], v2 offset:10240
    ds_read_b64_tr_b16 v[42:43], v2 offset:10752
    v_mfma_f32_32x32x16_bf16 v[64:79], v[28:31], v[196:199], v[64:79]
    ds_read_b64_tr_b16 v[44:45], v3 offset:10240
    ds_read_b64_tr_b16 v[46:47], v3 offset:10752
    s_waitcnt lgkmcnt(4)
    v_mfma_f32_32x32x16_bf16 v[48:63], v[32:35], v[200:203], v[48:63]
    ds_read_b64_tr_b16 v[24:25], v2 offset:12288
    ds_read_b64_tr_b16 v[26:27], v2 offset:12800
    v_mfma_f32_32x32x16_bf16 v[64:79], v[36:39], v[200:203], v[64:79]
    ds_read_b64_tr_b16 v[28:29], v3 offset:12288
    ds_read_b64_tr_b16 v[30:31], v3 offset:12800
    s_waitcnt lgkmcnt(4)
    v_mfma_f32_32x32x16_bf16 v[48:63], v[40:43], v[204:207], v[48:63]
    ds_read_b64_tr_b16 v[32:33], v2 offset:14336
    ds_read_b64_tr_b16 v[34:35], v2 offset:14848
    v_mfma_f32_32x32x16_bf16 v[64:79], v[44:47], v[204:207], v[64:79]
    ds_read_b64_tr_b16 v[36:37], v3 offset:14336
    ds_read_b64_tr_b16 v[38:39], v3 offset:14848
    s_waitcnt lgkmcnt(4)
    v_mfma_f32_32x32x16_bf16 v[48:63], v[24:27], v[208:211], v[48:63]
    ds_read_b64_tr_b16 v[40:41], v2 offset:16384
    ds_read_b64_tr_b16 v[42:43], v2 offset:16896
    v_mfma_f32_32x32x16_bf16 v[64:79], v[28:31], v[208:211], v[64:79]
    ds_read_b64_tr_b16 v[44:45], v3 offset:16384
    ds_read_b64_tr_b16 v[46:47], v3 offset:16896
    s_waitcnt lgkmcnt(4)
    v_mfma_f32_32x32x16_bf16 v[48:63], v[32:35], v[212:215], v[48:63]
    ds_read_b64_tr_b16 v[24:25], v2 offset:18432
    ds_read_b64_tr_b16 v[26:27], v2 offset:18944
    v_mfma_f32_32x32x16_bf16 v[64:79], v[36:39], v[212:215], v[64:79]
    ds_read_b64_tr_b16 v[28:29], v3 offset:18432
    ds_read_b64_tr_b16 v[30:31], v3 offset:18944
    s_waitcnt lgkmcnt(4)
    v_mfma_f32_32x32x16_bf16 v[48:63], v[40:43], v[216:219], v[48:63]
    ds_read_b64_tr_b16 v[32:33], v2 offset:20480
    ds_read_b64_tr_b16 v[34:35], v2 offset:20992
    v_mfma_f32_32x32x16_bf16 v[64:79], v[44:47], v[216:219], v[64:79]
    ds_read_b64_tr_b16 v[36:37], v3 offset:20480
    ds_read_b64_tr_b16 v[38:39], v3 offset:20992
    s_waitcnt lgkmcnt(4)
    v_mfma_f32_32x32x16_bf16 v[48:63], v[24:27], v[220:223], v[48:63]
    ds_read_b64_tr_b16 v[40:41], v2 offset:22528
    ds_read_b64_tr_b16 v[42:43], v2 offset:23040
    v_mfma_f32_32x32x16_bf16 v[64:79], v[28:31], v[220:223], v[64:79]
    ds_read_b64_tr_b16 v[44:45], v3 offset:22528
    ds_read_b64_tr_b16 v[46:47], v3 offset:23040
    s_waitcnt lgkmcnt(4)
    v_mfma_f32_32x32x16_bf16 v[48:63], v[32:35], v[224:227], v[48:63]
    ds_read_b64_tr_b16 v[24:25], v2 offset:24576
    ds_read_b64_tr_b16 v[26:27], v2 offset:25088
    v_mfma_f32_32x32x16_bf16 v[64:79], v[36:39], v[224:227], v[64:79]
    ds_read_b64_tr_b16 v[28:29], v3 offset:24576
    ds_read_b64_tr_b16 v[30:31], v3 offset:25088
    s_waitcnt lgkmcnt(4)
    v_mfma_f32_32x32x16_bf16 v[48:63], v[40:43], v[228:231], v[48:63]
    ds_read_b64_tr_b16 v[32:33], v2 offset:26624
    ds_read_b64_tr_b16 v[34:35], v2 offset:27136
    v_mfma_f32_32x32x16_bf16 v[64:79], v[44:47], v[228:231], v[64:79]
    ds_read_b64_tr_b16 v[36:37], v3 offset:26624
    ds_read_b64_tr_b16 v[38:39], v3 offset:27136
    s_waitcnt lgkmcnt(4)
    v_mfma_f32_32x32x16_bf16 v[48:63], v[24:27], v[232:235], v[48:63]
    ds_read_b64_tr_b16 v[40:41], v2 offset:28672
    ds_read_b64_tr_b16 v[42:43], v2 offset:29184
    v_mfma_f32_32x32x16_bf16 v[64:79], v[28:31], v[232:235], v[64:79]
    ds_read_b64_tr_b16 v[44:45], v3 offset:28672
    ds_read_b64_tr_b16 v[46:47], v3 offset:29184
    s_waitcnt lgkmcnt(4)
    v_mfma_f32_32x32x16_bf16 v[48:63], v[32:35], v[236:239], v[48:63]
    ds_read_b64_tr_b16 v[24:25], v2 offset:30720
    ds_read_b64_tr_b16 v[26:27], v2 offset:31232
    v_mfma_f32_32x32x16_bf16 v[64:79], v[36:39], v[236:239], v[64:79]
    ds_read_b64_tr_b16 v[28:29], v3 offset:30720
    ds_read_b64_tr_b16 v[30:31], v3 offset:31232
    s_waitcnt lgkmcnt(4)
    v_mfma_f32_32x32x16_bf16 v[48:63], v[40:43], v[240:243], v[48:63]
    ds_read_b64_tr_b16 v[32:33], v2 offset:32768
    ds_read_b64_tr_b16 v[34:35], v2 offset:33280
    v_mfma_f32_32x32x16_bf16 v[64:79], v[44:47], v[240:243], v[64:79]
    ds_read_b64_tr_b16 v[36:37], v3 offset:32768
    ds_read_b64_tr_b16 v[38:39], v3 offset:33280
    s_waitcnt lgkmcnt(4)
    v_mfma_f32_32x32x16_bf16 v[48:63], v[24:27], v[244:247], v[48:63]
    ds_read_b64_tr_b16 v[40:41], v2 offset:34816
    ds_read_b64_tr_b16 v[42:43], v2 offset:35328
    v_mfma_f32_32x32x16_bf16 v[64:79], v[28:31], v[244:247], v[64:79]
    ds_read_b64_tr_b16 v[44:45], v3 offset:34816
    ds_read_b64_tr_b16 v[46:47], v3 offset:35328
    v_and_b32 v23, s48, v5
    v_xor_b32 v2, v23, v4
    v_xor_b32 v3, 64, v2
    s_waitcnt lgkmcnt(4)
    v_mfma_f32_32x32x16_bf16 v[48:63], v[32:35], v[248:251], v[48:63]
    s_barrier
    ds_read_b64_tr_b16 v[24:25], v2 offset:0
    ds_read_b64_tr_b16 v[26:27], v2 offset:512
    v_mfma_f32_32x32x16_bf16 v[64:79], v[36:39], v[248:251], v[64:79]
    ds_read_b64_tr_b16 v[28:29], v3 offset:0
    ds_read_b64_tr_b16 v[30:31], v3 offset:512
    s_waitcnt lgkmcnt(4)
    v_mfma_f32_32x32x16_bf16 v[48:63], v[40:43], v[252:255], v[48:63]
    ds_read_b64_tr_b16 v[32:33], v2 offset:2048
    ds_read_b64_tr_b16 v[34:35], v2 offset:2560
    v_mfma_f32_32x32x16_bf16 v[64:79], v[44:47], v[252:255], v[64:79]
    ds_read_b64_tr_b16 v[36:37], v3 offset:2048
    ds_read_b64_tr_b16 v[38:39], v3 offset:2560
    s_mov_b32 s57, s58
    s_mov_b32 s58, s59
    s_mov_b32 s45, s46
    s_branch recurrent_scan__sliding_local_dilated__mixer_gmlp__prompt_kernel_P0
recurrent_scan__sliding_local_dilated__mixer_gmlp__prompt_kernel_P1:
    s_waitcnt lgkmcnt(4)
    v_mfma_f32_32x32x16_bf16 v[48:63], v[24:27], v[112:115], 0
    s_add_u32 s46, s45, 1
    ds_read_b64_tr_b16 v[40:41], v2 offset:4096
    ds_read_b64_tr_b16 v[42:43], v2 offset:4608
    v_mfma_f32_32x32x16_bf16 v[64:79], v[28:31], v[112:115], 0
    ds_read_b64_tr_b16 v[44:45], v3 offset:4096
    ds_read_b64_tr_b16 v[46:47], v3 offset:4608
    s_add_u32 s72, s42, s46
    s_add_u32 s74, s44, s46
    s_min_u32 s74, s74, 26
    s_waitcnt lgkmcnt(4)
    v_mfma_f32_32x32x16_bf16 v[48:63], v[32:35], v[116:119], v[48:63]
    s_barrier
    ds_read_b64_tr_b16 v[24:25], v2 offset:6144
    ds_read_b64_tr_b16 v[26:27], v2 offset:6656
    s_add_u32 s74, s74, 72
    v_mfma_f32_32x32x16_bf16 v[64:79], v[36:39], v[116:119], v[64:79]
    ds_read_b64_tr_b16 v[28:29], v3 offset:6144
    ds_read_b64_tr_b16 v[30:31], v3 offset:6656
    s_cmp_lt_u32 s46, s39
    s_cselect_b32 s47, s72, s74
    s_cselect_b32 s48, -1, 0
    s_waitcnt lgkmcnt(4)
    v_mfma_f32_32x32x16_bf16 v[48:63], v[40:43], v[120:123], v[48:63]
    ds_read_b64_tr_b16 v[32:33], v2 offset:8192
    ds_read_b64_tr_b16 v[34:35], v2 offset:8704
    s_lshl_b32 s59, s47, 18
    v_mul_f32 v80, v9, v80
    v_mfma_f32_32x32x16_bf16 v[64:79], v[44:47], v[120:123], v[64:79]
    ds_read_b64_tr_b16 v[36:37], v3 offset:8192
    ds_read_b64_tr_b16 v[38:39], v3 offset:8704
    v_mul_f32 v81, v9, v81
    v_mul_f32 v82, v9, v82
    v_mul_f32 v83, v9, v83
    s_waitcnt lgkmcnt(4)
    v_mfma_f32_32x32x16_bf16 v[48:63], v[24:27], v[124:127], v[48:63]
    ds_read_b64_tr_b16 v[40:41], v2 offset:10240
    ds_read_b64_tr_b16 v[42:43], v2 offset:10752
    v_cvt_pk_bf16_f32 v80, v80, v81
    v_mul_f32 v84, v9, v84
    v_mfma_f32_32x32x16_bf16 v[64:79], v[28:31], v[124:127], v[64:79]
    ds_read_b64_tr_b16 v[44:45], v3 offset:10240
    ds_read_b64_tr_b16 v[46:47], v3 offset:10752
    v_mul_f32 v85, v9, v85
    v_cvt_pk_bf16_f32 v81, v82, v83
    v_mul_f32 v86, v9, v86
    s_waitcnt lgkmcnt(4)
    v_mfma_f32_32x32x16_bf16 v[48:63], v[32:35], v[128:131], v[48:63]
    ds_read_b64_tr_b16 v[24:25], v2 offset:12288
    ds_read_b64_tr_b16 v[26:27], v2 offset:12800
    v_mul_f32 v87, v9, v87
    v_cvt_pk_bf16_f32 v82, v84, v85
    v_mfma_f32_32x32x16_bf16 v[64:79], v[36:39], v[128:131], v[64:79]
    ds_read_b64_tr_b16 v[28:29], v3 offset:12288
    ds_read_b64_tr_b16 v[30:31], v3 offset:12800
    v_mul_f32 v88, v9, v88
    v_mul_f32 v89, v9, v89
    v_cvt_pk_bf16_f32 v83, v86, v87
    s_waitcnt lgkmcnt(4)
    v_mfma_f32_32x32x16_bf16 v[48:63], v[40:43], v[132:135], v[48:63]
    ds_read_b64_tr_b16 v[32:33], v2 offset:14336
    ds_read_b64_tr_b16 v[34:35], v2 offset:14848
    v_mul_f32 v90, v9, v90
    v_mul_f32 v91, v9, v91
    v_mfma_f32_32x32x16_bf16 v[64:79], v[44:47], v[132:135], v[64:79]
    ds_read_b64_tr_b16 v[36:37], v3 offset:14336
    ds_read_b64_tr_b16 v[38:39], v3 offset:14848
    v_cvt_pk_bf16_f32 v88, v88, v89
    v_mul_f32 v92, v9, v92
    v_mul_f32 v93, v9, v93
    s_waitcnt lgkmcnt(4)
    v_mfma_f32_32x32x16_bf16 v[48:63], v[24:27], v[136:139], v[48:63]
    ds_read_b64_tr_b16 v[40:41], v2 offset:16384
    ds_read_b64_tr_b16 v[42:43], v2 offset:16896
    v_cvt_pk_bf16_f32 v89, v90, v91
    v_mfma_f32_32x32x16_bf16 v[64:79], v[28:31], v[136:139], v[64:79]
    ds_read_b64_tr_b16 v[44:45], v3 offset:16384
    ds_read_b64_tr_b16 v[46:47], v3 offset:16896
    v_mul_f32 v94, v9, v94
    v_mul_f32 v95, v9, v95
    v_cvt_pk_bf16_f32 v90, v92, v93
    s_waitcnt lgkmcnt(4)
    v_mfma_f32_32x32x16_bf16 v[48:63], v[32:35], v[140:143], v[48:63]
    ds_read_b64_tr_b16 v[24:25], v2 offset:18432
    ds_read_b64_tr_b16 v[26:27], v2 offset:18944
    v_mul_f32 v96, v9, v96
    v_mul_f32 v97, v9, v97
    v_mfma_f32_32x32x16_bf16 v[64:79], v[36:39], v[140:143], v[64:79]
    ds_read_b64_tr_b16 v[28:29], v3 offset:18432
    ds_read_b64_tr_b16 v[30:31], v3 offset:18944
    v_cvt_pk_bf16_f32 v91, v94, v95
    v_mul_f32 v98, v9, v98
    v_mul_f32 v99, v9, v99
    s_waitcnt lgkmcnt(4)
    v_mfma_f32_32x32x16_bf16 v[48:63], v[40:43], v[144:147], v[48:63]
    ds_read_b64_tr_b16 v[32:33], v2 offset:20480
    ds_read_b64_tr_b16 v[34:35], v2 offset:20992
    v_cvt_pk_bf16_f32 v96, v96, v97
    v_mul_f32 v100, v9, v100
    v_mfma_f32_32x32x16_bf16 v[64:79], v[44:47], v[144:147], v[64:79]
    ds_read_b64_tr_b16 v[36:37], v3 offset:20480
    ds_read_b64_tr_b16 v[38:39], v3 offset:20992
    v_mul_f32 v101, v9, v101
    v_cvt_pk_bf16_f32 v97, v98, v99
    v_mul_f32 v102, v9, v102
    s_waitcnt lgkmcnt(4)
    v_mfma_f32_32x32x16_bf16 v[48:63], v[24:27], v[148:151], v[48:63]
    ds_read_b64_tr_b16 v[40:41], v2 offset:22528
    ds_read_b64_tr_b16 v[42:43], v2 offset:23040
    v_mul_f32 v103, v9, v103
    v_cvt_pk_bf16_f32 v98, v100, v101
    v_mfma_f32_32x32x16_bf16 v[64:79], v[28:31], v[148:151], v[64:79]
    ds_read_b64_tr_b16 v[44:45], v3 offset:22528
    ds_read_b64_tr_b16 v[46:47], v3 offset:23040
    v_mul_f32 v104, v9, v104
    v_mul_f32 v105, v9, v105
    v_cvt_pk_bf16_f32 v99, v102, v103
    s_waitcnt lgkmcnt(4)
    v_mfma_f32_32x32x16_bf16 v[48:63], v[32:35], v[152:155], v[48:63]
    ds_read_b64_tr_b16 v[24:25], v2 offset:24576
    ds_read_b64_tr_b16 v[26:27], v2 offset:25088
    v_mul_f32 v106, v9, v106
    v_mul_f32 v107, v9, v107
    v_mfma_f32_32x32x16_bf16 v[64:79], v[36:39], v[152:155], v[64:79]
    ds_read_b64_tr_b16 v[28:29], v3 offset:24576
    ds_read_b64_tr_b16 v[30:31], v3 offset:25088
    v_cvt_pk_bf16_f32 v104, v104, v105
    v_mul_f32 v108, v9, v108
    v_mul_f32 v109, v9, v109
    s_waitcnt lgkmcnt(4)
    v_mfma_f32_32x32x16_bf16 v[48:63], v[40:43], v[156:159], v[48:63]
    ds_read_b64_tr_b16 v[32:33], v2 offset:26624
    ds_read_b64_tr_b16 v[34:35], v2 offset:27136
    v_cvt_pk_bf16_f32 v105, v106, v107
    v_mul_f32 v110, v9, v110
    v_mfma_f32_32x32x16_bf16 v[64:79], v[44:47], v[156:159], v[64:79]
    ds_read_b64_tr_b16 v[36:37], v3 offset:26624
    ds_read_b64_tr_b16 v[38:39], v3 offset:27136
    v_mul_f32 v111, v9, v111
    v_cvt_pk_bf16_f32 v106, v108, v109
    v_cvt_pk_bf16_f32 v107, v110, v111
    s_waitcnt lgkmcnt(4)
    v_mfma_f32_32x32x16_bf16 v[48:63], v[24:27], v[160:163], v[48:63]
    ds_read_b64_tr_b16 v[40:41], v2 offset:28672
    ds_read_b64_tr_b16 v[42:43], v2 offset:29184
    v_mfma_f32_32x32x16_bf16 v[64:79], v[28:31], v[160:163], v[64:79]
    ds_read_b64_tr_b16 v[44:45], v3 offset:28672
    ds_read_b64_tr_b16 v[46:47], v3 offset:29184
    s_waitcnt lgkmcnt(4)
    v_mfma_f32_32x32x16_bf16 v[48:63], v[32:35], v[164:167], v[48:63]
    ds_read_b64_tr_b16 v[24:25], v2 offset:30720
    ds_read_b64_tr_b16 v[26:27], v2 offset:31232
    v_mfma_f32_32x32x16_bf16 v[64:79], v[36:39], v[164:167], v[64:79]
    ds_read_b64_tr_b16 v[28:29], v3 offset:30720
    ds_read_b64_tr_b16 v[30:31], v3 offset:31232
    s_waitcnt lgkmcnt(4)
    v_mfma_f32_32x32x16_bf16 v[48:63], v[40:43], v[168:171], v[48:63]
    ds_read_b64_tr_b16 v[32:33], v2 offset:32768
    ds_read_b64_tr_b16 v[34:35], v2 offset:33280
    v_mfma_f32_32x32x16_bf16 v[64:79], v[44:47], v[168:171], v[64:79]
    ds_read_b64_tr_b16 v[36:37], v3 offset:32768
    ds_read_b64_tr_b16 v[38:39], v3 offset:33280
    s_waitcnt lgkmcnt(4)
    v_mfma_f32_32x32x16_bf16 v[48:63], v[24:27], v[172:175], v[48:63]
    ds_read_b64_tr_b16 v[40:41], v2 offset:34816
    ds_read_b64_tr_b16 v[42:43], v2 offset:35328
    v_mfma_f32_32x32x16_bf16 v[64:79], v[28:31], v[172:175], v[64:79]
    ds_read_b64_tr_b16 v[44:45], v3 offset:34816
    ds_read_b64_tr_b16 v[46:47], v3 offset:35328
    s_waitcnt lgkmcnt(4)
    v_mfma_f32_32x32x16_bf16 v[48:63], v[32:35], v[176:179], v[48:63]
    v_add_u32 v2, 36864, v2
    v_add_u32 v3, 36864, v3
    ds_read_b64_tr_b16 v[24:25], v2 offset:0
    ds_read_b64_tr_b16 v[26:27], v2 offset:512
    v_mfma_f32_32x32x16_bf16 v[64:79], v[36:39], v[176:179], v[64:79]
    ds_read_b64_tr_b16 v[28:29], v3 offset:0
    ds_read_b64_tr_b16 v[30:31], v3 offset:512
    s_waitcnt lgkmcnt(4)
    v_mfma_f32_32x32x16_bf16 v[48:63], v[40:43], v[180:183], v[48:63]
    ds_read_b64_tr_b16 v[32:33], v2 offset:2048
    ds_read_b64_tr_b16 v[34:35], v2 offset:2560
    v_mfma_f32_32x32x16_bf16 v[64:79], v[44:47], v[180:183], v[64:79]
    ds_read_b64_tr_b16 v[36:37], v3 offset:2048
    ds_read_b64_tr_b16 v[38:39], v3 offset:2560
    s_waitcnt lgkmcnt(4)
    v_mfma_f32_32x32x16_bf16 v[48:63], v[24:27], v[184:187], v[48:63]
    ds_read_b64_tr_b16 v[40:41], v2 offset:4096
    ds_read_b64_tr_b16 v[42:43], v2 offset:4608
    v_mfma_f32_32x32x16_bf16 v[64:79], v[28:31], v[184:187], v[64:79]
    ds_read_b64_tr_b16 v[44:45], v3 offset:4096
    ds_read_b64_tr_b16 v[46:47], v3 offset:4608
    s_waitcnt lgkmcnt(4)
    v_mfma_f32_32x32x16_bf16 v[48:63], v[32:35], v[188:191], v[48:63]
    ds_read_b64_tr_b16 v[24:25], v2 offset:6144
    ds_read_b64_tr_b16 v[26:27], v2 offset:6656
    v_mfma_f32_32x32x16_bf16 v[64:79], v[36:39], v[188:191], v[64:79]
    ds_read_b64_tr_b16 v[28:29], v3 offset:6144
    ds_read_b64_tr_b16 v[30:31], v3 offset:6656
    s_waitcnt lgkmcnt(4)
    v_mfma_f32_32x32x16_bf16 v[48:63], v[40:43], v[192:195], v[48:63]
    ds_read_b64_tr_b16 v[32:33], v2 offset:8192
    ds_read_b64_tr_b16 v[34:35], v2 offset:8704
    v_mfma_f32_32x32x16_bf16 v[64:79], v[44:47], v[192:195], v[64:79]
    ds_read_b64_tr_b16 v[36:37], v3 offset:8192
    ds_read_b64_tr_b16 v[38:39], v3 offset:8704
    s_waitcnt lgkmcnt(4)
    v_mfma_f32_32x32x16_bf16 v[48:63], v[24:27], v[196:199], v[48:63]
    ds_read_b64_tr_b16 v[40:41], v2 offset:10240
    ds_read_b64_tr_b16 v[42:43], v2 offset:10752
    v_mfma_f32_32x32x16_bf16 v[64:79], v[28:31], v[196:199], v[64:79]
    ds_read_b64_tr_b16 v[44:45], v3 offset:10240
    ds_read_b64_tr_b16 v[46:47], v3 offset:10752
    s_waitcnt lgkmcnt(4)
    v_mfma_f32_32x32x16_bf16 v[48:63], v[32:35], v[200:203], v[48:63]
    ds_read_b64_tr_b16 v[24:25], v2 offset:12288
    ds_read_b64_tr_b16 v[26:27], v2 offset:12800
    v_mfma_f32_32x32x16_bf16 v[64:79], v[36:39], v[200:203], v[64:79]
    ds_read_b64_tr_b16 v[28:29], v3 offset:12288
    ds_read_b64_tr_b16 v[30:31], v3 offset:12800
    s_waitcnt lgkmcnt(4)
    v_mfma_f32_32x32x16_bf16 v[48:63], v[40:43], v[204:207], v[48:63]
    ds_read_b64_tr_b16 v[32:33], v2 offset:14336
    ds_read_b64_tr_b16 v[34:35], v2 offset:14848
    v_mfma_f32_32x32x16_bf16 v[64:79], v[44:47], v[204:207], v[64:79]
    ds_read_b64_tr_b16 v[36:37], v3 offset:14336
    ds_read_b64_tr_b16 v[38:39], v3 offset:14848
    s_waitcnt lgkmcnt(4)
    v_mfma_f32_32x32x16_bf16 v[48:63], v[24:27], v[208:211], v[48:63]
    ds_read_b64_tr_b16 v[40:41], v2 offset:16384
    ds_read_b64_tr_b16 v[42:43], v2 offset:16896
    v_mfma_f32_32x32x16_bf16 v[64:79], v[28:31], v[208:211], v[64:79]
    ds_read_b64_tr_b16 v[44:45], v3 offset:16384
    ds_read_b64_tr_b16 v[46:47], v3 offset:16896
    s_waitcnt lgkmcnt(4)
    v_mfma_f32_32x32x16_bf16 v[48:63], v[32:35], v[212:215], v[48:63]
    ds_read_b64_tr_b16 v[24:25], v2 offset:18432
    ds_read_b64_tr_b16 v[26:27], v2 offset:18944
    v_mfma_f32_32x32x16_bf16 v[64:79], v[36:39], v[212:215], v[64:79]
    ds_read_b64_tr_b16 v[28:29], v3 offset:18432
    ds_read_b64_tr_b16 v[30:31], v3 offset:18944
    s_waitcnt lgkmcnt(4)
    v_mfma_f32_32x32x16_bf16 v[48:63], v[40:43], v[216:219], v[48:63]
    ds_read_b64_tr_b16 v[32:33], v2 offset:20480
    ds_read_b64_tr_b16 v[34:35], v2 offset:20992
    v_mfma_f32_32x32x16_bf16 v[64:79], v[44:47], v[216:219], v[64:79]
    ds_read_b64_tr_b16 v[36:37], v3 offset:20480
    ds_read_b64_tr_b16 v[38:39], v3 offset:20992
    s_waitcnt lgkmcnt(4)
    v_mfma_f32_32x32x16_bf16 v[48:63], v[24:27], v[220:223], v[48:63]
    ds_read_b64_tr_b16 v[40:41], v2 offset:22528
    ds_read_b64_tr_b16 v[42:43], v2 offset:23040
    v_mfma_f32_32x32x16_bf16 v[64:79], v[28:31], v[220:223], v[64:79]
    ds_read_b64_tr_b16 v[44:45], v3 offset:22528
    ds_read_b64_tr_b16 v[46:47], v3 offset:23040
    s_waitcnt lgkmcnt(4)
    v_mfma_f32_32x32x16_bf16 v[48:63], v[32:35], v[224:227], v[48:63]
    ds_read_b64_tr_b16 v[24:25], v2 offset:24576
    ds_read_b64_tr_b16 v[26:27], v2 offset:25088
    s_add_u32 s76, s57, 0
    buffer_store_dwordx4 v[80:83], v6, s[24:27], s76 offen sc1
    v_mfma_f32_32x32x16_bf16 v[64:79], v[36:39], v[224:227], v[64:79]
    ds_read_b64_tr_b16 v[28:29], v3 offset:24576
    ds_read_b64_tr_b16 v[30:31], v3 offset:25088
    s_waitcnt lgkmcnt(4)
    v_mfma_f32_32x32x16_bf16 v[48:63], v[40:43], v[228:231], v[48:63]
    ds_read_b64_tr_b16 v[32:33], v2 offset:26624
    ds_read_b64_tr_b16 v[34:35], v2 offset:27136
    s_add_u32 s76, s57, 65536
    buffer_store_dwordx4 v[88:91], v6, s[24:27], s76 offen sc1
    v_mfma_f32_32x32x16_bf16 v[64:79], v[44:47], v[228:231], v[64:79]
    ds_read_b64_tr_b16 v[36:37], v3 offset:26624
    ds_read_b64_tr_b16 v[38:39], v3 offset:27136
    s_waitcnt lgkmcnt(4)
    v_mfma_f32_32x32x16_bf16 v[48:63], v[24:27], v[232:235], v[48:63]
    ds_read_b64_tr_b16 v[40:41], v2 offset:28672
    ds_read_b64_tr_b16 v[42:43], v2 offset:29184
    s_add_u32 s76, s57, 131072
    buffer_store_dwordx4 v[96:99], v6, s[24:27], s76 offen sc1
    v_mfma_f32_32x32x16_bf16 v[64:79], v[28:31], v[232:235], v[64:79]
    ds_read_b64_tr_b16 v[44:45], v3 offset:28672
    ds_read_b64_tr_b16 v[46:47], v3 offset:29184
    s_waitcnt lgkmcnt(4)
    v_mfma_f32_32x32x16_bf16 v[48:63], v[32:35], v[236:239], v[48:63]
    ds_read_b64_tr_b16 v[24:25], v2 offset:30720
    ds_read_b64_tr_b16 v[26:27], v2 offset:31232
    s_add_u32 s76, s57, 196608
    buffer_store_dwordx4 v[104:107], v6, s[24:27], s76 offen sc1
    v_mfma_f32_32x32x16_bf16 v[64:79], v[36:39], v[236:239], v[64:79]
    ds_read_b64_tr_b16 v[28:29], v3 offset:30720
    ds_read_b64_tr_b16 v[30:31], v3 offset:31232
    s_waitcnt lgkmcnt(4)
    v_mfma_f32_32x32x16_bf16 v[48:63], v[40:43], v[240:243], v[48:63]
    ds_read_b64_tr_b16 v[32:33], v2 offset:32768
    ds_read_b64_tr_b16 v[34:35], v2 offset:33280
    v_mfma_f32_32x32x16_bf16 v[64:79], v[44:47], v[240:243], v[64:79]
    ds_read_b64_tr_b16 v[36:37], v3 offset:32768
    ds_read_b64_tr_b16 v[38:39], v3 offset:33280
    s_waitcnt lgkmcnt(4)
    v_mfma_f32_32x32x16_bf16 v[48:63], v[24:27], v[244:247], v[48:63]
    ds_read_b64_tr_b16 v[40:41], v2 offset:34816
    ds_read_b64_tr_b16 v[42:43], v2 offset:35328
    v_mfma_f32_32x32x16_bf16 v[64:79], v[28:31], v[244:247], v[64:79]
    ds_read_b64_tr_b16 v[44:45], v3 offset:34816
    ds_read_b64_tr_b16 v[46:47], v3 offset:35328
    v_and_b32 v23, s48, v5
    v_xor_b32 v2, v23, v4
    v_xor_b32 v3, 64, v2
    s_waitcnt lgkmcnt(4)
    v_mfma_f32_32x32x16_bf16 v[48:63], v[32:35], v[248:251], v[48:63]
    s_barrier
    ds_read_b64_tr_b16 v[24:25], v2 offset:0
    ds_read_b64_tr_b16 v[26:27], v2 offset:512
    v_mfma_f32_32x32x16_bf16 v[64:79], v[36:39], v[248:251], v[64:79]
    ds_read_b64_tr_b16 v[28:29], v3 offset:0
    ds_read_b64_tr_b16 v[30:31], v3 offset:512
    s_waitcnt lgkmcnt(4)
    v_mfma_f32_32x32x16_bf16 v[48:63], v[40:43], v[252:255], v[48:63]
    ds_read_b64_tr_b16 v[32:33], v2 offset:2048
    ds_read_b64_tr_b16 v[34:35], v2 offset:2560
    v_mfma_f32_32x32x16_bf16 v[64:79], v[44:47], v[252:255], v[64:79]
    ds_read_b64_tr_b16 v[36:37], v3 offset:2048
    ds_read_b64_tr_b16 v[38:39], v3 offset:2560
    s_mov_b32 s57, s58
    s_mov_b32 s58, s59
    s_mov_b32 s45, s46
recurrent_scan__sliding_local_dilated__mixer_gmlp__prompt_kernel_P0:
    s_waitcnt lgkmcnt(4)
    v_mfma_f32_32x32x16_bf16 v[80:95], v[24:27], v[112:115], 0
    s_add_u32 s46, s45, 1
    ds_read_b64_tr_b16 v[40:41], v2 offset:4096
    ds_read_b64_tr_b16 v[42:43], v2 offset:4608
    v_mfma_f32_32x32x16_bf16 v[96:111], v[28:31], v[112:115], 0
    ds_read_b64_tr_b16 v[44:45], v3 offset:4096
    ds_read_b64_tr_b16 v[46:47], v3 offset:4608
    s_add_u32 s72, s42, s46
    s_add_u32 s74, s44, s46
    s_min_u32 s74, s74, 26
    s_waitcnt lgkmcnt(4)
    v_mfma_f32_32x32x16_bf16 v[80:95], v[32:35], v[116:119], v[80:95]
    s_barrier
    ds_read_b64_tr_b16 v[24:25], v2 offset:6144
    ds_read_b64_tr_b16 v[26:27], v2 offset:6656
    s_add_u32 s74, s74, 72
    v_mfma_f32_32x32x16_bf16 v[96:111], v[36:39], v[116:119], v[96:111]
    ds_read_b64_tr_b16 v[28:29], v3 offset:6144
    ds_read_b64_tr_b16 v[30:31], v3 offset:6656
    s_cmp_lt_u32 s46, s39
    s_cselect_b32 s47, s72, s74
    s_cselect_b32 s48, -1, 0
    s_waitcnt lgkmcnt(4)
    v_mfma_f32_32x32x16_bf16 v[80:95], v[40:43], v[120:123], v[80:95]
    ds_read_b64_tr_b16 v[32:33], v2 offset:8192
    ds_read_b64_tr_b16 v[34:35], v2 offset:8704
    s_lshl_b32 s59, s47, 18
    v_mul_f32 v48, v9, v48
    v_mfma_f32_32x32x16_bf16 v[96:111], v[44:47], v[120:123], v[96:111]
    ds_read_b64_tr_b16 v[36:37], v3 offset:8192
    ds_read_b64_tr_b16 v[38:39], v3 offset:8704
    v_mul_f32 v49, v9, v49
    v_mul_f32 v50, v9, v50
    v_mul_f32 v51, v9, v51
    s_waitcnt lgkmcnt(4)
    v_mfma_f32_32x32x16_bf16 v[80:95], v[24:27], v[124:127], v[80:95]
    ds_read_b64_tr_b16 v[40:41], v2 offset:10240
    ds_read_b64_tr_b16 v[42:43], v2 offset:10752
    v_cvt_pk_bf16_f32 v48, v48, v49
    v_mul_f32 v52, v9, v52
    v_mfma_f32_32x32x16_bf16 v[96:111], v[28:31], v[124:127], v[96:111]
    ds_read_b64_tr_b16 v[44:45], v3 offset:10240
    ds_read_b64_tr_b16 v[46:47], v3 offset:10752
    v_mul_f32 v53, v9, v53
    v_cvt_pk_bf16_f32 v49, v50, v51
    v_mul_f32 v54, v9, v54
    s_waitcnt lgkmcnt(4)
    v_mfma_f32_32x32x16_bf16 v[80:95], v[32:35], v[128:131], v[80:95]
    ds_read_b64_tr_b16 v[24:25], v2 offset:12288
    ds_read_b64_tr_b16 v[26:27], v2 offset:12800
    v_mul_f32 v55, v9, v55
    v_cvt_pk_bf16_f32 v50, v52, v53
    v_mfma_f32_32x32x16_bf16 v[96:111], v[36:39], v[128:131], v[96:111]
    ds_read_b64_tr_b16 v[28:29], v3 offset:12288
    ds_read_b64_tr_b16 v[30:31], v3 offset:12800
    v_mul_f32 v56, v9, v56
    v_mul_f32 v57, v9, v57
    v_cvt_pk_bf16_f32 v51, v54, v55
    s_waitcnt lgkmcnt(4)
    v_mfma_f32_32x32x16_bf16 v[80:95], v[40:43], v[132:135], v[80:95]
    ds_read_b64_tr_b16 v[32:33], v2 offset:14336
    ds_read_b64_tr_b16 v[34:35], v2 offset:14848
    v_mul_f32 v58, v9, v58
    v_mul_f32 v59, v9, v59
    v_mfma_f32_32x32x16_bf16 v[96:111], v[44:47], v[132:135], v[96:111]
    ds_read_b64_tr_b16 v[36:37], v3 offset:14336
    ds_read_b64_tr_b16 v[38:39], v3 offset:14848
    v_cvt_pk_bf16_f32 v56, v56, v57
    v_mul_f32 v60, v9, v60
    v_mul_f32 v61, v9, v61
    s_waitcnt lgkmcnt(4)
    v_mfma_f32_32x32x16_bf16 v[80:95], v[24:27], v[136:139], v[80:95]
    ds_read_b64_tr_b16 v[40:41], v2 offset:16384
    ds_read_b64_tr_b16 v[42:43], v2 offset:16896
    v_cvt_pk_bf16_f32 v57, v58, v59
    v_mfma_f32_32x32x16_bf16 v[96:111], v[28:31], v[136:139], v[96:111]
    ds_read_b64_tr_b16 v[44:45], v3 offset:16384
    ds_read_b64_tr_b16 v[46:47], v3 offset:16896
    v_mul_f32 v62, v9, v62
    v_mul_f32 v63, v9, v63
    v_cvt_pk_bf16_f32 v58, v60, v61
    s_waitcnt lgkmcnt(4)
    v_mfma_f32_32x32x16_bf16 v[80:95], v[32:35], v[140:143], v[80:95]
    ds_read_b64_tr_b16 v[24:25], v2 offset:18432
    ds_read_b64_tr_b16 v[26:27], v2 offset:18944
    v_mul_f32 v64, v9, v64
    v_mul_f32 v65, v9, v65
    v_mfma_f32_32x32x16_bf16 v[96:111], v[36:39], v[140:143], v[96:111]
    ds_read_b64_tr_b16 v[28:29], v3 offset:18432
    ds_read_b64_tr_b16 v[30:31], v3 offset:18944
    v_cvt_pk_bf16_f32 v59, v62, v63
    v_mul_f32 v66, v9, v66
    v_mul_f32 v67, v9, v67
    s_waitcnt lgkmcnt(4)
    v_mfma_f32_32x32x16_bf16 v[80:95], v[40:43], v[144:147], v[80:95]
    ds_read_b64_tr_b16 v[32:33], v2 offset:20480
    ds_read_b64_tr_b16 v[34:35], v2 offset:20992
    v_cvt_pk_bf16_f32 v64, v64, v65
    v_mul_f32 v68, v9, v68
    v_mfma_f32_32x32x16_bf16 v[96:111], v[44:47], v[144:147], v[96:111]
    ds_read_b64_tr_b16 v[36:37], v3 offset:20480
    ds_read_b64_tr_b16 v[38:39], v3 offset:20992
    v_mul_f32 v69, v9, v69
    v_cvt_pk_bf16_f32 v65, v66, v67
    v_mul_f32 v70, v9, v70
    s_waitcnt lgkmcnt(4)
    v_mfma_f32_32x32x16_bf16 v[80:95], v[24:27], v[148:151], v[80:95]
    ds_read_b64_tr_b16 v[40:41], v2 offset:22528
    ds_read_b64_tr_b16 v[42:43], v2 offset:23040
    v_mul_f32 v71, v9, v71
    v_cvt_pk_bf16_f32 v66, v68, v69
    v_mfma_f32_32x32x16_bf16 v[96:111], v[28:31], v[148:151], v[96:111]
    ds_read_b64_tr_b16 v[44:45], v3 offset:22528
    ds_read_b64_tr_b16 v[46:47], v3 offset:23040
    v_mul_f32 v72, v9, v72
    v_mul_f32 v73, v9, v73
    v_cvt_pk_bf16_f32 v67, v70, v71
    s_waitcnt lgkmcnt(4)
    v_mfma_f32_32x32x16_bf16 v[80:95], v[32:35], v[152:155], v[80:95]
    ds_read_b64_tr_b16 v[24:25], v2 offset:24576
    ds_read_b64_tr_b16 v[26:27], v2 offset:25088
    v_mul_f32 v74, v9, v74
    v_mul_f32 v75, v9, v75
    v_mfma_f32_32x32x16_bf16 v[96:111], v[36:39], v[152:155], v[96:111]
    ds_read_b64_tr_b16 v[28:29], v3 offset:24576
    ds_read_b64_tr_b16 v[30:31], v3 offset:25088
    v_cvt_pk_bf16_f32 v72, v72, v73
    v_mul_f32 v76, v9, v76
    v_mul_f32 v77, v9, v77
    s_waitcnt lgkmcnt(4)
    v_mfma_f32_32x32x16_bf16 v[80:95], v[40:43], v[156:159], v[80:95]
    ds_read_b64_tr_b16 v[32:33], v2 offset:26624
    ds_read_b64_tr_b16 v[34:35], v2 offset:27136
    v_cvt_pk_bf16_f32 v73, v74, v75
    v_mul_f32 v78, v9, v78
    v_mfma_f32_32x32x16_bf16 v[96:111], v[44:47], v[156:159], v[96:111]
    ds_read_b64_tr_b16 v[36:37], v3 offset:26624
    ds_read_b64_tr_b16 v[38:39], v3 offset:27136
    v_mul_f32 v79, v9, v79
    v_cvt_pk_bf16_f32 v74, v76, v77
    v_cvt_pk_bf16_f32 v75, v78, v79
    s_waitcnt lgkmcnt(4)
    v_mfma_f32_32x32x16_bf16 v[80:95], v[24:27], v[160:163], v[80:95]
    ds_read_b64_tr_b16 v[40:41], v2 offset:28672
    ds_read_b64_tr_b16 v[42:43], v2 offset:29184
    v_mfma_f32_32x32x16_bf16 v[96:111], v[28:31], v[160:163], v[96:111]
    ds_read_b64_tr_b16 v[44:45], v3 offset:28672
    ds_read_b64_tr_b16 v[46:47], v3 offset:29184
    s_waitcnt lgkmcnt(4)
    v_mfma_f32_32x32x16_bf16 v[80:95], v[32:35], v[164:167], v[80:95]
    ds_read_b64_tr_b16 v[24:25], v2 offset:30720
    ds_read_b64_tr_b16 v[26:27], v2 offset:31232
    s_add_u32 s76, s57, 0
    buffer_store_dwordx4 v[48:51], v6, s[24:27], s76 offen sc1
    v_mfma_f32_32x32x16_bf16 v[96:111], v[36:39], v[164:167], v[96:111]
    ds_read_b64_tr_b16 v[28:29], v3 offset:30720
    ds_read_b64_tr_b16 v[30:31], v3 offset:31232
    s_waitcnt lgkmcnt(4)
    v_mfma_f32_32x32x16_bf16 v[80:95], v[40:43], v[168:171], v[80:95]
    ds_read_b64_tr_b16 v[32:33], v2 offset:32768
    ds_read_b64_tr_b16 v[34:35], v2 offset:33280
    s_add_u32 s76, s57, 65536
    buffer_store_dwordx4 v[56:59], v6, s[24:27], s76 offen sc1
    v_mfma_f32_32x32x16_bf16 v[96:111], v[44:47], v[168:171], v[96:111]
    ds_read_b64_tr_b16 v[36:37], v3 offset:32768
    ds_read_b64_tr_b16 v[38:39], v3 offset:33280
    s_waitcnt lgkmcnt(4)
    v_mfma_f32_32x32x16_bf16 v[80:95], v[24:27], v[172:175], v[80:95]
    ds_read_b64_tr_b16 v[40:41], v2 offset:34816
    ds_read_b64_tr_b16 v[42:43], v2 offset:35328
    s_add_u32 s76, s57, 131072
    buffer_store_dwordx4 v[64:67], v6, s[24:27], s76 offen sc1
    v_mfma_f32_32x32x16_bf16 v[96:111], v[28:31], v[172:175], v[96:111]
    ds_read_b64_tr_b16 v[44:45], v3 offset:34816
    ds_read_b64_tr_b16 v[46:47], v3 offset:35328
    s_waitcnt lgkmcnt(4)
    v_mfma_f32_32x32x16_bf16 v[80:95], v[32:35], v[176:179], v[80:95]
    v_add_u32 v2, 36864, v2
    v_add_u32 v3, 36864, v3
    ds_read_b64_tr_b16 v[24:25], v2 offset:0
    ds_read_b64_tr_b16 v[26:27], v2 offset:512
    s_add_u32 s76, s57, 196608
    buffer_store_dwordx4 v[72:75], v6, s[24:27], s76 offen sc1
    v_mfma_f32_32x32x16_bf16 v[96:111], v[36:39], v[176:179], v[96:111]
    ds_read_b64_tr_b16 v[28:29], v3 offset:0
    ds_read_b64_tr_b16 v[30:31], v3 offset:512
    s_waitcnt lgkmcnt(4)
    v_mfma_f32_32x32x16_bf16 v[80:95], v[40:43], v[180:183], v[80:95]
    ds_read_b64_tr_b16 v[32:33], v2 offset:2048
    ds_read_b64_tr_b16 v[34:35], v2 offset:2560
    v_mfma_f32_32x32x16_bf16 v[96:111], v[44:47], v[180:183], v[96:111]
    ds_read_b64_tr_b16 v[36:37], v3 offset:2048
    ds_read_b64_tr_b16 v[38:39], v3 offset:2560
    s_waitcnt lgkmcnt(4)
    v_mfma_f32_32x32x16_bf16 v[80:95], v[24:27], v[184:187], v[80:95]
    ds_read_b64_tr_b16 v[40:41], v2 offset:4096
    ds_read_b64_tr_b16 v[42:43], v2 offset:4608
    v_mfma_f32_32x32x16_bf16 v[96:111], v[28:31], v[184:187], v[96:111]
    ds_read_b64_tr_b16 v[44:45], v3 offset:4096
    ds_read_b64_tr_b16 v[46:47], v3 offset:4608
    s_waitcnt lgkmcnt(4)
    v_mfma_f32_32x32x16_bf16 v[80:95], v[32:35], v[188:191], v[80:95]
    ds_read_b64_tr_b16 v[24:25], v2 offset:6144
    ds_read_b64_tr_b16 v[26:27], v2 offset:6656
    v_mfma_f32_32x32x16_bf16 v[96:111], v[36:39], v[188:191], v[96:111]
    ds_read_b64_tr_b16 v[28:29], v3 offset:6144
    ds_read_b64_tr_b16 v[30:31], v3 offset:6656
    s_waitcnt lgkmcnt(4)
    v_mfma_f32_32x32x16_bf16 v[80:95], v[40:43], v[192:195], v[80:95]
    ds_read_b64_tr_b16 v[32:33], v2 offset:8192
    ds_read_b64_tr_b16 v[34:35], v2 offset:8704
    v_mfma_f32_32x32x16_bf16 v[96:111], v[44:47], v[192:195], v[96:111]
    ds_read_b32 v14, v12
    ds_read_b64_tr_b16 v[36:37], v3 offset:8192
    ds_read_b64_tr_b16 v[38:39], v3 offset:8704
    s_waitcnt lgkmcnt(4)
    v_mfma_f32_32x32x16_bf16 v[80:95], v[24:27], v[196:199], v[80:95]
    ds_read_b64_tr_b16 v[40:41], v2 offset:10240
    ds_read_b64_tr_b16 v[42:43], v2 offset:10752
    v_mfma_f32_32x32x16_bf16 v[96:111], v[28:31], v[196:199], v[96:111]
    ds_read_b64_tr_b16 v[44:45], v3 offset:10240
    ds_read_b64_tr_b16 v[46:47], v3 offset:10752
    s_waitcnt lgkmcnt(4)
    v_mfma_f32_32x32x16_bf16 v[80:95], v[32:35], v[200:203], v[80:95]
    ds_read_b64_tr_b16 v[24:25], v2 offset:12288
    ds_read_b64_tr_b16 v[26:27], v2 offset:12800
    v_mfma_f32_32x32x16_bf16 v[96:111], v[36:39], v[200:203], v[96:111]
    ds_read_b64_tr_b16 v[28:29], v3 offset:12288
    ds_read_b64_tr_b16 v[30:31], v3 offset:12800
    s_waitcnt lgkmcnt(4)
    v_mfma_f32_32x32x16_bf16 v[80:95], v[40:43], v[204:207], v[80:95]
    ds_read_b64_tr_b16 v[32:33], v2 offset:14336
    ds_read_b64_tr_b16 v[34:35], v2 offset:14848
    v_mfma_f32_32x32x16_bf16 v[96:111], v[44:47], v[204:207], v[96:111]
    ds_read_b64_tr_b16 v[36:37], v3 offset:14336
    ds_read_b64_tr_b16 v[38:39], v3 offset:14848
    s_waitcnt lgkmcnt(4)
    v_mfma_f32_32x32x16_bf16 v[80:95], v[24:27], v[208:211], v[80:95]
    ds_read_b64_tr_b16 v[40:41], v2 offset:16384
    ds_read_b64_tr_b16 v[42:43], v2 offset:16896
    v_mfma_f32_32x32x16_bf16 v[96:111], v[28:31], v[208:211], v[96:111]
    ds_read_b64_tr_b16 v[44:45], v3 offset:16384
    ds_read_b64_tr_b16 v[46:47], v3 offset:16896
    s_waitcnt lgkmcnt(4)
    v_mfma_f32_32x32x16_bf16 v[80:95], v[32:35], v[212:215], v[80:95]
    ds_read_b64_tr_b16 v[24:25], v2 offset:18432
    ds_read_b64_tr_b16 v[26:27], v2 offset:18944
    v_mfma_f32_32x32x16_bf16 v[96:111], v[36:39], v[212:215], v[96:111]
    ds_read_b64_tr_b16 v[28:29], v3 offset:18432
    ds_read_b64_tr_b16 v[30:31], v3 offset:18944
    s_waitcnt lgkmcnt(4)
    v_mfma_f32_32x32x16_bf16 v[80:95], v[40:43], v[216:219], v[80:95]
    ds_read_b64_tr_b16 v[32:33], v2 offset:20480
    ds_read_b64_tr_b16 v[34:35], v2 offset:20992
    v_mfma_f32_32x32x16_bf16 v[96:111], v[44:47], v[216:219], v[96:111]
    ds_read_b64_tr_b16 v[36:37], v3 offset:20480
    ds_read_b64_tr_b16 v[38:39], v3 offset:20992
    s_waitcnt lgkmcnt(4)
    v_mfma_f32_32x32x16_bf16 v[80:95], v[24:27], v[220:223], v[80:95]
    ds_read_b64_tr_b16 v[40:41], v2 offset:22528
    ds_read_b64_tr_b16 v[42:43], v2 offset:23040
    v_mfma_f32_32x32x16_bf16 v[96:111], v[28:31], v[220:223], v[96:111]
    ds_read_b64_tr_b16 v[44:45], v3 offset:22528
    ds_read_b64_tr_b16 v[46:47], v3 offset:23040
    s_waitcnt lgkmcnt(4)
    v_mfma_f32_32x32x16_bf16 v[80:95], v[32:35], v[224:227], v[80:95]
    ds_read_b64_tr_b16 v[24:25], v2 offset:24576
    ds_read_b64_tr_b16 v[26:27], v2 offset:25088
    v_mfma_f32_32x32x16_bf16 v[96:111], v[36:39], v[224:227], v[96:111]
    ds_read_b64_tr_b16 v[28:29], v3 offset:24576
    ds_read_b64_tr_b16 v[30:31], v3 offset:25088
    s_waitcnt lgkmcnt(4)
    v_mfma_f32_32x32x16_bf16 v[80:95], v[40:43], v[228:231], v[80:95]
    ds_read_b64_tr_b16 v[32:33], v2 offset:26624
    ds_read_b64_tr_b16 v[34:35], v2 offset:27136
    v_mfma_f32_32x32x16_bf16 v[96:111], v[44:47], v[228:231], v[96:111]
    ds_read_b64_tr_b16 v[36:37], v3 offset:26624
    ds_read_b64_tr_b16 v[38:39], v3 offset:27136
    s_waitcnt lgkmcnt(4)
    v_mfma_f32_32x32x16_bf16 v[80:95], v[24:27], v[232:235], v[80:95]
    ds_read_b64_tr_b16 v[40:41], v2 offset:28672
    ds_read_b64_tr_b16 v[42:43], v2 offset:29184
    v_mfma_f32_32x32x16_bf16 v[96:111], v[28:31], v[232:235], v[96:111]
    ds_read_b64_tr_b16 v[44:45], v3 offset:28672
    ds_read_b64_tr_b16 v[46:47], v3 offset:29184
    s_waitcnt lgkmcnt(4)
    v_mfma_f32_32x32x16_bf16 v[80:95], v[32:35], v[236:239], v[80:95]
    ds_read_b64_tr_b16 v[24:25], v2 offset:30720
    ds_read_b64_tr_b16 v[26:27], v2 offset:31232
    v_mfma_f32_32x32x16_bf16 v[96:111], v[36:39], v[236:239], v[96:111]
    ds_read_b64_tr_b16 v[28:29], v3 offset:30720
    ds_read_b64_tr_b16 v[30:31], v3 offset:31232
    s_waitcnt lgkmcnt(4)
    v_mfma_f32_32x32x16_bf16 v[80:95], v[40:43], v[240:243], v[80:95]
    ds_read_b64_tr_b16 v[32:33], v2 offset:32768
    ds_read_b64_tr_b16 v[34:35], v2 offset:33280
    v_mfma_f32_32x32x16_bf16 v[96:111], v[44:47], v[240:243], v[96:111]
    ds_read_b64_tr_b16 v[36:37], v3 offset:32768
    ds_read_b64_tr_b16 v[38:39], v3 offset:33280
    s_waitcnt lgkmcnt(4)
    v_mfma_f32_32x32x16_bf16 v[80:95], v[24:27], v[244:247], v[80:95]
    s_waitcnt vmcnt(0)
    buffer_store_dword v14, v13, s[28:31], s32 offen sc1
    ds_read_b64_tr_b16 v[40:41], v2 offset:34816
    ds_read_b64_tr_b16 v[42:43], v2 offset:35328
    v_mfma_f32_32x32x16_bf16 v[96:111], v[28:31], v[244:247], v[96:111]
    ds_read_b64_tr_b16 v[44:45], v3 offset:34816
    ds_read_b64_tr_b16 v[46:47], v3 offset:35328
    v_and_b32 v23, s48, v5
    v_xor_b32 v2, v23, v4
    v_add_u32 v2, 73728, v2
    v_xor_b32 v3, 64, v2
    s_waitcnt lgkmcnt(4)
    v_mfma_f32_32x32x16_bf16 v[80:95], v[32:35], v[248:251], v[80:95]
    s_barrier
    ds_read_b64_tr_b16 v[24:25], v2 offset:0
    ds_read_b64_tr_b16 v[26:27], v2 offset:512
    v_mfma_f32_32x32x16_bf16 v[96:111], v[36:39], v[248:251], v[96:111]
    ds_read_b64_tr_b16 v[28:29], v3 offset:0
    ds_read_b64_tr_b16 v[30:31], v3 offset:512
    s_waitcnt lgkmcnt(4)
    v_mfma_f32_32x32x16_bf16 v[80:95], v[40:43], v[252:255], v[80:95]
    ds_read_b64_tr_b16 v[32:33], v2 offset:2048
    ds_read_b64_tr_b16 v[34:35], v2 offset:2560
    v_mfma_f32_32x32x16_bf16 v[96:111], v[44:47], v[252:255], v[96:111]
    ds_read_b64_tr_b16 v[36:37], v3 offset:2048
    ds_read_b64_tr_b16 v[38:39], v3 offset:2560
    s_mov_b32 s57, s58
    s_mov_b32 s58, s59
    s_mov_b32 s45, s46
recurrent_scan__sliding_local_dilated__mixer_gmlp__prompt_kernel_H1:
    s_waitcnt lgkmcnt(4)
    v_mfma_f32_32x32x16_bf16 v[48:63], v[24:27], v[112:115], 0
    s_add_u32 s46, s45, 1
    ds_read_b64_tr_b16 v[40:41], v2 offset:4096
    ds_read_b64_tr_b16 v[42:43], v2 offset:4608
    v_mfma_f32_32x32x16_bf16 v[64:79], v[28:31], v[112:115], 0
    ds_read_b64_tr_b16 v[44:45], v3 offset:4096
    ds_read_b64_tr_b16 v[46:47], v3 offset:4608
    s_waitcnt lgkmcnt(4)
    v_mfma_f32_32x32x16_bf16 v[48:63], v[32:35], v[116:119], v[48:63]
    s_barrier
    ds_read_b64_tr_b16 v[24:25], v2 offset:6144
    ds_read_b64_tr_b16 v[26:27], v2 offset:6656
    v_mul_f32 v96, v9, v96
    v_mul_f32 v97, v9, v97
    v_fma_f32 v16, v96, v96, s63
    v_mfma_f32_32x32x16_bf16 v[64:79], v[36:39], v[116:119], v[64:79]
    ds_read_b64_tr_b16 v[28:29], v3 offset:6144
    ds_read_b64_tr_b16 v[30:31], v3 offset:6656
    v_mul_f32 v98, v9, v98
    v_fma_f32 v17, v97, v97, s63
    v_mul_f32 v16, v16, v96
    v_exp_f32 v16, v16
    s_waitcnt lgkmcnt(4)
    v_mfma_f32_32x32x16_bf16 v[48:63], v[40:43], v[120:123], v[48:63]
    ds_read_b64_tr_b16 v[32:33], v2 offset:8192
    ds_read_b64_tr_b16 v[34:35], v2 offset:8704
    v_mul_f32 v99, v9, v99
    v_fma_f32 v18, v98, v98, s63
    v_mul_f32 v17, v17, v97
    v_mfma_f32_32x32x16_bf16 v[64:79], v[44:47], v[120:123], v[64:79]
    ds_read_b64_tr_b16 v[36:37], v3 offset:8192
    ds_read_b64_tr_b16 v[38:39], v3 offset:8704
    v_exp_f32 v17, v17
    v_mul_f32 v100, v9, v100
    v_add_f32 v16, 1.0, v16
    v_fma_f32 v19, v99, v99, s63
    v_mul_f32 v18, v18, v98
    s_waitcnt lgkmcnt(4)
    v_mfma_f32_32x32x16_bf16 v[48:63], v[24:27], v[124:127], v[48:63]
    ds_read_b64_tr_b16 v[40:41], v2 offset:10240
    ds_read_b64_tr_b16 v[42:43], v2 offset:10752
    v_exp_f32 v18, v18
    v_mul_f32 v101, v9, v101
    v_mfma_f32_32x32x16_bf16 v[64:79], v[28:31], v[124:127], v[64:79]
    ds_read_b64_tr_b16 v[44:45], v3 offset:10240
    ds_read_b64_tr_b16 v[46:47], v3 offset:10752
    v_add_f32 v17, 1.0, v17
    v_fma_f32 v20, v100, v100, s63
    v_rcp_f32 v16, v16
    v_mul_f32 v19, v19, v99
    s_waitcnt lgkmcnt(4)
    v_mfma_f32_32x32x16_bf16 v[48:63], v[32:35], v[128:131], v[48:63]
    ds_read_b64_tr_b16 v[24:25], v2 offset:12288
    ds_read_b64_tr_b16 v[26:27], v2 offset:12800
    v_mul_f32 v96, v16, v96
    v_exp_f32 v19, v19
    v_mul_f32 v102, v9, v102
    v_mfma_f32_32x32x16_bf16 v[64:79], v[36:39], v[128:131], v[64:79]
    ds_read_b64_tr_b16 v[28:29], v3 offset:12288
    ds_read_b64_tr_b16 v[30:31], v3 offset:12800
    v_add_f32 v18, 1.0, v18
    v_fma_f32 v21, v101, v101, s63
    v_rcp_f32 v17, v17
    v_mul_f32 v20, v20, v100
    s_waitcnt lgkmcnt(4)
    v_mfma_f32_32x32x16_bf16 v[48:63], v[40:43], v[132:135], v[48:63]
    ds_read_b64_tr_b16 v[32:33], v2 offset:14336
    ds_read_b64_tr_b16 v[34:35], v2 offset:14848
    v_mul_f32 v97, v17, v97
    v_exp_f32 v20, v20
    v_mul_f32 v103, v9, v103
    v_mfma_f32_32x32x16_bf16 v[64:79], v[44:47], v[132:135], v[64:79]
    ds_read_b64_tr_b16 v[36:37], v3 offset:14336
    ds_read_b64_tr_b16 v[38:39], v3 offset:14848
    v_add_f32 v19, 1.0, v19
    v_fma_f32 v16, v102, v102, s63
    v_rcp_f32 v18, v18
    v_mul_f32 v21, v21, v101
    s_waitcnt lgkmcnt(4)
    v_mfma_f32_32x32x16_bf16 v[48:63], v[24:27], v[136:139], v[48:63]
    ds_read_b64_tr_b16 v[40:41], v2 offset:16384
    ds_read_b64_tr_b16 v[42:43], v2 offset:16896
    v_mul_f32 v98, v18, v98
    v_exp_f32 v21, v21
    v_mul_f32 v104, v9, v104
    v_mfma_f32_32x32x16_bf16 v[64:79], v[28:31], v[136:139], v[64:79]
    ds_read_b64_tr_b16 v[44:45], v3 offset:16384
    ds_read_b64_tr_b16 v[46:47], v3 offset:16896
    v_add_f32 v20, 1.0, v20
    v_fma_f32 v17, v103, v103, s63
    v_rcp_f32 v19, v19
    v_mul_f32 v16, v16, v102
    s_waitcnt lgkmcnt(4)
    v_mfma_f32_32x32x16_bf16 v[48:63], v[32:35], v[140:143], v[48:63]
    ds_read_b64_tr_b16 v[24:25], v2 offset:18432
    ds_read_b64_tr_b16 v[26:27], v2 offset:18944
    v_cvt_pk_bf16_f32 v96, v96, v97
    v_mul_f32 v99, v19, v99
    v_exp_f32 v16, v16
    v_mfma_f32_32x32x16_bf16 v[64:79], v[36:39], v[140:143], v[64:79]
    ds_read_b64_tr_b16 v[28:29], v3 offset:18432
    ds_read_b64_tr_b16 v[30:31], v3 offset:18944
    v_mul_f32 v105, v9, v105
    v_add_f32 v21, 1.0, v21
    v_fma_f32 v18, v104, v104, s63
    v_rcp_f32 v20, v20
    s_waitcnt lgkmcnt(4)
    v_mfma_f32_32x32x16_bf16 v[48:63], v[40:43], v[144:147], v[48:63]
    ds_read_b64_tr_b16 v[32:33], v2 offset:20480
    ds_read_b64_tr_b16 v[34:35], v2 offset:20992
    v_mul_f32 v17, v17, v103
    v_mul_f32 v100, v20, v100
    v_exp_f32 v17, v17
    v_mfma_f32_32x32x16_bf16 v[64:79], v[44:47], v[144:147], v[64:79]
    ds_read_b64_tr_b16 v[36:37], v3 offset:20480
    ds_read_b64_tr_b16 v[38:39], v3 offset:20992
    v_mul_f32 v106, v9, v106
    v_add_f32 v16, 1.0, v16
    v_fma_f32 v19, v105, v105, s63
    v_rcp_f32 v21, v21
    s_waitcnt lgkmcnt(4)
    v_mfma_f32_32x32x16_bf16 v[48:63], v[24:27], v[148:151], v[48:63]
    ds_read_b64_tr_b16 v[40:41], v2 offset:22528
    ds_read_b64_tr_b16 v[42:43], v2 offset:23040
    v_mul_f32 v18, v18, v104
    v_cvt_pk_bf16_f32 v97, v98, v99
    v_mul_f32 v101, v21, v101
    v_mfma_f32_32x32x16_bf16 v[64:79], v[28:31], v[148:151], v[64:79]
    ds_read_b64_tr_b16 v[44:45], v3 offset:22528
    ds_read_b64_tr_b16 v[46:47], v3 offset:23040
    v_exp_f32 v18, v18
    v_mul_f32 v107, v9, v107
    v_add_f32 v17, 1.0, v17
    v_fma_f32 v20, v106, v106, s63
    s_waitcnt lgkmcnt(4)
    v_mfma_f32_32x32x16_bf16 v[48:63], v[32:35], v[152:155], v[48:63]
    ds_read_b64_tr_b16 v[24:25], v2 offset:24576
    ds_read_b64_tr_b16 v[26:27], v2 offset:25088
    v_rcp_f32 v16, v16
    v_mul_f32 v19, v19, v105
    v_mul_f32 v102, v16, v102
    v_mfma_f32_32x32x16_bf16 v[64:79], v[36:39], v[152:155], v[64:79]
    ds_read_b64_tr_b16 v[28:29], v3 offset:24576
    ds_read_b64_tr_b16 v[30:31], v3 offset:25088
    v_exp_f32 v19, v19
    v_mul_f32 v108, v9, v108
    v_add_f32 v18, 1.0, v18
    v_fma_f32 v21, v107, v107, s63
    s_waitcnt lgkmcnt(4)
    v_mfma_f32_32x32x16_bf16 v[48:63], v[40:43], v[156:159], v[48:63]
    ds_read_b64_tr_b16 v[32:33], v2 offset:26624
    ds_read_b64_tr_b16 v[34:35], v2 offset:27136
    v_rcp_f32 v17, v17
    v_mul_f32 v20, v20, v106
    v_cvt_pk_bf16_f32 v98, v100, v101
    v_mfma_f32_32x32x16_bf16 v[64:79], v[44:47], v[156:159], v[64:79]
    ds_read_b64_tr_b16 v[36:37], v3 offset:26624
    ds_read_b64_tr_b16 v[38:39], v3 offset:27136
    v_mul_f32 v103, v17, v103
    v_exp_f32 v20, v20
    v_mul_f32 v109, v9, v109
    s_waitcnt lgkmcnt(4)
    v_mfma_f32_32x32x16_bf16 v[48:63], v[24:27], v[160:163], v[48:63]
    ds_read_b64_tr_b16 v[40:41], v2 offset:28672
    ds_read_b64_tr_b16 v[42:43], v2 offset:29184
    v_add_f32 v19, 1.0, v19
    v_fma_f32 v16, v108, v108, s63
    v_rcp_f32 v18, v18
    v_mfma_f32_32x32x16_bf16 v[64:79], v[28:31], v[160:163], v[64:79]
    ds_read_b64_tr_b16 v[44:45], v3 offset:28672
    ds_read_b64_tr_b16 v[46:47], v3 offset:29184
    v_mul_f32 v21, v21, v107
    v_mul_f32 v104, v18, v104
    v_exp_f32 v21, v21
    v_mul_f32 v110, v9, v110
    s_waitcnt lgkmcnt(4)
    v_mfma_f32_32x32x16_bf16 v[48:63], v[32:35], v[164:167], v[48:63]
    ds_read_b64_tr_b16 v[24:25], v2 offset:30720
    ds_read_b64_tr_b16 v[26:27], v2 offset:31232
    v_add_f32 v20, 1.0, v20
    v_fma_f32 v17, v109, v109, s63
    v_rcp_f32 v19, v19
    v_mfma_f32_32x32x16_bf16 v[64:79], v[36:39], v[164:167], v[64:79]
    ds_read_b64_tr_b16 v[28:29], v3 offset:30720
    ds_read_b64_tr_b16 v[30:31], v3 offset:31232
    v_mul_f32 v16, v16, v108
    v_cvt_pk_bf16_f32 v99, v102, v103
    v_mul_f32 v105, v19, v105
    v_exp_f32 v16, v16
    s_waitcnt lgkmcnt(4)
    v_mfma_f32_32x32x16_bf16 v[48:63], v[40:43], v[168:171], v[48:63]
    ds_read_b64_tr_b16 v[32:33], v2 offset:32768
    ds_read_b64_tr_b16 v[34:35], v2 offset:33280
    v_mul_f32 v111, v9, v111
    v_add_f32 v21, 1.0, v21
    v_fma_f32 v18, v110, v110, s63
    v_mfma_f32_32x32x16_bf16 v[64:79], v[44:47], v[168:171], v[64:79]
    ds_read_b64_tr_b16 v[36:37], v3 offset:32768
    ds_read_b64_tr_b16 v[38:39], v3 offset:33280
    v_rcp_f32 v20, v20
    v_mul_f32 v17, v17, v109
    v_mul_f32 v106, v20, v106
    v_exp_f32 v17, v17
    s_waitcnt lgkmcnt(4)
    v_mfma_f32_32x32x16_bf16 v[48:63], v[24:27], v[172:175], v[48:63]
    ds_read_b64_tr_b16 v[40:41], v2 offset:34816
    ds_read_b64_tr_b16 v[42:43], v2 offset:35328
    v_mul_f32 v80, v9, v80
    v_add_f32 v16, 1.0, v16
    v_fma_f32 v19, v111, v111, s63
    v_mfma_f32_32x32x16_bf16 v[64:79], v[28:31], v[172:175], v[64:79]
    ds_read_b64_tr_b16 v[44:45], v3 offset:34816
    ds_read_b64_tr_b16 v[46:47], v3 offset:35328
    v_rcp_f32 v21, v21
    v_mul_f32 v18, v18, v110
    v_cvt_pk_bf16_f32 v100, v104, v105
    v_mul_f32 v107, v21, v107
    s_waitcnt lgkmcnt(4)
    v_mfma_f32_32x32x16_bf16 v[48:63], v[32:35], v[176:179], v[48:63]
    v_add_u32 v2, 36864, v2
    v_add_u32 v3, 36864, v3
    ds_read_b64_tr_b16 v[24:25], v2 offset:0
    ds_read_b64_tr_b16 v[26:27], v2 offset:512
    v_exp_f32 v18, v18
    v_mfma_f32_32x32x16_bf16 v[64:79], v[36:39], v[176:179], v[64:79]
    ds_read_b64_tr_b16 v[28:29], v3 offset:0
    ds_read_b64_tr_b16 v[30:31], v3 offset:512
    v_mul_f32 v81, v9, v81
    v_add_f32 v17, 1.0, v17
    v_fma_f32 v20, v80, v80, s63
    v_rcp_f32 v16, v16
    s_waitcnt lgkmcnt(4)
    v_mfma_f32_32x32x16_bf16 v[48:63], v[40:43], v[180:183], v[48:63]
    ds_read_b64_tr_b16 v[32:33], v2 offset:2048
    ds_read_b64_tr_b16 v[34:35], v2 offset:2560
    v_mul_f32 v19, v19, v111
    v_mul_f32 v108, v16, v108
    v_exp_f32 v19, v19
    v_mfma_f32_32x32x16_bf16 v[64:79], v[44:47], v[180:183], v[64:79]
    ds_read_b64_tr_b16 v[36:37], v3 offset:2048
    ds_read_b64_tr_b16 v[38:39], v3 offset:2560
    v_mul_f32 v82, v9, v82
    v_add_f32 v18, 1.0, v18
    v_fma_f32 v21, v81, v81, s63
    v_rcp_f32 v17, v17
    s_waitcnt lgkmcnt(4)
    v_mfma_f32_32x32x16_bf16 v[48:63], v[24:27], v[184:187], v[48:63]
    ds_read_b64_tr_b16 v[40:41], v2 offset:4096
    ds_read_b64_tr_b16 v[42:43], v2 offset:4608
    v_mul_f32 v20, v20, v80
    v_cvt_pk_bf16_f32 v101, v106, v107
    v_mul_f32 v109, v17, v109
    v_exp_f32 v20, v20
    v_mfma_f32_32x32x16_bf16 v[64:79], v[28:31], v[184:187], v[64:79]
    ds_read_b64_tr_b16 v[44:45], v3 offset:4096
    ds_read_b64_tr_b16 v[46:47], v3 offset:4608
    v_mul_f32 v83, v9, v83
    v_add_f32 v19, 1.0, v19
    v_fma_f32 v16, v82, v82, s63
    s_waitcnt lgkmcnt(4)
    v_mfma_f32_32x32x16_bf16 v[48:63], v[32:35], v[188:191], v[48:63]
    ds_read_b64_tr_b16 v[24:25], v2 offset:6144
    ds_read_b64_tr_b16 v[26:27], v2 offset:6656
    v_rcp_f32 v18, v18
    v_mul_f32 v21, v21, v81
    v_mul_f32 v110, v18, v110
    v_mfma_f32_32x32x16_bf16 v[64:79], v[36:39], v[188:191], v[64:79]
    ds_read_b64_tr_b16 v[28:29], v3 offset:6144
    ds_read_b64_tr_b16 v[30:31], v3 offset:6656
    v_exp_f32 v21, v21
    v_mul_f32 v84, v9, v84
    v_add_f32 v20, 1.0, v20
    v_fma_f32 v17, v83, v83, s63
    s_waitcnt lgkmcnt(4)
    v_mfma_f32_32x32x16_bf16 v[48:63], v[40:43], v[192:195], v[48:63]
    ds_read_b64_tr_b16 v[32:33], v2 offset:8192
    ds_read_b64_tr_b16 v[34:35], v2 offset:8704
    v_rcp_f32 v19, v19
    v_mul_f32 v16, v16, v82
    v_cvt_pk_bf16_f32 v102, v108, v109
    v_mul_f32 v111, v19, v111
    v_mfma_f32_32x32x16_bf16 v[64:79], v[44:47], v[192:195], v[64:79]
    ds_read_b64_tr_b16 v[36:37], v3 offset:8192
    ds_read_b64_tr_b16 v[38:39], v3 offset:8704
    v_exp_f32 v16, v16
    v_mul_f32 v85, v9, v85
    v_add_f32 v21, 1.0, v21
    s_waitcnt lgkmcnt(4)
    v_mfma_f32_32x32x16_bf16 v[48:63], v[24:27], v[196:199], v[48:63]
    ds_read_b64_tr_b16 v[40:41], v2 offset:10240
    ds_read_b64_tr_b16 v[42:43], v2 offset:10752
    v_fma_f32 v18, v84, v84, s63
    v_rcp_f32 v20, v20
    v_mul_f32 v17, v17, v83
    v_mfma_f32_32x32x16_bf16 v[64:79], v[28:31], v[196:199], v[64:79]
    ds_read_b64_tr_b16 v[44:45], v3 offset:10240
    ds_read_b64_tr_b16 v[46:47], v3 offset:10752
    v_mul_f32 v80, v20, v80
    v_exp_f32 v17, v17
    v_mul_f32 v86, v9, v86
    v_add_f32 v16, 1.0, v16
    s_waitcnt lgkmcnt(4)
    v_mfma_f32_32x32x16_bf16 v[48:63], v[32:35], v[200:203], v[48:63]
    ds_read_b64_tr_b16 v[24:25], v2 offset:12288
    ds_read_b64_tr_b16 v[26:27], v2 offset:12800
    v_fma_f32 v19, v85, v85, s63
    v_rcp_f32 v21, v21
    v_mul_f32 v18, v18, v84
    v_mfma_f32_32x32x16_bf16 v[64:79], v[36:39], v[200:203], v[64:79]
    ds_read_b64_tr_b16 v[28:29], v3 offset:12288
    ds_read_b64_tr_b16 v[30:31], v3 offset:12800
    v_cvt_pk_bf16_f32 v103, v110, v111
    v_mul_f32 v81, v21, v81
    v_exp_f32 v18, v18
    v_mul_f32 v87, v9, v87
    s_waitcnt lgkmcnt(4)
    v_mfma_f32_32x32x16_bf16 v[48:63], v[40:43], v[204:207], v[48:63]
    ds_read_b64_tr_b16 v[32:33], v2 offset:14336
    ds_read_b64_tr_b16 v[34:35], v2 offset:14848
    v_add_f32 v17, 1.0, v17
    v_fma_f32 v20, v86, v86, s63
    v_rcp_f32 v16, v16
    v_mfma_f32_32x32x16_bf16 v[64:79], v[44:47], v[204:207], v[64:79]
    ds_read_b64_tr_b16 v[36:37], v3 offset:14336
    ds_read_b64_tr_b16 v[38:39], v3 offset:14848
    v_mul_f32 v19, v19, v85
    v_mul_f32 v82, v16, v82
    v_exp_f32 v19, v19
    v_mul_f32 v88, v9, v88
    s_waitcnt lgkmcnt(4)
    v_mfma_f32_32x32x16_bf16 v[48:63], v[24:27], v[208:211], v[48:63]
    ds_read_b64_tr_b16 v[40:41], v2 offset:16384
    ds_read_b64_tr_b16 v[42:43], v2 offset:16896
    v_add_f32 v18, 1.0, v18
    v_fma_f32 v21, v87, v87, s63
    v_rcp_f32 v17, v17
    v_mfma_f32_32x32x16_bf16 v[64:79], v[28:31], v[208:211], v[64:79]
    ds_read_b64_tr_b16 v[44:45], v3 offset:16384
    ds_read_b64_tr_b16 v[46:47], v3 offset:16896
    v_mul_f32 v20, v20, v86
    v_cvt_pk_bf16_f32 v104, v80, v81
    v_mul_f32 v83, v17, v83
    v_exp_f32 v20, v20
    s_waitcnt lgkmcnt(4)
    v_mfma_f32_32x32x16_bf16 v[48:63], v[32:35], v[212:215], v[48:63]
    ds_read_b64_tr_b16 v[24:25], v2 offset:18432
    ds_read_b64_tr_b16 v[26:27], v2 offset:18944
    v_mul_f32 v89, v9, v89
    v_add_f32 v19, 1.0, v19
    v_fma_f32 v16, v88, v88, s63
    v_mfma_f32_32x32x16_bf16 v[64:79], v[36:39], v[212:215], v[64:79]
    ds_read_b64_tr_b16 v[28:29], v3 offset:18432
    ds_read_b64_tr_b16 v[30:31], v3 offset:18944
    v_rcp_f32 v18, v18
    v_mul_f32 v21, v21, v87
    v_mul_f32 v84, v18, v84
    v_exp_f32 v21, v21
    s_waitcnt lgkmcnt(4)
    v_mfma_f32_32x32x16_bf16 v[48:63], v[40:43], v[216:219], v[48:63]
    ds_read_b64_tr_b16 v[32:33], v2 offset:20480
    ds_read_b64_tr_b16 v[34:35], v2 offset:20992
    v_mul_f32 v90, v9, v90
    v_add_f32 v20, 1.0, v20
    v_fma_f32 v17, v89, v89, s63
    v_mfma_f32_32x32x16_bf16 v[64:79], v[44:47], v[216:219], v[64:79]
    ds_read_b64_tr_b16 v[36:37], v3 offset:20480
    ds_read_b64_tr_b16 v[38:39], v3 offset:20992
    v_rcp_f32 v19, v19
    v_mul_f32 v16, v16, v88
    v_cvt_pk_bf16_f32 v105, v82, v83
    v_mul_f32 v85, v19, v85
    s_waitcnt lgkmcnt(4)
    v_mfma_f32_32x32x16_bf16 v[48:63], v[24:27], v[220:223], v[48:63]
    ds_read_b64_tr_b16 v[40:41], v2 offset:22528
    ds_read_b64_tr_b16 v[42:43], v2 offset:23040
    v_exp_f32 v16, v16
    v_mul_f32 v91, v9, v91
    v_add_f32 v21, 1.0, v21
    v_mfma_f32_32x32x16_bf16 v[64:79], v[28:31], v[220:223], v[64:79]
    ds_read_b64_tr_b16 v[44:45], v3 offset:22528
    ds_read_b64_tr_b16 v[46:47], v3 offset:23040
    v_fma_f32 v18, v90, v90, s63
    v_rcp_f32 v20, v20
    v_mul_f32 v17, v17, v89
    v_mul_f32 v86, v20, v86
    s_waitcnt lgkmcnt(4)
    v_mfma_f32_32x32x16_bf16 v[48:63], v[32:35], v[224:227], v[48:63]
    ds_read_b64_tr_b16 v[24:25], v2 offset:24576
    ds_read_b64_tr_b16 v[26:27], v2 offset:25088
    v_exp_f32 v17, v17
    v_mul_f32 v92, v9, v92
    v_add_f32 v16, 1.0, v16
    v_mfma_f32_32x32x16_bf16 v[64:79], v[36:39], v[224:227], v[64:79]
    ds_read_b64_tr_b16 v[28:29], v3 offset:24576
    ds_read_b64_tr_b16 v[30:31], v3 offset:25088
    v_fma_f32 v19, v91, v91, s63
    v_rcp_f32 v21, v21
    v_mul_f32 v18, v18, v90
    v_cvt_pk_bf16_f32 v106, v84, v85
    s_waitcnt lgkmcnt(4)
    v_mfma_f32_32x32x16_bf16 v[48:63], v[40:43], v[228:231], v[48:63]
    ds_read_b64_tr_b16 v[32:33], v2 offset:26624
    ds_read_b64_tr_b16 v[34:35], v2 offset:27136
    v_mul_f32 v87, v21, v87
    v_exp_f32 v18, v18
    v_mfma_f32_32x32x16_bf16 v[64:79], v[44:47], v[228:231], v[64:79]
    ds_read_b64_tr_b16 v[36:37], v3 offset:26624
    ds_read_b64_tr_b16 v[38:39], v3 offset:27136
    v_mul_f32 v93, v9, v93
    v_add_f32 v17, 1.0, v17
    v_fma_f32 v20, v92, v92, s63
    v_rcp_f32 v16, v16
    s_waitcnt lgkmcnt(4)
    v_mfma_f32_32x32x16_bf16 v[48:63], v[24:27], v[232:235], v[48:63]
    ds_read_b64_tr_b16 v[40:41], v2 offset:28672
    ds_read_b64_tr_b16 v[42:43], v2 offset:29184
    v_mul_f32 v19, v19, v91
    v_mul_f32 v88, v16, v88
    v_exp_f32 v19, v19
    v_mfma_f32_32x32x16_bf16 v[64:79], v[28:31], v[232:235], v[64:79]
    ds_read_b64_tr_b16 v[44:45], v3 offset:28672
    ds_read_b64_tr_b16 v[46:47], v3 offset:29184
    v_mul_f32 v94, v9, v94
    v_add_f32 v18, 1.0, v18
    v_fma_f32 v21, v93, v93, s63
    v_rcp_f32 v17, v17
    s_waitcnt lgkmcnt(4)
    v_mfma_f32_32x32x16_bf16 v[48:63], v[32:35], v[236:239], v[48:63]
    ds_read_b64_tr_b16 v[24:25], v2 offset:30720
    ds_read_b64_tr_b16 v[26:27], v2 offset:31232
    v_mul_f32 v20, v20, v92
    v_cvt_pk_bf16_f32 v107, v86, v87
    v_mul_f32 v89, v17, v89
    v_exp_f32 v20, v20
    v_mfma_f32_32x32x16_bf16 v[64:79], v[36:39], v[236:239], v[64:79]
    ds_read_b64_tr_b16 v[28:29], v3 offset:30720
    ds_read_b64_tr_b16 v[30:31], v3 offset:31232
    v_mul_f32 v95, v9, v95
    v_add_f32 v19, 1.0, v19
    v_fma_f32 v16, v94, v94, s63
    s_waitcnt lgkmcnt(4)
    v_mfma_f32_32x32x16_bf16 v[48:63], v[40:43], v[240:243], v[48:63]
    ds_read_b64_tr_b16 v[32:33], v2 offset:32768
    ds_read_b64_tr_b16 v[34:35], v2 offset:33280
    v_rcp_f32 v18, v18
    v_mul_f32 v21, v21, v93
    v_mul_f32 v90, v18, v90
    v_mfma_f32_32x32x16_bf16 v[64:79], v[44:47], v[240:243], v[64:79]
    ds_read_b64_tr_b16 v[36:37], v3 offset:32768
    ds_read_b64_tr_b16 v[38:39], v3 offset:33280
    v_exp_f32 v21, v21
    v_add_f32 v20, 1.0, v20
    v_fma_f32 v17, v95, v95, s63
    v_rcp_f32 v19, v19
    s_waitcnt lgkmcnt(4)
    v_mfma_f32_32x32x16_bf16 v[48:63], v[24:27], v[244:247], v[48:63]
    ds_read_b64_tr_b16 v[40:41], v2 offset:34816
    ds_read_b64_tr_b16 v[42:43], v2 offset:35328
    v_mul_f32 v16, v16, v94
    v_cvt_pk_bf16_f32 v108, v88, v89
    v_mul_f32 v91, v19, v91
    v_mfma_f32_32x32x16_bf16 v[64:79], v[28:31], v[244:247], v[64:79]
    ds_read_b64_tr_b16 v[44:45], v3 offset:34816
    ds_read_b64_tr_b16 v[46:47], v3 offset:35328
    v_lshrrev_b32 v2, 7, v4
    v_and_b32 v3, 24, v4
    v_lshl_add_u32 v2, v2, 5, v3
    v_exp_f32 v16, v16
    s_waitcnt lgkmcnt(4)
    v_mfma_f32_32x32x16_bf16 v[48:63], v[32:35], v[248:251], v[48:63]
    s_barrier
    ds_read_b64_tr_b16 v[24:25], v2 offset:0
    ds_read_b64_tr_b16 v[26:27], v2 offset:128
    v_add_f32 v21, 1.0, v21
    v_rcp_f32 v20, v20
    v_mfma_f32_32x32x16_bf16 v[64:79], v[36:39], v[248:251], v[64:79]
    v_mul_f32 v17, v17, v95
    v_mul_f32 v92, v20, v92
    v_exp_f32 v17, v17
    v_add_f32 v16, 1.0, v16
    v_rcp_f32 v21, v21
    s_waitcnt lgkmcnt(2)
    v_mfma_f32_32x32x16_bf16 v[48:63], v[40:43], v[252:255], v[48:63]
    ds_read_b64_tr_b16 v[32:33], v2 offset:512
    ds_read_b64_tr_b16 v[34:35], v2 offset:640
    v_cvt_pk_bf16_f32 v109, v90, v91
    v_mul_f32 v93, v21, v93
    v_add_f32 v17, 1.0, v17
    v_rcp_f32 v16, v16
    v_mfma_f32_32x32x16_bf16 v[64:79], v[44:47], v[252:255], v[64:79]
    v_mul_f32 v94, v16, v94
    v_rcp_f32 v17, v17
    v_cvt_pk_bf16_f32 v110, v92, v93
    v_mul_f32 v95, v17, v95
    v_cvt_pk_bf16_f32 v111, v94, v95
    s_mov_b32 s57, s58
    s_mov_b32 s58, s59
    s_mov_b32 s45, s46
recurrent_scan__sliding_local_dilated__mixer_gmlp__prompt_kernel_S0:
    s_waitcnt lgkmcnt(2)
    v_mfma_f32_32x32x16_bf16 v[80:95], v[24:27], v[112:115], 0
    s_add_u32 s46, s45, 1
    ds_read_b64_tr_b16 v[40:41], v2 offset:1024
    ds_read_b64_tr_b16 v[42:43], v2 offset:1152
    s_waitcnt lgkmcnt(2)
    v_mfma_f32_32x32x16_bf16 v[80:95], v[32:35], v[116:119], v[80:95]
    s_barrier
    ds_read_b64_tr_b16 v[24:25], v2 offset:1536
    ds_read_b64_tr_b16 v[26:27], v2 offset:1664
    v_mul_f32 v48, v9, v48
    v_mul_f32 v49, v9, v49
    v_fma_f32 v16, v48, v48, s63
    v_mul_f32 v50, v9, v50
    v_fma_f32 v17, v49, v49, s63
    v_mul_f32 v16, v16, v48
    v_exp_f32 v16, v16
    s_waitcnt lgkmcnt(2)
    v_mfma_f32_32x32x16_bf16 v[80:95], v[40:43], v[120:123], v[80:95]
    ds_read_b64_tr_b16 v[32:33], v2 offset:2048
    ds_read_b64_tr_b16 v[34:35], v2 offset:2176
    v_mul_f32 v51, v9, v51
    v_fma_f32 v18, v50, v50, s63
    v_mul_f32 v17, v17, v49
    v_exp_f32 v17, v17
    v_mul_f32 v52, v9, v52
    v_add_f32 v16, 1.0, v16
    v_fma_f32 v19, v51, v51, s63
    s_waitcnt lgkmcnt(2)
    v_mfma_f32_32x32x16_bf16 v[80:95], v[24:27], v[124:127], v[80:95]
    ds_read_b64_tr_b16 v[40:41], v2 offset:2560
    ds_read_b64_tr_b16 v[42:43], v2 offset:2688
    v_mul_f32 v18, v18, v50
    v_exp_f32 v18, v18
    v_mul_f32 v53, v9, v53
    v_add_f32 v17, 1.0, v17
    v_fma_f32 v20, v52, v52, s63
    v_rcp_f32 v16, v16
    v_mul_f32 v19, v19, v51
    s_waitcnt lgkmcnt(2)
    v_mfma_f32_32x32x16_bf16 v[80:95], v[32:35], v[128:131], v[80:95]
    ds_read_b64_tr_b16 v[24:25], v2 offset:3072
    ds_read_b64_tr_b16 v[26:27], v2 offset:3200
    v_mul_f32 v48, v16, v48
    v_exp_f32 v19, v19
    v_mul_f32 v54, v9, v54
    v_add_f32 v18, 1.0, v18
    v_fma_f32 v21, v53, v53, s63
    v_rcp_f32 v17, v17
    v_mul_f32 v20, v20, v52
    s_waitcnt lgkmcnt(2)
    v_mfma_f32_32x32x16_bf16 v[80:95], v[40:43], v[132:135], v[80:95]
    ds_read_b64_tr_b16 v[32:33], v2 offset:3584
    ds_read_b64_tr_b16 v[34:35], v2 offset:3712
    v_mul_f32 v49, v17, v49
    v_exp_f32 v20, v20
    v_mul_f32 v55, v9, v55
    v_add_f32 v19, 1.0, v19
    v_fma_f32 v16, v54, v54, s63
    v_rcp_f32 v18, v18
    s_waitcnt lgkmcnt(2)
    v_mfma_f32_32x32x16_bf16 v[80:95], v[24:27], v[136:139], v[80:95]
    ds_read_b64_tr_b16 v[40:41], v2 offset:4096
    ds_read_b64_tr_b16 v[42:43], v2 offset:4224
    v_mul_f32 v21, v21, v53
    v_mul_f32 v50, v18, v50
    v_exp_f32 v21, v21
    v_mul_f32 v56, v9, v56
    v_add_f32 v20, 1.0, v20
    v_fma_f32 v17, v55, v55, s63
    v_rcp_f32 v19, v19
    s_waitcnt lgkmcnt(2)
    v_mfma_f32_32x32x16_bf16 v[80:95], v[32:35], v[140:143], v[80:95]
    ds_read_b64_tr_b16 v[24:25], v2 offset:4608
    ds_read_b64_tr_b16 v[26:27], v2 offset:4736
    v_mul_f32 v16, v16, v54
    v_cvt_pk_bf16_f32 v48, v48, v49
    v_mul_f32 v51, v19, v51
    v_exp_f32 v16, v16
    v_mul_f32 v57, v9, v57
    v_add_f32 v21, 1.0, v21
    v_fma_f32 v18, v56, v56, s63
    s_waitcnt lgkmcnt(2)
    v_mfma_f32_32x32x16_bf16 v[80:95], v[40:43], v[144:147], v[80:95]
    ds_read_b64_tr_b16 v[32:33], v2 offset:5120
    ds_read_b64_tr_b16 v[34:35], v2 offset:5248
    v_rcp_f32 v20, v20
    v_mul_f32 v17, v17, v55
    v_mul_f32 v52, v20, v52
    v_exp_f32 v17, v17
    v_mul_f32 v58, v9, v58
    v_add_f32 v16, 1.0, v16
    v_fma_f32 v19, v57, v57, s63
    s_waitcnt lgkmcnt(2)
    v_mfma_f32_32x32x16_bf16 v[80:95], v[24:27], v[148:151], v[80:95]
    ds_read_b64_tr_b16 v[40:41], v2 offset:5632
    ds_read_b64_tr_b16 v[42:43], v2 offset:5760
    v_rcp_f32 v21, v21
    v_mul_f32 v18, v18, v56
    v_cvt_pk_bf16_f32 v49, v50, v51
    v_mul_f32 v53, v21, v53
    v_exp_f32 v18, v18
    v_mul_f32 v59, v9, v59
    v_add_f32 v17, 1.0, v17
    s_waitcnt lgkmcnt(2)
    v_mfma_f32_32x32x16_bf16 v[80:95], v[32:35], v[152:155], v[80:95]
    ds_read_b64_tr_b16 v[24:25], v2 offset:6144
    ds_read_b64_tr_b16 v[26:27], v2 offset:6272
    v_fma_f32 v20, v58, v58, s63
    v_rcp_f32 v16, v16
    v_mul_f32 v19, v19, v57
    v_mul_f32 v54, v16, v54
    v_exp_f32 v19, v19
    v_mul_f32 v60, v9, v60
    s_waitcnt lgkmcnt(2)
    v_mfma_f32_32x32x16_bf16 v[80:95], v[40:43], v[156:159], v[80:95]
    ds_read_b64_tr_b16 v[32:33], v2 offset:6656
    ds_read_b64_tr_b16 v[34:35], v2 offset:6784
    v_add_f32 v18, 1.0, v18
    v_fma_f32 v21, v59, v59, s63
    v_rcp_f32 v17, v17
    v_mul_f32 v20, v20, v58
    v_cvt_pk_bf16_f32 v50, v52, v53
    v_mul_f32 v55, v17, v55
    v_exp_f32 v20, v20
    s_waitcnt lgkmcnt(2)
    v_mfma_f32_32x32x16_bf16 v[80:95], v[24:27], v[160:163], v[80:95]
    ds_read_b64_tr_b16 v[40:41], v2 offset:7168
    ds_read_b64_tr_b16 v[42:43], v2 offset:7296
    v_mul_f32 v61, v9, v61
    v_add_f32 v19, 1.0, v19
    v_fma_f32 v16, v60, v60, s63
    v_rcp_f32 v18, v18
    v_mul_f32 v21, v21, v59
    v_mul_f32 v56, v18, v56
    v_exp_f32 v21, v21
    s_waitcnt lgkmcnt(2)
    v_mfma_f32_32x32x16_bf16 v[80:95], v[32:35], v[164:167], v[80:95]
    ds_read_b64_tr_b16 v[24:25], v2 offset:7680
    ds_read_b64_tr_b16 v[26:27], v2 offset:7808
    v_mul_f32 v62, v9, v62
    v_add_f32 v20, 1.0, v20
    v_fma_f32 v17, v61, v61, s63
    v_rcp_f32 v19, v19
    v_mul_f32 v16, v16, v60
    v_cvt_pk_bf16_f32 v51, v54, v55
    v_mul_f32 v57, v19, v57
    s_waitcnt lgkmcnt(2)
    v_mfma_f32_32x32x16_bf16 v[80:95], v[40:43], v[168:171], v[80:95]
    ds_read_b64_tr_b16 v[32:33], v2 offset:8192
    ds_read_b64_tr_b16 v[34:35], v2 offset:8320
    v_exp_f32 v16, v16
    v_mul_f32 v63, v9, v63
    v_add_f32 v21, 1.0, v21
    v_fma_f32 v18, v62, v62, s63
    v_rcp_f32 v20, v20
    v_mul_f32 v17, v17, v61
    v_mul_f32 v58, v20, v58
    s_waitcnt lgkmcnt(2)
    v_mfma_f32_32x32x16_bf16 v[80:95], v[24:27], v[172:175], v[80:95]
    ds_read_b64_tr_b16 v[40:41], v2 offset:8704
    ds_read_b64_tr_b16 v[42:43], v2 offset:8832
    v_exp_f32 v17, v17
    v_mul_f32 v64, v9, v64
    v_add_f32 v16, 1.0, v16
    v_fma_f32 v19, v63, v63, s63
    v_rcp_f32 v21, v21
    v_mul_f32 v18, v18, v62
    s_waitcnt lgkmcnt(2)
    v_mfma_f32_32x32x16_bf16 v[80:95], v[32:35], v[176:179], v[80:95]
    ds_read_b64_tr_b16 v[24:25], v2 offset:9216
    ds_read_b64_tr_b16 v[26:27], v2 offset:9344
    v_cvt_pk_bf16_f32 v56, v56, v57
    v_mul_f32 v59, v21, v59
    v_exp_f32 v18, v18
    v_mul_f32 v65, v9, v65
    v_add_f32 v17, 1.0, v17
    v_fma_f32 v20, v64, v64, s63
    v_rcp_f32 v16, v16
    s_waitcnt lgkmcnt(2)
    v_mfma_f32_32x32x16_bf16 v[80:95], v[40:43], v[180:183], v[80:95]
    ds_read_b64_tr_b16 v[32:33], v2 offset:9728
    ds_read_b64_tr_b16 v[34:35], v2 offset:9856
    v_mul_f32 v19, v19, v63
    v_mul_f32 v60, v16, v60
    v_exp_f32 v19, v19
    v_mul_f32 v66, v9, v66
    v_add_f32 v18, 1.0, v18
    v_fma_f32 v21, v65, v65, s63
    v_rcp_f32 v17, v17
    s_waitcnt lgkmcnt(2)
    v_mfma_f32_32x32x16_bf16 v[80:95], v[24:27], v[184:187], v[80:95]
    ds_read_b64_tr_b16 v[40:41], v2 offset:10240
    ds_read_b64_tr_b16 v[42:43], v2 offset:10368
    v_mul_f32 v20, v20, v64
    v_cvt_pk_bf16_f32 v57, v58, v59
    v_mul_f32 v61, v17, v61
    v_exp_f32 v20, v20
    v_mul_f32 v67, v9, v67
    v_add_f32 v19, 1.0, v19
    v_fma_f32 v16, v66, v66, s63
    s_waitcnt lgkmcnt(2)
    v_mfma_f32_32x32x16_bf16 v[80:95], v[32:35], v[188:191], v[80:95]
    ds_read_b64_tr_b16 v[24:25], v2 offset:10752
    ds_read_b64_tr_b16 v[26:27], v2 offset:10880
    v_rcp_f32 v18, v18
    v_mul_f32 v21, v21, v65
    v_mul_f32 v62, v18, v62
    v_exp_f32 v21, v21
    v_mul_f32 v68, v9, v68
    v_add_f32 v20, 1.0, v20
    v_fma_f32 v17, v67, v67, s63
    s_waitcnt lgkmcnt(2)
    v_mfma_f32_32x32x16_bf16 v[80:95], v[40:43], v[192:195], v[80:95]
    ds_read_b64_tr_b16 v[32:33], v2 offset:11264
    ds_read_b64_tr_b16 v[34:35], v2 offset:11392
    v_rcp_f32 v19, v19
    v_mul_f32 v16, v16, v66
    v_cvt_pk_bf16_f32 v58, v60, v61
    v_mul_f32 v63, v19, v63
    v_exp_f32 v16, v16
    v_mul_f32 v69, v9, v69
    v_add_f32 v21, 1.0, v21
    s_waitcnt lgkmcnt(2)
    v_mfma_f32_32x32x16_bf16 v[80:95], v[24:27], v[196:199], v[80:95]
    ds_read_b64_tr_b16 v[40:41], v2 offset:11776
    ds_read_b64_tr_b16 v[42:43], v2 offset:11904
    v_fma_f32 v18, v68, v68, s63
    v_rcp_f32 v20, v20
    v_mul_f32 v17, v17, v67
    v_mul_f32 v64, v20, v64
    v_exp_f32 v17, v17
    v_mul_f32 v70, v9, v70
    s_waitcnt lgkmcnt(2)
    v_mfma_f32_32x32x16_bf16 v[80:95], v[32:35], v[200:203], v[80:95]
    ds_read_b64_tr_b16 v[24:25], v2 offset:12288
    ds_read_b64_tr_b16 v[26:27], v2 offset:12416
    v_add_f32 v16, 1.0, v16
    v_fma_f32 v19, v69, v69, s63
    v_rcp_f32 v21, v21
    v_mul_f32 v18, v18, v68
    v_cvt_pk_bf16_f32 v59, v62, v63
    v_mul_f32 v65, v21, v65
    v_exp_f32 v18, v18
    s_waitcnt lgkmcnt(2)
    v_mfma_f32_32x32x16_bf16 v[80:95], v[40:43], v[204:207], v[80:95]
    ds_read_b64_tr_b16 v[32:33], v2 offset:12800
    ds_read_b64_tr_b16 v[34:35], v2 offset:12928
    v_mul_f32 v71, v9, v71
    v_add_f32 v17, 1.0, v17
    v_fma_f32 v20, v70, v70, s63
    v_rcp_f32 v16, v16
    v_mul_f32 v19, v19, v69
    v_mul_f32 v66, v16, v66
    v_exp_f32 v19, v19
    s_waitcnt lgkmcnt(2)
    v_mfma_f32_32x32x16_bf16 v[80:95], v[24:27], v[208:211], v[80:95]
    ds_read_b64_tr_b16 v[40:41], v2 offset:13312
    ds_read_b64_tr_b16 v[42:43], v2 offset:13440
    v_mul_f32 v72, v9, v72
    v_add_f32 v18, 1.0, v18
    v_fma_f32 v21, v71, v71, s63
    v_rcp_f32 v17, v17
    v_mul_f32 v20, v20, v70
    v_cvt_pk_bf16_f32 v64, v64, v65
    v_mul_f32 v67, v17, v67
    s_waitcnt lgkmcnt(2)
    v_mfma_f32_32x32x16_bf16 v[80:95], v[32:35], v[212:215], v[80:95]
    ds_read_b64_tr_b16 v[24:25], v2 offset:13824
    ds_read_b64_tr_b16 v[26:27], v2 offset:13952
    v_exp_f32 v20, v20
    v_mul_f32 v73, v9, v73
    v_add_f32 v19, 1.0, v19
    v_fma_f32 v16, v72, v72, s63
    v_rcp_f32 v18, v18
    v_mul_f32 v21, v21, v71
    v_mul_f32 v68, v18, v68
    s_waitcnt lgkmcnt(2)
    v_mfma_f32_32x32x16_bf16 v[80:95], v[40:43], v[216:219], v[80:95]
    ds_read_b64_tr_b16 v[32:33], v2 offset:14336
    ds_read_b64_tr_b16 v[34:35], v2 offset:14464
    v_exp_f32 v21, v21
    v_mul_f32 v74, v9, v74
    v_add_f32 v20, 1.0, v20
    v_fma_f32 v17, v73, v73, s63
    v_rcp_f32 v19, v19
    v_mul_f32 v16, v16, v72
    s_waitcnt lgkmcnt(2)
    v_mfma_f32_32x32x16_bf16 v[80:95], v[24:27], v[220:223], v[80:95]
    ds_read_b64_tr_b16 v[40:41], v2 offset:14848
    ds_read_b64_tr_b16 v[42:43], v2 offset:14976
    v_cvt_pk_bf16_f32 v65, v66, v67
    v_mul_f32 v69, v19, v69
    v_exp_f32 v16, v16
    v_mul_f32 v75, v9, v75
    v_add_f32 v21, 1.0, v21
    v_fma_f32 v18, v74, v74, s63
    v_rcp_f32 v20, v20
    s_waitcnt lgkmcnt(2)
    v_mfma_f32_32x32x16_bf16 v[80:95], v[32:35], v[224:227], v[80:95]
    ds_read_b64_tr_b16 v[24:25], v2 offset:15360
    ds_read_b64_tr_b16 v[26:27], v2 offset:15488
    v_mul_f32 v17, v17, v73
    v_mul_f32 v70, v20, v70
    v_exp_f32 v17, v17
    v_mul_f32 v76, v9, v76
    v_add_f32 v16, 1.0, v16
    v_fma_f32 v19, v75, v75, s63
    v_rcp_f32 v21, v21
    s_waitcnt lgkmcnt(2)
    v_mfma_f32_32x32x16_bf16 v[80:95], v[40:43], v[228:231], v[80:95]
    ds_read_b64_tr_b16 v[32:33], v2 offset:15872
    ds_read_b64_tr_b16 v[34:35], v2 offset:16000
    v_mul_f32 v18, v18, v74
    v_cvt_pk_bf16_f32 v66, v68, v69
    v_mul_f32 v71, v21, v71
    v_exp_f32 v18, v18
    v_mul_f32 v77, v9, v77
    v_add_f32 v17, 1.0, v17
    v_fma_f32 v20, v76, v76, s63
    s_waitcnt lgkmcnt(2)
    v_mfma_f32_32x32x16_bf16 v[80:95], v[24:27], v[232:235], v[80:95]
    ds_read_b64_tr_b16 v[40:41], v2 offset:16384
    ds_read_b64_tr_b16 v[42:43], v2 offset:16512
    v_rcp_f32 v16, v16
    v_mul_f32 v19, v19, v75
    v_mul_f32 v72, v16, v72
    v_exp_f32 v19, v19
    v_mul_f32 v78, v9, v78
    v_add_f32 v18, 1.0, v18
    v_fma_f32 v21, v77, v77, s63
    s_waitcnt lgkmcnt(2)
    v_mfma_f32_32x32x16_bf16 v[80:95], v[32:35], v[236:239], v[80:95]
    ds_read_b64_tr_b16 v[24:25], v2 offset:16896
    ds_read_b64_tr_b16 v[26:27], v2 offset:17024
    v_rcp_f32 v17, v17
    v_mul_f32 v20, v20, v76
    v_cvt_pk_bf16_f32 v67, v70, v71
    v_mul_f32 v73, v17, v73
    v_exp_f32 v20, v20
    v_mul_f32 v79, v9, v79
    s_waitcnt lgkmcnt(2)
    v_mfma_f32_32x32x16_bf16 v[80:95], v[40:43], v[240:243], v[80:95]
    ds_read_b64_tr_b16 v[32:33], v2 offset:17408
    ds_read_b64_tr_b16 v[34:35], v2 offset:17536
    v_add_f32 v19, 1.0, v19
    v_fma_f32 v16, v78, v78, s63
    v_rcp_f32 v18, v18
    v_mul_f32 v21, v21, v77
    v_mul_f32 v74, v18, v74
    v_exp_f32 v21, v21
    v_add_f32 v20, 1.0, v20
    s_waitcnt lgkmcnt(2)
    v_mfma_f32_32x32x16_bf16 v[80:95], v[24:27], v[244:247], v[80:95]
    ds_read_b64_tr_b16 v[40:41], v2 offset:17920
    ds_read_b64_tr_b16 v[42:43], v2 offset:18048
    v_fma_f32 v17, v79, v79, s63
    v_rcp_f32 v19, v19
    v_mul_f32 v16, v16, v78
    v_cvt_pk_bf16_f32 v72, v72, v73
    v_mul_f32 v75, v19, v75
    v_exp_f32 v16, v16
    v_add_f32 v21, 1.0, v21
    s_waitcnt lgkmcnt(2)
    v_mfma_f32_32x32x16_bf16 v[80:95], v[32:35], v[248:251], v[80:95]
    s_barrier
    v_rcp_f32 v20, v20
    v_mul_f32 v17, v17, v79
    v_mul_f32 v76, v20, v76
    v_exp_f32 v17, v17
    v_add_f32 v16, 1.0, v16
    v_rcp_f32 v21, v21
    s_waitcnt lgkmcnt(0)
    v_mfma_f32_32x32x16_bf16 v[80:95], v[40:43], v[252:255], v[80:95]
    v_cvt_pk_bf16_f32 v73, v74, v75
    v_mul_f32 v77, v21, v77
    v_add_f32 v17, 1.0, v17
    v_rcp_f32 v16, v16
    s_nop 0
    v_mul_f32 v78, v16, v78
    v_rcp_f32 v17, v17
    v_cvt_pk_bf16_f32 v74, v76, v77
    v_mul_f32 v79, v17, v79
    v_cvt_pk_bf16_f32 v75, v78, v79
    s_mov_b32 s57, s58
    s_mov_b32 s58, s59
    s_mov_b32 s45, s46
    s_cmp_lg_u32 s41, 0
    s_cbranch_scc1 recurrent_scan__sliding_local_dilated__mixer_gmlp__prompt_kernel_zmis
    v_mov_b32 v204, v104
    v_mov_b32 v205, v105
    v_mov_b32 v206, v106
    v_mov_b32 v207, v107
    v_mov_b32 v208, v108
    v_mov_b32 v209, v109
    v_mov_b32 v210, v110
    v_mov_b32 v211, v111
    v_mov_b32 v212, v96
    v_mov_b32 v213, v97
    v_mov_b32 v214, v98
    v_mov_b32 v215, v99
    v_mov_b32 v216, v100
    v_mov_b32 v217, v101
    v_mov_b32 v218, v102
    v_mov_b32 v219, v103
    v_mov_b32 v220, v48
    v_mov_b32 v221, v49
    v_mov_b32 v222, v50
    v_mov_b32 v223, v51
    v_mov_b32 v224, v56
    v_mov_b32 v225, v57
    v_mov_b32 v226, v58
    v_mov_b32 v227, v59
    v_mov_b32 v228, v64
    v_mov_b32 v229, v65
    v_mov_b32 v230, v66
    v_mov_b32 v231, v67
    v_mov_b32 v232, v72
    v_mov_b32 v233, v73
    v_mov_b32 v234, v74
    v_mov_b32 v235, v75
    s_branch recurrent_scan__sliding_local_dilated__mixer_gmlp__prompt_kernel_zdone
recurrent_scan__sliding_local_dilated__mixer_gmlp__prompt_kernel_zmis:
    v_mov_b32 v204, v48
    v_mov_b32 v205, v49
    v_mov_b32 v206, v50
    v_mov_b32 v207, v51
    v_mov_b32 v208, v56
    v_mov_b32 v209, v57
    v_mov_b32 v210, v58
    v_mov_b32 v211, v59
    v_mov_b32 v212, v104
    v_mov_b32 v213, v105
    v_mov_b32 v214, v106
    v_mov_b32 v215, v107
    v_mov_b32 v216, v108
    v_mov_b32 v217, v109
    v_mov_b32 v218, v110
    v_mov_b32 v219, v111
    v_mov_b32 v220, v96
    v_mov_b32 v221, v97
    v_mov_b32 v222, v98
    v_mov_b32 v223, v99
    v_mov_b32 v224, v100
    v_mov_b32 v225, v101
    v_mov_b32 v226, v102
    v_mov_b32 v227, v103
    v_mov_b32 v228, v64
    v_mov_b32 v229, v65
    v_mov_b32 v230, v66
    v_mov_b32 v231, v67
    v_mov_b32 v232, v72
    v_mov_b32 v233, v73
    v_mov_b32 v234, v74
    v_mov_b32 v235, v75
recurrent_scan__sliding_local_dilated__mixer_gmlp__prompt_kernel_zdone:
    v_mul_f32 v80, v9, v80
    v_permlane32_swap_b32 v204, v208
    v_mul_f32 v81, v9, v81
    v_permlane32_swap_b32 v205, v209
    v_fma_f32 v16, v80, v80, s63
    v_mul_f32 v82, v9, v82
    v_permlane32_swap_b32 v206, v210
    v_fma_f32 v17, v81, v81, s63
    v_mul_f32 v16, v16, v80
    v_permlane32_swap_b32 v207, v211
    v_exp_f32 v16, v16
    v_mul_f32 v83, v9, v83
    v_permlane16_swap_b32 v204, v208
    v_fma_f32 v18, v82, v82, s63
    v_mul_f32 v17, v17, v81
    v_permlane16_swap_b32 v205, v209
    v_exp_f32 v17, v17
    v_mul_f32 v84, v9, v84
    v_permlane16_swap_b32 v206, v210
    v_add_f32 v16, 1.0, v16
    v_fma_f32 v19, v83, v83, s63
    v_permlane16_swap_b32 v207, v211
    v_mul_f32 v18, v18, v82
    v_exp_f32 v18, v18
    v_permlane32_swap_b32 v212, v216
    v_mul_f32 v85, v9, v85
    v_permlane32_swap_b32 v213, v217
    v_add_f32 v17, 1.0, v17
    v_fma_f32 v20, v84, v84, s63
    v_permlane32_swap_b32 v214, v218
    v_rcp_f32 v16, v16
    v_mul_f32 v19, v19, v83
    v_permlane32_swap_b32 v215, v219
    v_mul_f32 v80, v16, v80
    v_exp_f32 v19, v19
    v_permlane16_swap_b32 v212, v216
    v_mul_f32 v86, v9, v86
    v_add_f32 v18, 1.0, v18
    v_permlane16_swap_b32 v213, v217
    v_fma_f32 v21, v85, v85, s63
    v_rcp_f32 v17, v17
    v_permlane16_swap_b32 v214, v218
    v_mul_f32 v20, v20, v84
    v_mul_f32 v81, v17, v81
    v_permlane16_swap_b32 v215, v219
    v_exp_f32 v20, v20
    v_mul_f32 v87, v9, v87
    v_permlane32_swap_b32 v220, v224
    v_add_f32 v19, 1.0, v19
    v_permlane32_swap_b32 v221, v225
    v_fma_f32 v16, v86, v86, s63
    v_rcp_f32 v18, v18
    v_permlane32_swap_b32 v222, v226
    v_mul_f32 v21, v21, v85
    v_mul_f32 v82, v18, v82
    v_permlane32_swap_b32 v223, v227
    v_exp_f32 v21, v21
    v_add_f32 v20, 1.0, v20
    v_permlane16_swap_b32 v220, v224
    v_fma_f32 v17, v87, v87, s63
    v_rcp_f32 v19, v19
    v_permlane16_swap_b32 v221, v225
    v_mul_f32 v16, v16, v86
    v_cvt_pk_bf16_f32 v80, v80, v81
    v_permlane16_swap_b32 v222, v226
    v_mul_f32 v83, v19, v83
    v_exp_f32 v16, v16
    v_permlane16_swap_b32 v223, v227
    v_add_f32 v21, 1.0, v21
    v_rcp_f32 v20, v20
    v_permlane32_swap_b32 v228, v232
    v_mul_f32 v17, v17, v87
    v_permlane32_swap_b32 v229, v233
    v_mul_f32 v84, v20, v84
    v_exp_f32 v17, v17
    v_permlane32_swap_b32 v230, v234
    v_add_f32 v16, 1.0, v16
    v_rcp_f32 v21, v21
    v_permlane32_swap_b32 v231, v235
    v_cvt_pk_bf16_f32 v81, v82, v83
    v_mul_f32 v85, v21, v85
    v_permlane16_swap_b32 v228, v232
    v_add_f32 v17, 1.0, v17
    v_rcp_f32 v16, v16
    v_permlane16_swap_b32 v229, v233
    v_mul_f32 v86, v16, v86
    v_rcp_f32 v17, v17
    v_permlane16_swap_b32 v230, v234
    v_cvt_pk_bf16_f32 v82, v84, v85
    v_mul_f32 v87, v17, v87
    v_permlane16_swap_b32 v231, v235
    v_cvt_pk_bf16_f32 v83, v86, v87
    v_mov_b32 v236, v80
    v_mov_b32 v237, v81
    v_mov_b32 v238, v82
    v_mov_b32 v239, v83
    s_nop 0
    v_permlane16_swap_b32 v236, v238
    v_permlane16_swap_b32 v237, v239
    s_branch recurrent_scan__sliding_local_dilated__mixer_gmlp__prompt_kernel_At
recurrent_scan__sliding_local_dilated__mixer_gmlp__prompt_kernel_prod:
    v_mov_b32 v11, 0
    s_cmp_lg_u32 s36, 4
    s_cbranch_scc1 recurrent_scan__sliding_local_dilated__mixer_gmlp__prompt_kernel_nopf1
    s_getpc_b64 s[88:89]
recurrent_scan__sliding_local_dilated__mixer_gmlp__prompt_kernel_pc_1:
    s_sub_u32 s88, s88, recurrent_scan__sliding_local_dilated__mixer_gmlp__prompt_kernel_pc_1-code_begin
    s_subb_u32 s89, s89, 0
    s_mov_b32 s90, code_end-code_begin
    s_mov_b32 s91, 0x00020000
    s_lshr_b32 s92, s2, 3
    s_lshl_b32 s92, s92, 13
    v_lshlrev_b32 v20, 7, v1
    buffer_load_dword v21, v20, s[88:91], s92 offen
recurrent_scan__sliding_local_dilated__mixer_gmlp__prompt_kernel_nopf1:
    s_min_u32 s72, s38, 4
    s_lshl_b32 s42, s38, 1
    s_add_u32 s42, s42, s72
    s_add_u32 s42, s42, 36
    s_lshl_b32 s72, s38, 1
    s_sub_u32 s72, s72, 6
    s_sub_u32 s44, s38, 3
    s_cmp_lt_u32 s38, 4
    s_cselect_b32 s39, 3, 2
    s_cselect_b32 s44, s44, s72
    s_mul_i32 s3, s38, 288
    s_and_b32 s72, s38, 1
    s_lshl_b32 s73, s72, 5
    s_add_u32 s43, s3, s73
    s_sub_u32 s43, s43, 512
    s_xor_b32 s72, s72, 1
    s_lshl_b32 s72, s72, 8
    s_add_u32 s3, s3, s72
    s_add_u32 s72, s38, 1
    s_bfe_u32 s41, s72, 0x10001
    s_mov_b32 s101, 73728
    s_sub_u32 s62, s36, 4
    s_and_b32 s70, s62, 1
    s_mov_b32 s77, 73728
    s_mov_b32 s78, 27648
    v_lshrrev_b32 v18, 2, v1
    v_and_b32 v18, 4, v18
    v_xor_b32 v18, v18, v17
    v_lshlrev_b32 v18, 4, v18
    v_mul_u32_u24 v6, 9216, v16
    v_add_u32 v6, v6, v18
    v_mul_u32_u24 v7, 3456, v16
    v_add_u32 v7, v7, v18
    v_lshlrev_b32 v10, 12, v16
    v_lshl_add_u32 v10, v17, 4, v10
    s_and_b32 s72, s37, 7
    s_mul_i32 s72, s72, 72
    s_mul_i32 s73, s62, 18
    s_add_u32 s72, s72, s73
    v_min_u32 v18, 17, v1
    v_add_u32 v18, s72, v18
    v_mul_u32_u24 v8, 9216, v18
    v_mul_u32_u24 v9, 3456, v18
    s_waitcnt lgkmcnt(0)
    s_mov_b32 s16, s8
    s_mov_b32 s17, s9
    s_mov_b32 s18, 5308416
    s_mov_b32 s19, 0x00020000
    s_mov_b32 s20, s6
    s_mov_b32 s21, s7
    s_mov_b32 s22, 1990656
    s_mov_b32 s23, 0x00020000
    s_mov_b32 s35, 0x00020000
    s_mov_b32 s12, s10
    s_mov_b32 s13, s11
    s_mov_b32 s14, 8388608
    s_mov_b32 s15, 0x00020000
    s_add_u32 s24, s98, 39845888
    s_addc_u32 s25, s99, 0
    s_mov_b32 s26, 8388608
    s_mov_b32 s27, 0x00020000
    s_add_u32 s28, s98, 49283072
    s_addc_u32 s29, s99, 0
    s_mov_b32 s30, 524288
    s_mov_b32 s31, 0x00020000
    s_add_u32 s4, s98, 50331648
    s_addc_u32 s5, s99, 0
    s_mov_b32 s6, 262144
    s_mov_b32 s7, 0x00020000
    s_mov_b32 s8, s96
    s_mov_b32 s9, s97
    s_mov_b32 s10, 256
    s_mov_b32 s11, 0x00020000
    s_add_u32 s64, s98, 51380224
    s_addc_u32 s65, s99, 0
    s_mov_b32 s66, 20480
    s_mov_b32 s67, 0x00020000
    s_lshl_b32 s63, s2, 3
    s_or_b32 s63, s63, s62
    v_mov_b32 v24, 16384
    s_cmp_lg_u32 s63, 0
    s_cbranch_scc1 recurrent_scan__sliding_local_dilated__mixer_gmlp__prompt_kernel_notag
    buffer_load_dword v25, v24, s[64:67], 0 offen sc1
recurrent_scan__sliding_local_dilated__mixer_gmlp__prompt_kernel_notag:
    s_mov_b32 s46, 0
    s_mov_b32 s61, 0
    s_add_u32 s72, s42, s46
    s_lshl_b32 s72, s72, 7
    s_lshl_b32 s73, s46, 7
    s_add_u32 s73, s73, s43
    s_cmp_eq_u32 s46, 4
    s_cselect_b32 s74, 64, -128
    s_mul_i32 s74, s74, s41
    s_add_u32 s73, s73, s74
    s_add_u32 s74, s44, s46
    s_min_u32 s74, s74, 26
    s_lshl_b32 s74, s74, 7
    s_cmp_lt_u32 s46, s39
    s_cselect_b32 s47, s72, s73
    s_cmp_eq_u32 s46, 6
    s_cselect_b32 s47, s3, s47
    s_sub_u32 s72, s46, s39
    s_sub_u32 s73, 4, s39
    s_cmp_ge_u32 s72, s73
    s_cselect_b32 s47, s47, s74
    s_cselect_b64 s[52:53], 0, -1
    s_cselect_b64 s[32:33], s[16:17], s[20:21]
    s_cselect_b32 s34, s18, s22
    s_cselect_b32 s49, s77, s78
    s_cmp_lt_u32 s46, 7
    s_cselect_b32 s47, s47, 0x7f000000
    v_cndmask_b32 v2, v6, v7, s[52:53]
    s_sub_u32 s56, s49, 1024
    s_lshl_b32 s55, s49, 1
    s_mul_i32 s54, s55, s62
    s_add_u32 s54, s54, s47
    s_mul_i32 s55, s55, 4
    v_add_u32 v3, s56, v2
    s_lshl_b32 s72, s62, 11
    s_add_u32 m0, s61, s72
    s_sub_u32 s61, 73728, s61
    s_add_u32 s46, s46, 1
    buffer_load_dwordx4 v2, s[32:35], s54 offen offset:0  lds
    buffer_load_dwordx4 v3, s[32:35], s54 offen offset:1024  lds
    s_add_u32 m0, m0, 8192
    s_add_u32 s54, s54, s55
    buffer_load_dwordx4 v2, s[32:35], s54 offen offset:0  lds
    buffer_load_dwordx4 v3, s[32:35], s54 offen offset:1024  lds
    s_add_u32 m0, m0, 8192
    s_add_u32 s54, s54, s55
    buffer_load_dwordx4 v2, s[32:35], s54 offen offset:0  lds
    buffer_load_dwordx4 v3, s[32:35], s54 offen offset:1024  lds
    s_add_u32 m0, m0, 8192
    s_add_u32 s54, s54, s55
    buffer_load_dwordx4 v2, s[32:35], s54 offen offset:0  lds
    buffer_load_dwordx4 v3, s[32:35], s54 offen offset:1024  lds
    s_add_u32 m0, m0, 8192
    s_add_u32 s54, s54, s55
    buffer_load_dwordx4 v2, s[32:35], s54 offen offset:0  lds
    buffer_load_dwordx4 v3, s[32:35], s54 offen offset:1024  lds
    s_add_u32 m0, m0, 8192
    s_add_u32 s54, s54, s55
    buffer_load_dwordx4 v2, s[32:35], s54 offen offset:0  lds
    buffer_load_dwordx4 v3, s[32:35], s54 offen offset:1024  lds
    s_add_u32 m0, m0, 8192
    s_add_u32 s54, s54, s55
    buffer_load_dwordx4 v2, s[32:35], s54 offen offset:0  lds
    buffer_load_dwordx4 v3, s[32:35], s54 offen offset:1024  lds
    s_add_u32 m0, m0, 8192
    s_add_u32 s54, s54, s55
    buffer_load_dwordx4 v2, s[32:35], s54 offen offset:0  lds
    buffer_load_dwordx4 v3, s[32:35], s54 offen offset:1024  lds
    s_add_u32 m0, m0, 8192
    s_add_u32 s54, s54, s55
    buffer_load_dwordx4 v2, s[32:35], s54 offen offset:0  lds
    buffer_load_dwordx4 v3, s[32:35], s54 offen offset:1024  lds
    s_add_u32 s72, s42, s46
    s_lshl_b32 s72, s72, 7
    s_lshl_b32 s73, s46, 7
    s_add_u32 s73, s73, s43
    s_cmp_eq_u32 s46, 4
    s_cselect_b32 s74, 64, -128
    s_mul_i32 s74, s74, s41
    s_add_u32 s73, s73, s74
    s_add_u32 s74, s44, s46
    s_min_u32 s74, s74, 26
    s_lshl_b32 s74, s74, 7
    s_cmp_lt_u32 s46, s39
    s_cselect_b32 s47, s72, s73
    s_cmp_eq_u32 s46, 6
    s_cselect_b32 s47, s3, s47
    s_sub_u32 s72, s46, s39
    s_sub_u32 s73, 4, s39
    s_cmp_ge_u32 s72, s73
    s_cselect_b32 s47, s47, s74
    s_cselect_b64 s[52:53], 0, -1
    s_cselect_b64 s[32:33], s[16:17], s[20:21]
    s_cselect_b32 s34, s18, s22
    s_cselect_b32 s49, s77, s78
    s_cmp_lt_u32 s46, 7
    s_cselect_b32 s47, s47, 0x7f000000
    v_cndmask_b32 v23, v8, v9, s[52:53]
    buffer_load_dword v14, v23, s[32:35], s47 offen
    s_add_u32 s46, s46, 1
    s_add_u32 s72, s42, s46
    s_lshl_b32 s72, s72, 7
    s_lshl_b32 s73, s46, 7
    s_add_u32 s73, s73, s43
    s_cmp_eq_u32 s46, 4
    s_cselect_b32 s74, 64, -128
    s_mul_i32 s74, s74, s41
    s_add_u32 s73, s73, s74
    s_add_u32 s74, s44, s46
    s_min_u32 s74, s74, 26
    s_lshl_b32 s74, s74, 7
    s_cmp_lt_u32 s46, s39
    s_cselect_b32 s47, s72, s73
    s_cmp_eq_u32 s46, 6
    s_cselect_b32 s47, s3, s47
    s_sub_u32 s72, s46, s39
    s_sub_u32 s73, 4, s39
    s_cmp_ge_u32 s72, s73
    s_cselect_b32 s47, s47, s74
    s_cselect_b64 s[52:53], 0, -1
    s_cselect_b64 s[32:33], s[16:17], s[20:21]
    s_cselect_b32 s34, s18, s22
    s_cselect_b32 s49, s77, s78
    s_cmp_lt_u32 s46, 7
    s_cselect_b32 s47, s47, 0x7f000000
    s_sub_u32 s46, s46, 1
    v_cndmask_b32 v23, v8, v9, s[52:53]
    buffer_load_dword v14, v23, s[32:35], s47 offen
    s_lshl_b32 s68, s38, 19
    s_lshl_b32 s72, s37, 8
    s_add_u32 s68, s68, s72
    s_lshl_b32 s72, s70, 7
    s_add_u32 s68, s68, s72
    s_mov_b32 s69, s68
    s_waitcnt vmcnt(2)
    s_cmp_lg_u32 s63, 0
    s_cbranch_scc1 recurrent_scan__sliding_local_dilated__mixer_gmlp__prompt_kernel_notag2
    v_add_u32 v25, 1, v25
    v_max_u32 v25, 1, v25
    buffer_store_dword v25, v24, s[64:67], 0 offen sc1
recurrent_scan__sliding_local_dilated__mixer_gmlp__prompt_kernel_notag2:
    s_barrier
recurrent_scan__sliding_local_dilated__mixer_gmlp__prompt_kernel_ploop:
    s_cmp_lg_u32 s46, 4
    s_cbranch_scc1 recurrent_scan__sliding_local_dilated__mixer_gmlp__prompt_kernel_nopub_2
    s_cmp_lg_u32 s62, 0
    s_cbranch_scc1 recurrent_scan__sliding_local_dilated__mixer_gmlp__prompt_kernel_nopub_2
    v_lshrrev_b32 v20, 5, v1
    v_and_b32 v21, 31, v1
    v_lshlrev_b32 v20, 12, v20
    v_lshl_add_u32 v20, v21, 3, v20
    v_add_u32 v20, 147456, v20
    ds_read_b64 v[32:33], v20
    ds_read_b64 v[40:41], v20 offset:256
    ds_read_b64 v[36:37], v20 offset:8192
    ds_read_b64 v[42:43], v20 offset:8448
    v_lshlrev_b32 v21, 4, v1
    s_lshl_b32 s72, s37, 4
    s_add_u32 s72, s72, s38
    s_lshl_b32 s72, s72, 11
    v_mov_b32 v34, s100
    v_mov_b32 v35, s100
    v_mov_b32 v38, s100
    v_mov_b32 v39, s100
    s_waitcnt lgkmcnt(0)
    v_add_f32 v32, v32, v40
    v_add_f32 v33, v33, v41
    v_add_f32 v36, v36, v42
    v_add_f32 v37, v37, v43
    buffer_store_dwordx4 v[32:35], v21, s[28:31], s72 offen sc1
    buffer_store_dwordx4 v[36:39], v21, s[28:31], s72 offen offset:1024 sc1
recurrent_scan__sliding_local_dilated__mixer_gmlp__prompt_kernel_nopub_2:
    s_add_u32 s72, s42, s46
    s_lshl_b32 s72, s72, 7
    s_lshl_b32 s73, s46, 7
    s_add_u32 s73, s73, s43
    s_cmp_eq_u32 s46, 4
    s_cselect_b32 s74, 64, -128
    s_mul_i32 s74, s74, s41
    s_add_u32 s73, s73, s74
    s_add_u32 s74, s44, s46
    s_min_u32 s74, s74, 26
    s_lshl_b32 s74, s74, 7
    s_cmp_lt_u32 s46, s39
    s_cselect_b32 s47, s72, s73
    s_cmp_eq_u32 s46, 6
    s_cselect_b32 s47, s3, s47
    s_sub_u32 s72, s46, s39
    s_sub_u32 s73, 4, s39
    s_cmp_ge_u32 s72, s73
    s_cselect_b32 s47, s47, s74
    s_cselect_b64 s[52:53], 0, -1
    s_cselect_b64 s[32:33], s[16:17], s[20:21]
    s_cselect_b32 s34, s18, s22
    s_cselect_b32 s49, s77, s78
    s_cmp_lt_u32 s46, 7
    s_cselect_b32 s47, s47, 0x7f000000
    v_cndmask_b32 v2, v6, v7, s[52:53]
    s_sub_u32 s56, s49, 1024
    s_lshl_b32 s55, s49, 1
    s_mul_i32 s54, s55, s62
    s_add_u32 s54, s54, s47
    s_mul_i32 s55, s55, 4
    v_add_u32 v3, s56, v2
    s_lshl_b32 s72, s62, 11
    s_add_u32 m0, s61, s72
    s_sub_u32 s61, 73728, s61
    s_add_u32 s46, s46, 1
    buffer_load_dwordx4 v2, s[32:35], s54 offen offset:0  lds
    buffer_load_dwordx4 v3, s[32:35], s54 offen offset:1024  lds
    s_add_u32 m0, m0, 8192
    s_add_u32 s54, s54, s55
    buffer_load_dwordx4 v2, s[32:35], s54 offen offset:0  lds
    buffer_load_dwordx4 v3, s[32:35], s54 offen offset:1024  lds
    s_add_u32 m0, m0, 8192
    s_add_u32 s54, s54, s55
    buffer_load_dwordx4 v2, s[32:35], s54 offen offset:0  lds
    buffer_load_dwordx4 v3, s[32:35], s54 offen offset:1024  lds
    s_add_u32 m0, m0, 8192
    s_add_u32 s54, s54, s55
    buffer_load_dwordx4 v2, s[32:35], s54 offen offset:0  lds
    buffer_load_dwordx4 v3, s[32:35], s54 offen offset:1024  lds
    s_add_u32 m0, m0, 8192
    s_add_u32 s54, s54, s55
    buffer_load_dwordx4 v2, s[32:35], s54 offen offset:0  lds
    buffer_load_dwordx4 v3, s[32:35], s54 offen offset:1024  lds
    s_add_u32 m0, m0, 8192
    s_add_u32 s54, s54, s55
    buffer_load_dwordx4 v2, s[32:35], s54 offen offset:0  lds
    buffer_load_dwordx4 v3, s[32:35], s54 offen offset:1024  lds
    s_add_u32 m0, m0, 8192
    s_add_u32 s54, s54, s55
    buffer_load_dwordx4 v2, s[32:35], s54 offen offset:0  lds
    buffer_load_dwordx4 v3, s[32:35], s54 offen offset:1024  lds
    s_add_u32 m0, m0, 8192
    s_add_u32 s54, s54, s55
    buffer_load_dwordx4 v2, s[32:35], s54 offen offset:0  lds
    buffer_load_dwordx4 v3, s[32:35], s54 offen offset:1024  lds
    s_add_u32 m0, m0, 8192
    s_add_u32 s54, s54, s55
    buffer_load_dwordx4 v2, s[32:35], s54 offen offset:0  lds
    buffer_load_dwordx4 v3, s[32:35], s54 offen offset:1024  lds
    s_add_u32 s46, s46, 1
    s_add_u32 s72, s42, s46
    s_lshl_b32 s72, s72, 7
    s_lshl_b32 s73, s46, 7
    s_add_u32 s73, s73, s43
    s_cmp_eq_u32 s46, 4
    s_cselect_b32 s74, 64, -128
    s_mul_i32 s74, s74, s41
    s_add_u32 s73, s73, s74
    s_add_u32 s74, s44, s46
    s_min_u32 s74, s74, 26
    s_lshl_b32 s74, s74, 7
    s_cmp_lt_u32 s46, s39
    s_cselect_b32 s47, s72, s73
    s_cmp_eq_u32 s46, 6
    s_cselect_b32 s47, s3, s47
    s_sub_u32 s72, s46, s39
    s_sub_u32 s73, 4, s39
    s_cmp_ge_u32 s72, s73
    s_cselect_b32 s47, s47, s74
    s_cselect_b64 s[52:53], 0, -1
    s_cselect_b64 s[32:33], s[16:17], s[20:21]
    s_cselect_b32 s34, s18, s22
    s_cselect_b32 s49, s77, s78
    s_cmp_lt_u32 s46, 7
    s_cselect_b32 s47, s47, 0x7f000000
    s_sub_u32 s46, s46, 1
    v_cndmask_b32 v23, v8, v9, s[52:53]
    buffer_load_dword v14, v23, s[32:35], s47 offen
    s_cmp_lg_u32 s46, 2
    s_cbranch_scc1 recurrent_scan__sliding_local_dilated__mixer_gmlp__prompt_kernel_sp_5
    s_cmp_lt_u32 s62, 2
    s_cbranch_scc1 recurrent_scan__sliding_local_dilated__mixer_gmlp__prompt_kernel_s0b
    buffer_load_dwordx4 v[132:135], v10, s[12:15], s69 offen nt
    s_add_u32 s69, s69, 32768
    buffer_load_dwordx4 v[140:143], v10, s[12:15], s69 offen nt
    s_add_u32 s69, s69, 32768
    buffer_load_dwordx4 v[148:151], v10, s[12:15], s69 offen nt
    s_add_u32 s69, s69, 32768
    buffer_load_dwordx4 v[156:159], v10, s[12:15], s69 offen nt
    s_add_u32 s69, s69, 32768
    buffer_load_dwordx4 v[164:167], v10, s[12:15], s69 offen nt
    s_add_u32 s69, s69, 32768
    buffer_load_dwordx4 v[172:175], v10, s[12:15], s69 offen nt
    s_add_u32 s69, s69, 32768
    buffer_load_dwordx4 v[180:183], v10, s[12:15], s69 offen nt
    s_add_u32 s69, s69, 32768
    buffer_load_dwordx4 v[188:191], v10, s[12:15], s69 offen nt
    s_add_u32 s69, s69, 32768
    buffer_load_dwordx4 v[196:199], v10, s[12:15], s69 offen nt
    s_add_u32 s69, s69, 32768
    buffer_load_dwordx4 v[204:207], v10, s[12:15], s69 offen nt
    s_add_u32 s69, s69, 32768
    buffer_load_dwordx4 v[212:215], v10, s[12:15], s69 offen nt
    s_add_u32 s69, s69, 32768
    buffer_load_dwordx4 v[220:223], v10, s[12:15], s69 offen nt
    s_add_u32 s69, s69, 32768
    buffer_load_dwordx4 v[228:231], v10, s[12:15], s69 offen nt
    s_add_u32 s69, s69, 32768
    buffer_load_dwordx4 v[236:239], v10, s[12:15], s69 offen nt
    s_add_u32 s69, s69, 32768
    buffer_load_dwordx4 v[244:247], v10, s[12:15], s69 offen nt
    s_add_u32 s69, s69, 32768
    buffer_load_dwordx4 v[252:255], v10, s[12:15], s69 offen nt
    s_add_u32 s69, s69, 32768
    s_waitcnt vmcnt(17)
    s_branch recurrent_scan__sliding_local_dilated__mixer_gmlp__prompt_kernel_l_3
recurrent_scan__sliding_local_dilated__mixer_gmlp__prompt_kernel_s0b:
    v_mov_b32 v21, 163824
    ds_write_b32 v21, v11
    ds_write_b32 v21, v11 offset:4
    s_waitcnt vmcnt(1) lgkmcnt(0)
    s_cmp_lg_u32 s63, 0
    s_cbranch_scc1 recurrent_scan__sliding_local_dilated__mixer_gmlp__prompt_kernel_l_3
    buffer_store_dword v25, v11, s[8:11], 0 offen sc1
    s_branch recurrent_scan__sliding_local_dilated__mixer_gmlp__prompt_kernel_l_3
recurrent_scan__sliding_local_dilated__mixer_gmlp__prompt_kernel_sp_5:
    s_cmp_lg_u32 s46, 4
    s_cbranch_scc1 recurrent_scan__sliding_local_dilated__mixer_gmlp__prompt_kernel_sp_6
    s_mov_b32 s73, 20000
recurrent_scan__sliding_local_dilated__mixer_gmlp__prompt_kernel_ptag:
    buffer_load_dword v22, v11, s[8:11], 0 offen sc1
    s_waitcnt vmcnt(0)
    v_readfirstlane_b32 s100, v22
    v_mov_b32 v21, 163832
    ds_write_b32 v21, v22
    s_waitcnt lgkmcnt(0)
    s_sub_u32 s73, s73, 1
    s_cmp_eq_u32 s73, 0
    s_cbranch_scc1 recurrent_scan__sliding_local_dilated__mixer_gmlp__prompt_kernel_l_3
    s_cmp_lg_u32 s100, 0
    s_cbranch_scc1 recurrent_scan__sliding_local_dilated__mixer_gmlp__prompt_kernel_l_3
    s_sleep 8
    s_branch recurrent_scan__sliding_local_dilated__mixer_gmlp__prompt_kernel_ptag
recurrent_scan__sliding_local_dilated__mixer_gmlp__prompt_kernel_sp_6:
    s_cmp_lt_u32 s62, 2
    s_cbranch_scc1 recurrent_scan__sliding_local_dilated__mixer_gmlp__prompt_kernel_l_4
    s_cmp_lg_u32 s46, 5
    s_cbranch_scc1 recurrent_scan__sliding_local_dilated__mixer_gmlp__prompt_kernel_sp_7
    v_lshlrev_b32 v128, 16, v132
    v_and_b32 v129, 0xffff0000, v132
    v_lshlrev_b32 v130, 16, v133
    v_and_b32 v131, 0xffff0000, v133
    v_lshlrev_b32 v132, 16, v134
    v_and_b32 v133, 0xffff0000, v134
    v_lshlrev_b32 v134, 16, v135
    v_and_b32 v135, 0xffff0000, v135
    v_lshlrev_b32 v136, 16, v140
    v_and_b32 v137, 0xffff0000, v140
    v_lshlrev_b32 v138, 16, v141
    v_and_b32 v139, 0xffff0000, v141
    v_lshlrev_b32 v140, 16, v142
    v_and_b32 v141, 0xffff0000, v142
    v_lshlrev_b32 v142, 16, v143
    v_and_b32 v143, 0xffff0000, v143
    v_lshlrev_b32 v144, 16, v148
    v_and_b32 v145, 0xffff0000, v148
    v_lshlrev_b32 v146, 16, v149
    v_and_b32 v147, 0xffff0000, v149
    v_lshlrev_b32 v148, 16, v150
    v_and_b32 v149, 0xffff0000, v150
    v_lshlrev_b32 v150, 16, v151
    v_and_b32 v151, 0xffff0000, v151
    v_lshlrev_b32 v152, 16, v156
    v_and_b32 v153, 0xffff0000, v156
    v_lshlrev_b32 v154, 16, v157
    v_and_b32 v155, 0xffff0000, v157
    v_lshlrev_b32 v156, 16, v158
    v_and_b32 v157, 0xffff0000, v158
    v_lshlrev_b32 v158, 16, v159
    v_and_b32 v159, 0xffff0000, v159
    v_lshlrev_b32 v160, 16, v164
    v_and_b32 v161, 0xffff0000, v164
    v_lshlrev_b32 v162, 16, v165
    v_and_b32 v163, 0xffff0000, v165
    v_lshlrev_b32 v164, 16, v166
    v_and_b32 v165, 0xffff0000, v166
    v_lshlrev_b32 v166, 16, v167
    v_and_b32 v167, 0xffff0000, v167
    v_lshlrev_b32 v168, 16, v172
    v_and_b32 v169, 0xffff0000, v172
    v_lshlrev_b32 v170, 16, v173
    v_and_b32 v171, 0xffff0000, v173
    v_lshlrev_b32 v172, 16, v174
    v_and_b32 v173, 0xffff0000, v174
    v_lshlrev_b32 v174, 16, v175
    v_and_b32 v175, 0xffff0000, v175
    v_lshlrev_b32 v176, 16, v180
    v_and_b32 v177, 0xffff0000, v180
    v_lshlrev_b32 v178, 16, v181
    v_and_b32 v179, 0xffff0000, v181
    v_lshlrev_b32 v180, 16, v182
    v_and_b32 v181, 0xffff0000, v182
    v_lshlrev_b32 v182, 16, v183
    v_and_b32 v183, 0xffff0000, v183
    v_lshlrev_b32 v184, 16, v188
    v_and_b32 v185, 0xffff0000, v188
    v_lshlrev_b32 v186, 16, v189
    v_and_b32 v187, 0xffff0000, v189
    v_lshlrev_b32 v188, 16, v190
    v_and_b32 v189, 0xffff0000, v190
    v_lshlrev_b32 v190, 16, v191
    v_and_b32 v191, 0xffff0000, v191
    v_lshlrev_b32 v192, 16, v196
    v_and_b32 v193, 0xffff0000, v196
    v_lshlrev_b32 v194, 16, v197
    v_and_b32 v195, 0xffff0000, v197
    v_lshlrev_b32 v196, 16, v198
    v_and_b32 v197, 0xffff0000, v198
    v_lshlrev_b32 v198, 16, v199
    v_and_b32 v199, 0xffff0000, v199
    v_lshlrev_b32 v200, 16, v204
    v_and_b32 v201, 0xffff0000, v204
    v_lshlrev_b32 v202, 16, v205
    v_and_b32 v203, 0xffff0000, v205
    v_lshlrev_b32 v204, 16, v206
    v_and_b32 v205, 0xffff0000, v206
    v_lshlrev_b32 v206, 16, v207
    v_and_b32 v207, 0xffff0000, v207
    v_lshlrev_b32 v208, 16, v212
    v_and_b32 v209, 0xffff0000, v212
    v_lshlrev_b32 v210, 16, v213
    v_and_b32 v211, 0xffff0000, v213
    v_lshlrev_b32 v212, 16, v214
    v_and_b32 v213, 0xffff0000, v214
    v_lshlrev_b32 v214, 16, v215
    v_and_b32 v215, 0xffff0000, v215
    v_lshlrev_b32 v216, 16, v220
    v_and_b32 v217, 0xffff0000, v220
    v_lshlrev_b32 v218, 16, v221
    v_and_b32 v219, 0xffff0000, v221
    v_lshlrev_b32 v220, 16, v222
    v_and_b32 v221, 0xffff0000, v222
    v_lshlrev_b32 v222, 16, v223
    v_and_b32 v223, 0xffff0000, v223
    v_lshlrev_b32 v224, 16, v228
    v_and_b32 v225, 0xffff0000, v228
    v_lshlrev_b32 v226, 16, v229
    v_and_b32 v227, 0xffff0000, v229
    v_lshlrev_b32 v228, 16, v230
    v_and_b32 v229, 0xffff0000, v230
    v_lshlrev_b32 v230, 16, v231
    v_and_b32 v231, 0xffff0000, v231
    v_lshlrev_b32 v232, 16, v236
    v_and_b32 v233, 0xffff0000, v236
    v_lshlrev_b32 v234, 16, v237
    v_and_b32 v235, 0xffff0000, v237
    v_lshlrev_b32 v236, 16, v238
    v_and_b32 v237, 0xffff0000, v238
    v_lshlrev_b32 v238, 16, v239
    v_and_b32 v239, 0xffff0000, v239
    v_lshlrev_b32 v240, 16, v244
    v_and_b32 v241, 0xffff0000, v244
    v_lshlrev_b32 v242, 16, v245
    v_and_b32 v243, 0xffff0000, v245
    v_lshlrev_b32 v244, 16, v246
    v_and_b32 v245, 0xffff0000, v246
    v_lshlrev_b32 v246, 16, v247
    v_and_b32 v247, 0xffff0000, v247
    v_lshlrev_b32 v248, 16, v252
    v_and_b32 v249, 0xffff0000, v252
    v_lshlrev_b32 v250, 16, v253
    v_and_b32 v251, 0xffff0000, v253
    v_lshlrev_b32 v252, 16, v254
    v_and_b32 v253, 0xffff0000, v254
    v_lshlrev_b32 v254, 16, v255
    v_and_b32 v255, 0xffff0000, v255
    v_lshlrev_b32 v20, 4, v1
    s_lshl_b32 s72, s37, 15
    s_lshl_b32 s73, s70, 10
    s_add_u32 s50, s72, s73
    s_mov_b32 s71, 20000
    s_waitcnt vmcnt(1)
    s_barrier
    s_mov_b32 s72, s50
    buffer_load_dwordx4 v[32:35], v20, s[28:31], s72 offen offset:0
    buffer_load_dwordx4 v[36:39], v20, s[28:31], s72 offen offset:2048
    s_add_u32 s72, s72, 4096
    buffer_load_dwordx4 v[40:43], v20, s[28:31], s72 offen offset:0
    buffer_load_dwordx4 v[44:47], v20, s[28:31], s72 offen offset:2048
    s_add_u32 s72, s72, 4096
    buffer_load_dwordx4 v[48:51], v20, s[28:31], s72 offen offset:0
    buffer_load_dwordx4 v[52:55], v20, s[28:31], s72 offen offset:2048
    s_add_u32 s72, s72, 4096
    buffer_load_dwordx4 v[56:59], v20, s[28:31], s72 offen offset:0
    buffer_load_dwordx4 v[60:63], v20, s[28:31], s72 offen offset:2048
    s_add_u32 s72, s72, 4096
    buffer_load_dwordx4 v[64:67], v20, s[28:31], s72 offen offset:0
    buffer_load_dwordx4 v[68:71], v20, s[28:31], s72 offen offset:2048
    s_add_u32 s72, s72, 4096
    buffer_load_dwordx4 v[72:75], v20, s[28:31], s72 offen offset:0
    buffer_load_dwordx4 v[76:79], v20, s[28:31], s72 offen offset:2048
    s_add_u32 s72, s72, 4096
    buffer_load_dwordx4 v[80:83], v20, s[28:31], s72 offen offset:0
    buffer_load_dwordx4 v[84:87], v20, s[28:31], s72 offen offset:2048
    s_add_u32 s72, s72, 4096
    buffer_load_dwordx4 v[88:91], v20, s[28:31], s72 offen offset:0
    buffer_load_dwordx4 v[92:95], v20, s[28:31], s72 offen offset:2048
    s_add_u32 s72, s72, 4096
    s_barrier
    s_branch recurrent_scan__sliding_local_dilated__mixer_gmlp__prompt_kernel_job
recurrent_scan__sliding_local_dilated__mixer_gmlp__prompt_kernel_sp_7:
recurrent_scan__sliding_local_dilated__mixer_gmlp__prompt_kernel_l_4:
    s_waitcnt vmcnt(1)
recurrent_scan__sliding_local_dilated__mixer_gmlp__prompt_kernel_l_3:
    s_barrier
    s_barrier
    s_cmp_lt_u32 s46, 5
    s_cbranch_scc1 recurrent_scan__sliding_local_dilated__mixer_gmlp__prompt_kernel_ploop
    s_add_u32 s72, s42, s46
    s_lshl_b32 s72, s72, 7
    s_lshl_b32 s73, s46, 7
    s_add_u32 s73, s73, s43
    s_cmp_eq_u32 s46, 4
    s_cselect_b32 s74, 64, -128
    s_mul_i32 s74, s74, s41
    s_add_u32 s73, s73, s74
    s_add_u32 s74, s44, s46
    s_min_u32 s74, s74, 26
    s_lshl_b32 s74, s74, 7
    s_cmp_lt_u32 s46, s39
    s_cselect_b32 s47, s72, s73
    s_cmp_eq_u32 s46, 6
    s_cselect_b32 s47, s3, s47
    s_sub_u32 s72, s46, s39
    s_sub_u32 s73, 4, s39
    s_cmp_ge_u32 s72, s73
    s_cselect_b32 s47, s47, s74
    s_cselect_b64 s[52:53], 0, -1
    s_cselect_b64 s[32:33], s[16:17], s[20:21]
    s_cselect_b32 s34, s18, s22
    s_cselect_b32 s49, s77, s78
    s_cmp_lt_u32 s46, 7
    s_cselect_b32 s47, s47, 0x7f000000
    v_cndmask_b32 v2, v6, v7, s[52:53]
    s_sub_u32 s56, s49, 1024
    s_lshl_b32 s55, s49, 1
    s_mul_i32 s54, s55, s62
    s_add_u32 s54, s54, s47
    s_mul_i32 s55, s55, 2
    v_and_b32 v3, 64, v2
    v_mul_u32_u24 v3, s41, v3
    v_lshl_add_u32 v2, v3, 1, v2
    v_add_u32 v3, s56, v2
    s_lshl_b32 s72, s62, 11
    s_add_u32 m0, s61, s72
    s_sub_u32 s61, 73728, s61
    s_add_u32 s46, s46, 1
    buffer_load_dwordx4 v2, s[32:35], s54 offen offset:0  lds
    buffer_load_dwordx4 v3, s[32:35], s54 offen offset:1024  lds
    s_add_u32 m0, m0, 4096
    s_add_u32 s54, s54, s55
    buffer_load_dwordx4 v2, s[32:35], s54 offen offset:0  lds
    buffer_load_dwordx4 v3, s[32:35], s54 offen offset:1024  lds
    s_add_u32 m0, m0, 4096
    s_add_u32 s54, s54, s55
    buffer_load_dwordx4 v2, s[32:35], s54 offen offset:0  lds
    buffer_load_dwordx4 v3, s[32:35], s54 offen offset:1024  lds
    s_add_u32 m0, m0, 4096
    s_add_u32 s54, s54, s55
    buffer_load_dwordx4 v2, s[32:35], s54 offen offset:0  lds
    buffer_load_dwordx4 v3, s[32:35], s54 offen offset:1024  lds
    s_add_u32 m0, m0, 4096
    s_add_u32 s54, s54, s55
    buffer_load_dwordx4 v2, s[32:35], s54 offen offset:0  lds
    buffer_load_dwordx4 v3, s[32:35], s54 offen offset:1024  lds
    s_add_u32 m0, m0, 4096
    s_add_u32 s54, s54, s55
    buffer_load_dwordx4 v2, s[32:35], s54 offen offset:0  lds
    buffer_load_dwordx4 v3, s[32:35], s54 offen offset:1024  lds
    s_add_u32 m0, m0, 4096
    s_add_u32 s54, s54, s55
    buffer_load_dwordx4 v2, s[32:35], s54 offen offset:0  lds
    buffer_load_dwordx4 v3, s[32:35], s54 offen offset:1024  lds
    s_add_u32 m0, m0, 4096
    s_add_u32 s54, s54, s55
    buffer_load_dwordx4 v2, s[32:35], s54 offen offset:0  lds
    buffer_load_dwordx4 v3, s[32:35], s54 offen offset:1024  lds
    s_add_u32 m0, m0, 4096
    s_add_u32 s54, s54, s55
    buffer_load_dwordx4 v2, s[32:35], s54 offen offset:0  lds
    buffer_load_dwordx4 v3, s[32:35], s54 offen offset:1024  lds
    s_add_u32 m0, m0, 4096
    s_add_u32 s54, s54, s55
    buffer_load_dwordx4 v2, s[32:35], s54 offen offset:0  lds
    buffer_load_dwordx4 v3, s[32:35], s54 offen offset:1024  lds
    s_add_u32 m0, m0, 4096
    s_add_u32 s54, s54, s55
    buffer_load_dwordx4 v2, s[32:35], s54 offen offset:0  lds
    buffer_load_dwordx4 v3, s[32:35], s54 offen offset:1024  lds
    s_add_u32 m0, m0, 4096
    s_add_u32 s54, s54, s55
    buffer_load_dwordx4 v2, s[32:35], s54 offen offset:0  lds
    buffer_load_dwordx4 v3, s[32:35], s54 offen offset:1024  lds
    s_add_u32 m0, m0, 4096
    s_add_u32 s54, s54, s55
    buffer_load_dwordx4 v2, s[32:35], s54 offen offset:0  lds
    buffer_load_dwordx4 v3, s[32:35], s54 offen offset:1024  lds
    s_add_u32 m0, m0, 4096
    s_add_u32 s54, s54, s55
    buffer_load_dwordx4 v2, s[32:35], s54 offen offset:0  lds
    buffer_load_dwordx4 v3, s[32:35], s54 offen offset:1024  lds
    s_add_u32 m0, m0, 4096
    s_add_u32 s54, s54, s55
    buffer_load_dwordx4 v2, s[32:35], s54 offen offset:0  lds
    buffer_load_dwordx4 v3, s[32:35], s54 offen offset:1024  lds
    s_add_u32 m0, m0, 4096
    s_add_u32 s54, s54, s55
    buffer_load_dwordx4 v2, s[32:35], s54 offen offset:0  lds
    buffer_load_dwordx4 v3, s[32:35], s54 offen offset:1024  lds
    s_add_u32 m0, m0, 4096
    s_add_u32 s54, s54, s55
    buffer_load_dwordx4 v2, s[32:35], s54 offen offset:0  lds
    buffer_load_dwordx4 v3, s[32:35], s54 offen offset:1024  lds
    s_add_u32 m0, m0, 4096
    s_add_u32 s54, s54, s55
    buffer_load_dwordx4 v2, s[32:35], s54 offen offset:0  lds
    buffer_load_dwordx4 v3, s[32:35], s54 offen offset:1024  lds
    s_cmp_lg_u32 s62, 0
    s_cbranch_scc1 recurrent_scan__sliding_local_dilated__mixer_gmlp__prompt_kernel_nopf3
    s_getpc_b64 s[88:89]
recurrent_scan__sliding_local_dilated__mixer_gmlp__prompt_kernel_pc_8:
    s_sub_u32 s88, s88, recurrent_scan__sliding_local_dilated__mixer_gmlp__prompt_kernel_pc_8-code_begin
    s_subb_u32 s89, s89, 0
    s_mov_b32 s90, code_end-code_begin
    s_mov_b32 s91, 0x00020000
    s_lshr_b32 s92, s2, 3
    s_lshl_b32 s92, s92, 13
    v_lshlrev_b32 v26, 7, v1
    buffer_load_dword v27, v26, s[88:91], s92 offen
recurrent_scan__sliding_local_dilated__mixer_gmlp__prompt_kernel_nopf3:
    v_lshrrev_b32 v2, 1, v1
    v_mul_u32_u24 v2, 9216, v2
    v_and_b32 v3, 1, v1
    v_lshl_add_u32 v2, v3, 4, v2
    s_mul_i32 s54, s62, 294912
    s_add_u32 s54, s54, s3
    s_lshl_b32 s72, s62, 10
    s_mov_b32 m0, s72
    s_waitcnt vmcnt(0)
    s_barrier
    s_barrier
    buffer_load_dwordx4 v2, s[16:19], s54 offen lds
    s_add_u32 m0, m0, 2048
    s_add_u32 s54, s54, 589824
    buffer_load_dwordx4 v2, s[16:19], s54 offen lds
    s_add_u32 m0, m0, 2048
    s_add_u32 s54, s54, 589824
    buffer_load_dwordx4 v2, s[16:19], s54 offen lds
    s_add_u32 m0, m0, 2048
    s_add_u32 s54, s54, 589824
    buffer_load_dwordx4 v2, s[16:19], s54 offen lds
    s_add_u32 m0, m0, 2048
    s_add_u32 s54, s54, 589824
    buffer_load_dwordx4 v2, s[16:19], s54 offen lds
    s_add_u32 m0, m0, 2048
    s_add_u32 s54, s54, 589824
    buffer_load_dwordx4 v2, s[16:19], s54 offen lds
    s_add_u32 m0, m0, 2048
    s_add_u32 s54, s54, 589824
    buffer_load_dwordx4 v2, s[16:19], s54 offen lds
    s_add_u32 m0, m0, 2048
    s_add_u32 s54, s54, 589824
    buffer_load_dwordx4 v2, s[16:19], s54 offen lds
    s_add_u32 m0, m0, 2048
    s_add_u32 s54, s54, 589824
    buffer_load_dwordx4 v2, s[16:19], s54 offen lds
    s_branch recurrent_scan__sliding_local_dilated__mixer_gmlp__prompt_kernel_Bh
recurrent_scan__sliding_local_dilated__mixer_gmlp__prompt_kernel_job:
    s_mov_b32 s69, 0
    s_branch recurrent_scan__sliding_local_dilated__mixer_gmlp__prompt_kernel_pst_w
recurrent_scan__sliding_local_dilated__mixer_gmlp__prompt_kernel_pst:
    s_cmp_lg_u32 s69, 0
    s_cbranch_scc1 recurrent_scan__sliding_local_dilated__mixer_gmlp__prompt_kernel_d5_9
    s_mov_b32 s69, 1
    s_barrier
    s_barrier
recurrent_scan__sliding_local_dilated__mixer_gmlp__prompt_kernel_d5_9:
    s_sleep 8
    s_mov_b32 s72, s50
    buffer_load_dwordx4 v[32:35], v20, s[28:31], s72 offen offset:0 sc1
    buffer_load_dwordx4 v[36:39], v20, s[28:31], s72 offen offset:2048 sc1
    s_add_u32 s72, s72, 4096
    buffer_load_dwordx4 v[40:43], v20, s[28:31], s72 offen offset:0 sc1
    buffer_load_dwordx4 v[44:47], v20, s[28:31], s72 offen offset:2048 sc1
    s_add_u32 s72, s72, 4096
    buffer_load_dwordx4 v[48:51], v20, s[28:31], s72 offen offset:0 sc1
    buffer_load_dwordx4 v[52:55], v20, s[28:31], s72 offen offset:2048 sc1
    s_add_u32 s72, s72, 4096
    buffer_load_dwordx4 v[56:59], v20, s[28:31], s72 offen offset:0 sc1
    buffer_load_dwordx4 v[60:63], v20, s[28:31], s72 offen offset:2048 sc1
    s_add_u32 s72, s72, 4096
    buffer_load_dwordx4 v[64:67], v20, s[28:31], s72 offen offset:0 sc1
    buffer_load_dwordx4 v[68:71], v20, s[28:31], s72 offen offset:2048 sc1
    s_add_u32 s72, s72, 4096
    buffer_load_dwordx4 v[72:75], v20, s[28:31], s72 offen offset:0 sc1
    buffer_load_dwordx4 v[76:79], v20, s[28:31], s72 offen offset:2048 sc1
    s_add_u32 s72, s72, 4096
    buffer_load_dwordx4 v[80:83], v20, s[28:31], s72 offen offset:0 sc1
    buffer_load_dwordx4 v[84:87], v20, s[28:31], s72 offen offset:2048 sc1
    s_add_u32 s72, s72, 4096
    buffer_load_dwordx4 v[88:91], v20, s[28:31], s72 offen offset:0 sc1
    buffer_load_dwordx4 v[92:95], v20, s[28:31], s72 offen offset:2048 sc1
    s_add_u32 s72, s72, 4096
recurrent_scan__sliding_local_dilated__mixer_gmlp__prompt_kernel_pst_w:
    s_waitcnt vmcnt(0)
    v_xor_b32 v34, s100, v34
    v_xor_b32 v38, s100, v38
    v_xor_b32 v42, s100, v42
    v_xor_b32 v46, s100, v46
    v_xor_b32 v50, s100, v50
    v_xor_b32 v54, s100, v54
    v_xor_b32 v58, s100, v58
    v_xor_b32 v62, s100, v62
    v_xor_b32 v66, s100, v66
    v_xor_b32 v70, s100, v70
    v_xor_b32 v74, s100, v74
    v_xor_b32 v78, s100, v78
    v_xor_b32 v82, s100, v82
    v_xor_b32 v86, s100, v86
    v_xor_b32 v90, s100, v90
    v_xor_b32 v94, s100, v94
    v_or_b32 v34, v34, v38
    v_or_b32 v34, v34, v42
    v_or_b32 v34, v34, v46
    v_or_b32 v34, v34, v50
    v_or_b32 v34, v34, v54
    v_or_b32 v34, v34, v58
    v_or_b32 v34, v34, v62
    v_or_b32 v34, v34, v66
    v_or_b32 v34, v34, v70
    v_or_b32 v34, v34, v74
    v_or_b32 v34, v34, v78
    v_or_b32 v34, v34, v82
    v_or_b32 v34, v34, v86
    v_or_b32 v34, v34, v90
    v_or_b32 v34, v34, v94
    v_cmp_ne_u32 vcc, 0, v34
    s_sub_u32 s71, s71, 1
    s_cmp_eq_u32 s71, 0
    s_cbranch_scc1 recurrent_scan__sliding_local_dilated__mixer_gmlp__prompt_kernel_pst_ok
    s_cmp_lg_u64 vcc, 0
    s_cbranch_scc1 recurrent_scan__sliding_local_dilated__mixer_gmlp__prompt_kernel_pst
recurrent_scan__sliding_local_dilated__mixer_gmlp__prompt_kernel_pst_ok:
    v_lshlrev_b32 v20, 3, v1
    s_lshl_b32 s73, s62, 9
    s_add_u32 s73, s73, 153600
    v_add_u32 v20, s73, v20
    v_lshlrev_b32 v21, 6, v17
    v_add_u32 v21, s73, v21
    s_mov_b32 s72, 0x39e38e39
    s_mov_b32 s74, 0x40088e99
    v_add_f32 v32, v32, v36
    v_add_f32 v33, v33, v37
    v_add_f32 v32, v32, v40
    v_add_f32 v33, v33, v41
    v_add_f32 v32, v32, v44
    v_add_f32 v33, v33, v45
    v_add_f32 v32, v32, v48
    v_add_f32 v33, v33, v49
    v_add_f32 v32, v32, v52
    v_add_f32 v33, v33, v53
    v_add_f32 v32, v32, v56
    v_add_f32 v33, v33, v57
    v_add_f32 v32, v32, v60
    v_add_f32 v33, v33, v61
    v_add_f32 v32, v32, v64
    v_add_f32 v33, v33, v65
    v_add_f32 v32, v32, v68
    v_add_f32 v33, v33, v69
    v_add_f32 v32, v32, v72
    v_add_f32 v33, v33, v73
    v_add_f32 v32, v32, v76
    v_add_f32 v33, v33, v77
    v_add_f32 v32, v32, v80
    v_add_f32 v33, v33, v81
    v_add_f32 v32, v32, v84
    v_add_f32 v33, v33, v85
    v_add_f32 v32, v32, v88
    v_add_f32 v33, v33, v89
    v_add_f32 v32, v32, v92
    v_add_f32 v33, v33, v93
    v_mul_f32 v32, s72, v32
    v_mul_f32 v33, s72, v33
    v_fma_f32 v33, -v32, v32, v33
    v_max_f32 v33, 0, v33
    v_add_f32 v33, 0x361367a4, v33
    v_rsq_f32 v33, v33
    s_nop 0
    v_mul_f32 v33, s74, v33
    ds_write_b64 v20, v[32:33]
    ds_read_b128 v[32:35], v21 offset:0
    ds_read_b128 v[36:39], v21 offset:16
    ds_read_b128 v[40:43], v21 offset:32
    ds_read_b128 v[44:47], v21 offset:48
    s_waitcnt lgkmcnt(0)
    v_mul_f32 v128, v33, v128
    v_mul_f32 v129, v35, v129
    v_mul_f32 v130, v37, v130
    v_mul_f32 v131, v39, v131
    v_mul_f32 v132, v41, v132
    v_mul_f32 v133, v43, v133
    v_mul_f32 v134, v45, v134
    v_mul_f32 v135, v47, v135
    v_cvt_pk_bf16_f32 v128, v128, v129
    v_cvt_pk_bf16_f32 v129, v130, v131
    v_cvt_pk_bf16_f32 v130, v132, v133
    v_cvt_pk_bf16_f32 v131, v134, v135
    v_mul_f32 v136, v33, v136
    v_mul_f32 v137, v35, v137
    v_mul_f32 v138, v37, v138
    v_mul_f32 v139, v39, v139
    v_mul_f32 v140, v41, v140
    v_mul_f32 v141, v43, v141
    v_mul_f32 v142, v45, v142
    v_mul_f32 v143, v47, v143
    v_cvt_pk_bf16_f32 v136, v136, v137
    v_cvt_pk_bf16_f32 v137, v138, v139
    v_cvt_pk_bf16_f32 v138, v140, v141
    v_cvt_pk_bf16_f32 v139, v142, v143
    v_mul_f32 v144, v33, v144
    v_mul_f32 v145, v35, v145
    v_mul_f32 v146, v37, v146
    v_mul_f32 v147, v39, v147
    v_mul_f32 v148, v41, v148
    v_mul_f32 v149, v43, v149
    v_mul_f32 v150, v45, v150
    v_mul_f32 v151, v47, v151
    v_cvt_pk_bf16_f32 v144, v144, v145
    v_cvt_pk_bf16_f32 v145, v146, v147
    v_cvt_pk_bf16_f32 v146, v148, v149
    v_cvt_pk_bf16_f32 v147, v150, v151
    v_mul_f32 v152, v33, v152
    v_mul_f32 v153, v35, v153
    v_mul_f32 v154, v37, v154
    v_mul_f32 v155, v39, v155
    v_mul_f32 v156, v41, v156
    v_mul_f32 v157, v43, v157
    v_mul_f32 v158, v45, v158
    v_mul_f32 v159, v47, v159
    v_cvt_pk_bf16_f32 v152, v152, v153
    v_cvt_pk_bf16_f32 v153, v154, v155
    v_cvt_pk_bf16_f32 v154, v156, v157
    v_cvt_pk_bf16_f32 v155, v158, v159
    v_mul_f32 v160, v33, v160
    v_mul_f32 v161, v35, v161
    v_mul_f32 v162, v37, v162
    v_mul_f32 v163, v39, v163
    v_mul_f32 v164, v41, v164
    v_mul_f32 v165, v43, v165
    v_mul_f32 v166, v45, v166
    v_mul_f32 v167, v47, v167
    v_cvt_pk_bf16_f32 v160, v160, v161
    v_cvt_pk_bf16_f32 v161, v162, v163
    v_cvt_pk_bf16_f32 v162, v164, v165
    v_cvt_pk_bf16_f32 v163, v166, v167
    v_mul_f32 v168, v33, v168
    v_mul_f32 v169, v35, v169
    v_mul_f32 v170, v37, v170
    v_mul_f32 v171, v39, v171
    v_mul_f32 v172, v41, v172
    v_mul_f32 v173, v43, v173
    v_mul_f32 v174, v45, v174
    v_mul_f32 v175, v47, v175
    v_cvt_pk_bf16_f32 v168, v168, v169
    v_cvt_pk_bf16_f32 v169, v170, v171
    v_cvt_pk_bf16_f32 v170, v172, v173
    v_cvt_pk_bf16_f32 v171, v174, v175
    v_mul_f32 v176, v33, v176
    v_mul_f32 v177, v35, v177
    v_mul_f32 v178, v37, v178
    v_mul_f32 v179, v39, v179
    v_mul_f32 v180, v41, v180
    v_mul_f32 v181, v43, v181
    v_mul_f32 v182, v45, v182
    v_mul_f32 v183, v47, v183
    v_cvt_pk_bf16_f32 v176, v176, v177
    v_cvt_pk_bf16_f32 v177, v178, v179
    v_cvt_pk_bf16_f32 v178, v180, v181
    v_cvt_pk_bf16_f32 v179, v182, v183
    v_mul_f32 v184, v33, v184
    v_mul_f32 v185, v35, v185
    v_mul_f32 v186, v37, v186
    v_mul_f32 v187, v39, v187
    v_mul_f32 v188, v41, v188
    v_mul_f32 v189, v43, v189
    v_mul_f32 v190, v45, v190
    v_mul_f32 v191, v47, v191
    v_cvt_pk_bf16_f32 v184, v184, v185
    v_cvt_pk_bf16_f32 v185, v186, v187
    v_cvt_pk_bf16_f32 v186, v188, v189
    v_cvt_pk_bf16_f32 v187, v190, v191
    v_mul_f32 v192, v33, v192
    v_mul_f32 v193, v35, v193
    v_mul_f32 v194, v37, v194
    v_mul_f32 v195, v39, v195
    v_mul_f32 v196, v41, v196
    v_mul_f32 v197, v43, v197
    v_mul_f32 v198, v45, v198
    v_mul_f32 v199, v47, v199
    v_cvt_pk_bf16_f32 v192, v192, v193
    v_cvt_pk_bf16_f32 v193, v194, v195
    v_cvt_pk_bf16_f32 v194, v196, v197
    v_cvt_pk_bf16_f32 v195, v198, v199
    v_mul_f32 v200, v33, v200
    v_mul_f32 v201, v35, v201
    v_mul_f32 v202, v37, v202
    v_mul_f32 v203, v39, v203
    v_mul_f32 v204, v41, v204
    v_mul_f32 v205, v43, v205
    v_mul_f32 v206, v45, v206
    v_mul_f32 v207, v47, v207
    v_cvt_pk_bf16_f32 v200, v200, v201
    v_cvt_pk_bf16_f32 v201, v202, v203
    v_cvt_pk_bf16_f32 v202, v204, v205
    v_cvt_pk_bf16_f32 v203, v206, v207
    v_mul_f32 v208, v33, v208
    v_mul_f32 v209, v35, v209
    v_mul_f32 v210, v37, v210
    v_mul_f32 v211, v39, v211
    v_mul_f32 v212, v41, v212
    v_mul_f32 v213, v43, v213
    v_mul_f32 v214, v45, v214
    v_mul_f32 v215, v47, v215
    v_cvt_pk_bf16_f32 v208, v208, v209
    v_cvt_pk_bf16_f32 v209, v210, v211
    v_cvt_pk_bf16_f32 v210, v212, v213
    v_cvt_pk_bf16_f32 v211, v214, v215
    v_mul_f32 v216, v33, v216
    v_mul_f32 v217, v35, v217
    v_mul_f32 v218, v37, v218
    v_mul_f32 v219, v39, v219
    v_mul_f32 v220, v41, v220
    v_mul_f32 v221, v43, v221
    v_mul_f32 v222, v45, v222
    v_mul_f32 v223, v47, v223
    v_cvt_pk_bf16_f32 v216, v216, v217
    v_cvt_pk_bf16_f32 v217, v218, v219
    v_cvt_pk_bf16_f32 v218, v220, v221
    v_cvt_pk_bf16_f32 v219, v222, v223
    v_mul_f32 v224, v33, v224
    v_mul_f32 v225, v35, v225
    v_mul_f32 v226, v37, v226
    v_mul_f32 v227, v39, v227
    v_mul_f32 v228, v41, v228
    v_mul_f32 v229, v43, v229
    v_mul_f32 v230, v45, v230
    v_mul_f32 v231, v47, v231
    v_cvt_pk_bf16_f32 v224, v224, v225
    v_cvt_pk_bf16_f32 v225, v226, v227
    v_cvt_pk_bf16_f32 v226, v228, v229
    v_cvt_pk_bf16_f32 v227, v230, v231
    v_mul_f32 v232, v33, v232
    v_mul_f32 v233, v35, v233
    v_mul_f32 v234, v37, v234
    v_mul_f32 v235, v39, v235
    v_mul_f32 v236, v41, v236
    v_mul_f32 v237, v43, v237
    v_mul_f32 v238, v45, v238
    v_mul_f32 v239, v47, v239
    v_cvt_pk_bf16_f32 v232, v232, v233
    v_cvt_pk_bf16_f32 v233, v234, v235
    v_cvt_pk_bf16_f32 v234, v236, v237
    v_cvt_pk_bf16_f32 v235, v238, v239
    v_mul_f32 v240, v33, v240
    v_mul_f32 v241, v35, v241
    v_mul_f32 v242, v37, v242
    v_mul_f32 v243, v39, v243
    v_mul_f32 v244, v41, v244
    v_mul_f32 v245, v43, v245
    v_mul_f32 v246, v45, v246
    v_mul_f32 v247, v47, v247
    v_cvt_pk_bf16_f32 v240, v240, v241
    v_cvt_pk_bf16_f32 v241, v242, v243
    v_cvt_pk_bf16_f32 v242, v244, v245
    v_cvt_pk_bf16_f32 v243, v246, v247
    v_mul_f32 v248, v33, v248
    v_mul_f32 v249, v35, v249
    v_mul_f32 v250, v37, v250
    v_mul_f32 v251, v39, v251
    v_mul_f32 v252, v41, v252
    v_mul_f32 v253, v43, v253
    v_mul_f32 v254, v45, v254
    v_mul_f32 v255, v47, v255
    v_cvt_pk_bf16_f32 v248, v248, v249
    v_cvt_pk_bf16_f32 v249, v250, v251
    v_cvt_pk_bf16_f32 v250, v252, v253
    v_cvt_pk_bf16_f32 v251, v254, v255
    s_cmp_lg_u32 s69, 0
    s_cbranch_scc1 recurrent_scan__sliding_local_dilated__mixer_gmlp__prompt_kernel_d5_10
    s_mov_b32 s69, 1
    s_barrier
    s_barrier
recurrent_scan__sliding_local_dilated__mixer_gmlp__prompt_kernel_d5_10:
    buffer_store_dwordx4 v[128:131], v10, s[24:27], s68 offen sc1
    s_add_u32 s68, s68, 32768
    buffer_store_dwordx4 v[136:139], v10, s[24:27], s68 offen sc1
    s_add_u32 s68, s68, 32768
    buffer_store_dwordx4 v[144:147], v10, s[24:27], s68 offen sc1
    s_add_u32 s68, s68, 32768
    buffer_store_dwordx4 v[152:155], v10, s[24:27], s68 offen sc1
    s_add_u32 s68, s68, 32768
    buffer_store_dwordx4 v[160:163], v10, s[24:27], s68 offen sc1
    s_add_u32 s68, s68, 32768
    buffer_store_dwordx4 v[168:171], v10, s[24:27], s68 offen sc1
    s_add_u32 s68, s68, 32768
    buffer_store_dwordx4 v[176:179], v10, s[24:27], s68 offen sc1
    s_add_u32 s68, s68, 32768
    buffer_store_dwordx4 v[184:187], v10, s[24:27], s68 offen sc1
    s_add_u32 s68, s68, 32768
    buffer_store_dwordx4 v[192:195], v10, s[24:27], s68 offen sc1
    s_add_u32 s68, s68, 32768
    buffer_store_dwordx4 v[200:203], v10, s[24:27], s68 offen sc1
    s_add_u32 s68, s68, 32768
    buffer_store_dwordx4 v[208:211], v10, s[24:27], s68 offen sc1
    s_add_u32 s68, s68, 32768
    buffer_store_dwordx4 v[216:219], v10, s[24:27], s68 offen sc1
    s_add_u32 s68, s68, 32768
    buffer_store_dwordx4 v[224:227], v10, s[24:27], s68 offen sc1
    s_add_u32 s68, s68, 32768
    buffer_store_dwordx4 v[232:235], v10, s[24:27], s68 offen sc1
    s_add_u32 s68, s68, 32768
    buffer_store_dwordx4 v[240:243], v10, s[24:27], s68 offen sc1
    s_add_u32 s68, s68, 32768
    buffer_store_dwordx4 v[248:251], v10, s[24:27], s68 offen sc1
    s_add_u32 s68, s68, 32768
    s_lshl_b32 s68, s38, 7
    s_lshl_b32 s73, s37, 3
    s_add_u32 s68, s68, s73
    s_lshl_b32 s73, s70, 2
    s_add_u32 s68, s68, s73
    v_mov_b32 v24, s100
    s_waitcnt vmcnt(0)
    buffer_store_dword v24, v11, s[64:67], s68 offen offset:0 sc1
    s_barrier
    s_barrier
    s_barrier
    v_cvt_pk_bf16_f32 v96, v32, v34
    v_cvt_pk_bf16_f32 v97, v36, v38
    v_cvt_pk_bf16_f32 v98, v40, v42
    v_cvt_pk_bf16_f32 v99, v44, v46
    v_lshlrev_b32 v112, 16, v96
    v_and_b32 v113, 0xffff0000, v96
    v_sub_f32 v112, v32, v112
    v_sub_f32 v113, v34, v113
    v_cvt_pk_bf16_f32 v100, v112, v113
    v_lshlrev_b32 v112, 16, v97
    v_and_b32 v113, 0xffff0000, v97
    v_sub_f32 v112, v36, v112
    v_sub_f32 v113, v38, v113
    v_cvt_pk_bf16_f32 v101, v112, v113
    v_lshlrev_b32 v112, 16, v98
    v_and_b32 v113, 0xffff0000, v98
    v_sub_f32 v112, v40, v112
    v_sub_f32 v113, v42, v113
    v_cvt_pk_bf16_f32 v102, v112, v113
    v_lshlrev_b32 v112, 16, v99
    v_and_b32 v113, 0xffff0000, v99
    v_sub_f32 v112, v44, v112
    v_sub_f32 v113, v46, v113
    v_cvt_pk_bf16_f32 v103, v112, v113
.p2align 3
    v_dot2_f32_bf16 v48, v128, v96, 0
    v_dot2_f32_bf16 v49, v136, v96, 0
    v_dot2_f32_bf16 v48, v128, v100, v48
    v_dot2_f32_bf16 v49, v136, v100, v49
    v_dot2_f32_bf16 v48, v129, v97, v48
    v_dot2_f32_bf16 v49, v137, v97, v49
    v_dot2_f32_bf16 v48, v129, v101, v48
    v_dot2_f32_bf16 v49, v137, v101, v49
    v_dot2_f32_bf16 v48, v130, v98, v48
    v_dot2_f32_bf16 v49, v138, v98, v49
    v_dot2_f32_bf16 v48, v130, v102, v48
    v_dot2_f32_bf16 v49, v138, v102, v49
    v_dot2_f32_bf16 v48, v131, v99, v48
    v_dot2_f32_bf16 v49, v139, v99, v49
    v_dot2_f32_bf16 v48, v131, v103, v48
    v_dot2_f32_bf16 v49, v139, v103, v49
    v_dot2_f32_bf16 v50, v144, v96, 0
    v_dot2_f32_bf16 v51, v152, v96, 0
    v_dot2_f32_bf16 v50, v144, v100, v50
    v_dot2_f32_bf16 v51, v152, v100, v51
    v_dot2_f32_bf16 v50, v145, v97, v50
    v_dot2_f32_bf16 v51, v153, v97, v51
    v_dot2_f32_bf16 v50, v145, v101, v50
    v_dot2_f32_bf16 v51, v153, v101, v51
    v_dot2_f32_bf16 v50, v146, v98, v50
    v_dot2_f32_bf16 v51, v154, v98, v51
    v_dot2_f32_bf16 v50, v146, v102, v50
    v_dot2_f32_bf16 v51, v154, v102, v51
    v_dot2_f32_bf16 v50, v147, v99, v50
    v_dot2_f32_bf16 v51, v155, v99, v51
    v_dot2_f32_bf16 v50, v147, v103, v50
    v_dot2_f32_bf16 v51, v155, v103, v51
    v_dot2_f32_bf16 v52, v160, v96, 0
    v_dot2_f32_bf16 v53, v168, v96, 0
    v_dot2_f32_bf16 v52, v160, v100, v52
    v_dot2_f32_bf16 v53, v168, v100, v53
    v_dot2_f32_bf16 v52, v161, v97, v52
    v_dot2_f32_bf16 v53, v169, v97, v53
    v_dot2_f32_bf16 v52, v161, v101, v52
    v_dot2_f32_bf16 v53, v169, v101, v53
    v_dot2_f32_bf16 v52, v162, v98, v52
    v_dot2_f32_bf16 v53, v170, v98, v53
    v_dot2_f32_bf16 v52, v162, v102, v52
    v_dot2_f32_bf16 v53, v170, v102, v53
    v_dot2_f32_bf16 v52, v163, v99, v52
    v_dot2_f32_bf16 v53, v171, v99, v53
    v_dot2_f32_bf16 v52, v163, v103, v52
    v_dot2_f32_bf16 v53, v171, v103, v53
    v_dot2_f32_bf16 v54, v176, v96, 0
    v_dot2_f32_bf16 v55, v184, v96, 0
    v_dot2_f32_bf16 v54, v176, v100, v54
    v_dot2_f32_bf16 v55, v184, v100, v55
    v_dot2_f32_bf16 v54, v177, v97, v54
    v_dot2_f32_bf16 v55, v185, v97, v55
    v_dot2_f32_bf16 v54, v177, v101, v54
    v_dot2_f32_bf16 v55, v185, v101, v55
    v_dot2_f32_bf16 v54, v178, v98, v54
    v_dot2_f32_bf16 v55, v186, v98, v55
    v_dot2_f32_bf16 v54, v178, v102, v54
    v_dot2_f32_bf16 v55, v186, v102, v55
    v_dot2_f32_bf16 v54, v179, v99, v54
    v_dot2_f32_bf16 v55, v187, v99, v55
    v_dot2_f32_bf16 v54, v179, v103, v54
    v_dot2_f32_bf16 v55, v187, v103, v55
    v_dot2_f32_bf16 v56, v192, v96, 0
    v_dot2_f32_bf16 v57, v200, v96, 0
    v_dot2_f32_bf16 v56, v192, v100, v56
    v_dot2_f32_bf16 v57, v200, v100, v57
    v_dot2_f32_bf16 v56, v193, v97, v56
    v_dot2_f32_bf16 v57, v201, v97, v57
    v_dot2_f32_bf16 v56, v193, v101, v56
    v_dot2_f32_bf16 v57, v201, v101, v57
    v_dot2_f32_bf16 v56, v194, v98, v56
    v_dot2_f32_bf16 v57, v202, v98, v57
    v_dot2_f32_bf16 v56, v194, v102, v56
    v_dot2_f32_bf16 v57, v202, v102, v57
    v_dot2_f32_bf16 v56, v195, v99, v56
    v_dot2_f32_bf16 v57, v203, v99, v57
    v_dot2_f32_bf16 v56, v195, v103, v56
    v_dot2_f32_bf16 v57, v203, v103, v57
    v_dot2_f32_bf16 v58, v208, v96, 0
    v_dot2_f32_bf16 v59, v216, v96, 0
    v_dot2_f32_bf16 v58, v208, v100, v58
    v_dot2_f32_bf16 v59, v216, v100, v59
    v_dot2_f32_bf16 v58, v209, v97, v58
    v_dot2_f32_bf16 v59, v217, v97, v59
    v_dot2_f32_bf16 v58, v209, v101, v58
    v_dot2_f32_bf16 v59, v217, v101, v59
    v_dot2_f32_bf16 v58, v210, v98, v58
    v_dot2_f32_bf16 v59, v218, v98, v59
    v_dot2_f32_bf16 v58, v210, v102, v58
    v_dot2_f32_bf16 v59, v218, v102, v59
    v_dot2_f32_bf16 v58, v211, v99, v58
    v_dot2_f32_bf16 v59, v219, v99, v59
    v_dot2_f32_bf16 v58, v211, v103, v58
    v_dot2_f32_bf16 v59, v219, v103, v59
    v_dot2_f32_bf16 v60, v224, v96, 0
    v_dot2_f32_bf16 v61, v232, v96, 0
    v_dot2_f32_bf16 v60, v224, v100, v60
    v_dot2_f32_bf16 v61, v232, v100, v61
    v_dot2_f32_bf16 v60, v225, v97, v60
    v_dot2_f32_bf16 v61, v233, v97, v61
    v_dot2_f32_bf16 v60, v225, v101, v60
    v_dot2_f32_bf16 v61, v233, v101, v61
    v_dot2_f32_bf16 v60, v226, v98, v60
    v_dot2_f32_bf16 v61, v234, v98, v61
    v_dot2_f32_bf16 v60, v226, v102, v60
    v_dot2_f32_bf16 v61, v234, v102, v61
    v_dot2_f32_bf16 v60, v227, v99, v60
    v_dot2_f32_bf16 v61, v235, v99, v61
    v_dot2_f32_bf16 v60, v227, v103, v60
    v_dot2_f32_bf16 v61, v235, v103, v61
    v_dot2_f32_bf16 v62, v240, v96, 0
    v_dot2_f32_bf16 v63, v248, v96, 0
    v_dot2_f32_bf16 v62, v240, v100, v62
    v_dot2_f32_bf16 v63, v248, v100, v63
    v_dot2_f32_bf16 v62, v241, v97, v62
    v_dot2_f32_bf16 v63, v249, v97, v63
    v_dot2_f32_bf16 v62, v241, v101, v62
    v_dot2_f32_bf16 v63, v249, v101, v63
    v_dot2_f32_bf16 v62, v242, v98, v62
    v_dot2_f32_bf16 v63, v250, v98, v63
    v_dot2_f32_bf16 v62, v242, v102, v62
    v_dot2_f32_bf16 v63, v250, v102, v63
    v_dot2_f32_bf16 v62, v243, v99, v62
    v_dot2_f32_bf16 v63, v251, v99, v63
    v_dot2_f32_bf16 v62, v243, v103, v62
    v_dot2_f32_bf16 v63, v251, v103, v63
    v_add_f32_dpp v48, v48, v48 quad_perm:[1,0,3,2] row_mask:0xf bank_mask:0xf
    v_add_f32_dpp v49, v49, v49 quad_perm:[1,0,3,2] row_mask:0xf bank_mask:0xf
    v_add_f32_dpp v50, v50, v50 quad_perm:[1,0,3,2] row_mask:0xf bank_mask:0xf
    v_add_f32_dpp v51, v51, v51 quad_perm:[1,0,3,2] row_mask:0xf bank_mask:0xf
    v_add_f32_dpp v52, v52, v52 quad_perm:[1,0,3,2] row_mask:0xf bank_mask:0xf
    v_add_f32_dpp v53, v53, v53 quad_perm:[1,0,3,2] row_mask:0xf bank_mask:0xf
    v_add_f32_dpp v54, v54, v54 quad_perm:[1,0,3,2] row_mask:0xf bank_mask:0xf
    v_add_f32_dpp v55, v55, v55 quad_perm:[1,0,3,2] row_mask:0xf bank_mask:0xf
    v_add_f32_dpp v56, v56, v56 quad_perm:[1,0,3,2] row_mask:0xf bank_mask:0xf
    v_add_f32_dpp v57, v57, v57 quad_perm:[1,0,3,2] row_mask:0xf bank_mask:0xf
    v_add_f32_dpp v58, v58, v58 quad_perm:[1,0,3,2] row_mask:0xf bank_mask:0xf
    v_add_f32_dpp v59, v59, v59 quad_perm:[1,0,3,2] row_mask:0xf bank_mask:0xf
    v_add_f32_dpp v60, v60, v60 quad_perm:[1,0,3,2] row_mask:0xf bank_mask:0xf
    v_add_f32_dpp v61, v61, v61 quad_perm:[1,0,3,2] row_mask:0xf bank_mask:0xf
    v_add_f32_dpp v62, v62, v62 quad_perm:[1,0,3,2] row_mask:0xf bank_mask:0xf
    v_add_f32_dpp v63, v63, v63 quad_perm:[1,0,3,2] row_mask:0xf bank_mask:0xf
    v_add_f32_dpp v48, v48, v48 quad_perm:[2,3,0,1] row_mask:0xf bank_mask:0xf
    v_add_f32_dpp v49, v49, v49 quad_perm:[2,3,0,1] row_mask:0xf bank_mask:0xf
    v_add_f32_dpp v50, v50, v50 quad_perm:[2,3,0,1] row_mask:0xf bank_mask:0xf
    v_add_f32_dpp v51, v51, v51 quad_perm:[2,3,0,1] row_mask:0xf bank_mask:0xf
    v_add_f32_dpp v52, v52, v52 quad_perm:[2,3,0,1] row_mask:0xf bank_mask:0xf
    v_add_f32_dpp v53, v53, v53 quad_perm:[2,3,0,1] row_mask:0xf bank_mask:0xf
    v_add_f32_dpp v54, v54, v54 quad_perm:[2,3,0,1] row_mask:0xf bank_mask:0xf
    v_add_f32_dpp v55, v55, v55 quad_perm:[2,3,0,1] row_mask:0xf bank_mask:0xf
    v_add_f32_dpp v56, v56, v56 quad_perm:[2,3,0,1] row_mask:0xf bank_mask:0xf
    v_add_f32_dpp v57, v57, v57 quad_perm:[2,3,0,1] row_mask:0xf bank_mask:0xf
    v_add_f32_dpp v58, v58, v58 quad_perm:[2,3,0,1] row_mask:0xf bank_mask:0xf
    v_add_f32_dpp v59, v59, v59 quad_perm:[2,3,0,1] row_mask:0xf bank_mask:0xf
    v_add_f32_dpp v60, v60, v60 quad_perm:[2,3,0,1] row_mask:0xf bank_mask:0xf
    v_add_f32_dpp v61, v61, v61 quad_perm:[2,3,0,1] row_mask:0xf bank_mask:0xf
    v_add_f32_dpp v62, v62, v62 quad_perm:[2,3,0,1] row_mask:0xf bank_mask:0xf
    v_add_f32_dpp v63, v63, v63 quad_perm:[2,3,0,1] row_mask:0xf bank_mask:0xf
    v_add_f32_dpp v48, v48, v48 row_half_mirror row_mask:0xf bank_mask:0xf
    v_add_f32_dpp v49, v49, v49 row_half_mirror row_mask:0xf bank_mask:0xf
    v_add_f32_dpp v50, v50, v50 row_half_mirror row_mask:0xf bank_mask:0xf
    v_add_f32_dpp v51, v51, v51 row_half_mirror row_mask:0xf bank_mask:0xf
    v_add_f32_dpp v52, v52, v52 row_half_mirror row_mask:0xf bank_mask:0xf
    v_add_f32_dpp v53, v53, v53 row_half_mirror row_mask:0xf bank_mask:0xf
    v_add_f32_dpp v54, v54, v54 row_half_mirror row_mask:0xf bank_mask:0xf
    v_add_f32_dpp v55, v55, v55 row_half_mirror row_mask:0xf bank_mask:0xf
    v_add_f32_dpp v56, v56, v56 row_half_mirror row_mask:0xf bank_mask:0xf
    v_add_f32_dpp v57, v57, v57 row_half_mirror row_mask:0xf bank_mask:0xf
    v_add_f32_dpp v58, v58, v58 row_half_mirror row_mask:0xf bank_mask:0xf
    v_add_f32_dpp v59, v59, v59 row_half_mirror row_mask:0xf bank_mask:0xf
    v_add_f32_dpp v60, v60, v60 row_half_mirror row_mask:0xf bank_mask:0xf
    v_add_f32_dpp v61, v61, v61 row_half_mirror row_mask:0xf bank_mask:0xf
    v_add_f32_dpp v62, v62, v62 row_half_mirror row_mask:0xf bank_mask:0xf
    v_add_f32_dpp v63, v63, v63 row_half_mirror row_mask:0xf bank_mask:0xf
    v_cmp_eq_u32 vcc, 1, v17
    s_nop 1
    v_cndmask_b32 v48, v48, v49, vcc
    v_cndmask_b32 v56, v56, v57, vcc
    v_cmp_eq_u32 vcc, 2, v17
    s_nop 1
    v_cndmask_b32 v48, v48, v50, vcc
    v_cndmask_b32 v56, v56, v58, vcc
    v_cmp_eq_u32 vcc, 3, v17
    s_nop 1
    v_cndmask_b32 v48, v48, v51, vcc
    v_cndmask_b32 v56, v56, v59, vcc
    v_cmp_eq_u32 vcc, 4, v17
    s_nop 1
    v_cndmask_b32 v48, v48, v52, vcc
    v_cndmask_b32 v56, v56, v60, vcc
    v_cmp_eq_u32 vcc, 5, v17
    s_nop 1
    v_cndmask_b32 v48, v48, v53, vcc
    v_cndmask_b32 v56, v56, v61, vcc
    v_cmp_eq_u32 vcc, 6, v17
    s_nop 1
    v_cndmask_b32 v48, v48, v54, vcc
    v_cndmask_b32 v56, v56, v62, vcc
    v_cmp_eq_u32 vcc, 7, v17
    s_nop 1
    v_cndmask_b32 v48, v48, v55, vcc
    v_cndmask_b32 v56, v56, v63, vcc
    v_lshlrev_b32 v20, 2, v16
    v_lshl_add_u32 v20, v17, 5, v20
    s_lshl_b32 s72, s38, 9
    s_lshl_b32 s73, s37, 14
    s_add_u32 s72, s72, s73
    s_lshl_b32 s73, s70, 13
    s_add_u32 s72, s72, s73
    buffer_store_dword v48, v20, s[4:7], s72 offen sc1
    buffer_store_dword v56, v20, s[4:7], s72 offen offset:256 sc1
    s_branch recurrent_scan__sliding_local_dilated__mixer_gmlp__prompt_kernel_Bh
recurrent_scan__sliding_local_dilated__mixer_gmlp__prompt_kernel_At:
    s_load_dwordx4 s[4:7], s[0:1], 48
    s_load_dwordx2 s[8:9], s[0:1], 16
    s_load_dwordx2 s[10:11], s[0:1], 80
    s_and_b32 s40, s2, 7
    s_lshr_b32 s41, s2, 3
    s_and_b32 s37, s40, 1
    s_lshl_b32 s37, s37, 3
    s_and_b32 s42, s41, 7
    s_add_u32 s37, s37, s42
    s_lshr_b32 s38, s40, 1
    s_lshl_b32 s38, s38, 2
    s_lshr_b32 s42, s41, 3
    s_add_u32 s38, s38, s42
    s_and_b32 s39, s38, 1
    s_mul_i32 s60, s38, 18
    s_lshl_b32 s40, s39, 1
    s_add_u32 s61, s60, 16
    s_lshl_b32 s41, s39, 4
    s_sub_u32 s61, s61, s41
    s_add_u32 s60, s60, s40
    s_lshl_b32 s60, s60, 15
    s_lshl_b32 s61, s61, 15
    s_sub_u32 s58, 73728, s101
    v_lshrrev_b32 v176, 4, v1
    v_and_b32 v177, 15, v1
    v_bfe_u32 v178, v1, 2, 2
    v_and_b32 v179, 3, v1
    v_lshl_add_u32 v180, v176, 3, v178
    v_lshlrev_b32 v180, 4, v180
    v_add_u32 v180, 16384, v180
    v_lshrrev_b32 v181, 1, v179
    v_and_b32 v182, 1, v179
    v_lshl_add_u32 v2, v179, 10, v180
    v_lshl_add_u32 v2, v181, 6, v2
    v_lshl_add_u32 v2, v182, 3, v2
    v_xor_b32 v3, 8, v2
    v_mul_u32_u24 v4, 1088, v181
    v_add_u32 v4, v4, v180
    v_xor_b32 v182, v182, v181
    v_lshl_add_u32 v4, v182, 3, v4
    s_lshl_b32 s40, s36, 5
    v_add_u32 v183, s40, v177
    v_and_b32 v184, 7, v1
    v_xor_b32 v184, v184, v176
    v_lshlrev_b32 v184, 4, v184
    v_lshl_add_u32 v5, v183, 7, v184
    v_xor_b32 v6, 64, v5
    v_add_u32 v240, s58, v5
    v_add_u32 v241, s58, v6
    v_add_u32 v242, s58, v2
    v_add_u32 v243, s58, v3
    v_add_u32 v244, s58, v4
    v_add_u32 v5, s101, v5
    v_add_u32 v6, s101, v6
    v_add_u32 v2, s101, v2
    v_add_u32 v3, s101, v3
    v_add_u32 v4, s101, v4
    s_lshl_b32 s41, s37, 7
    v_add_u32 v185, s41, v183
    v_lshlrev_b32 v7, 4, v185
    v_lshrrev_b32 v184, 1, v176
    v_lshl_add_u32 v8, v184, 15, v7
    v_and_b32 v186, 1, v176
    v_lshl_add_u32 v8, v186, 3, v8
    v_lshl_add_u32 v7, v176, 15, v7
    v_lshlrev_b32 v10, 2, v183
    v_add_u32 v10, 147456, v10
    s_lshl_b32 s99, s37, 8
    s_lshl_b32 s40, s38, 4
    s_add_u32 s99, s99, s40
    s_lshl_b32 s40, s36, 2
    s_add_u32 s99, s99, s40
    s_add_u32 s99, s99, 8192
    v_mov_b32 v20, 0
    v_mov_b32 v21, 0
    v_mov_b32 v22, 0
    v_mov_b32 v23, 0
    v_mov_b32 v24, 0
    v_mov_b32 v25, 0
    v_mov_b32 v26, 0
    v_mov_b32 v27, 0
    v_mov_b32 v28, 0
    v_mov_b32 v29, 0
    v_mov_b32 v30, 0
    v_mov_b32 v31, 0
    v_mov_b32 v32, 0
    v_mov_b32 v33, 0
    v_mov_b32 v34, 0
    v_mov_b32 v35, 0
    v_mov_b32 v36, 0
    v_mov_b32 v37, 0
    v_mov_b32 v38, 0
    v_mov_b32 v39, 0
    v_mov_b32 v40, 0
    v_mov_b32 v41, 0
    v_mov_b32 v42, 0
    v_mov_b32 v43, 0
    v_mov_b32 v44, 0
    v_mov_b32 v45, 0
    v_mov_b32 v46, 0
    v_mov_b32 v47, 0
    v_mov_b32 v48, 0
    v_mov_b32 v49, 0
    v_mov_b32 v50, 0
    v_mov_b32 v51, 0
    v_mov_b32 v52, 0
    v_mov_b32 v53, 0
    v_mov_b32 v54, 0
    v_mov_b32 v55, 0
    v_mov_b32 v56, 0
    v_mov_b32 v57, 0
    v_mov_b32 v58, 0
    v_mov_b32 v59, 0
    s_and_b32 s70, s2, 7
    s_mul_i32 s70, s70, 294912
    s_lshr_b32 s71, s2, 3
    s_lshl_b32 s71, s71, 10
    s_add_u32 s70, s70, s71
    s_mul_i32 s71, s36, 9
    s_lshr_b32 s71, s71, 2
    s_add_u32 s71, s71, 288
    s_lshl_b32 s71, s71, 15
    s_add_u32 s70, s70, s71
    v_lshlrev_b32 v245, 4, v1
    s_mul_i32 s75, s36, 12288
    s_add_u32 s75, s75, s58
    s_add_u32 s75, s75, 32
    v_add_u32 v246, s75, v245
    s_lshr_b32 s74, s2, 3
    s_lshl_b32 s74, s74, 6
    v_add_u32 v16, s74, v1
    v_mov_b32 v17, 0xff800000
    v_cmp_le_u32 s[42:43], 2, v16
    v_cmp_le_u32 s[44:45], 4, v16
    v_cmp_le_u32 s[46:47], 6, v16
    v_cmp_le_u32 s[48:49], 8, v16
    v_cmp_le_u32 s[50:51], 10, v16
    v_cmp_le_u32 s[52:53], 12, v16
    v_cmp_le_u32 s[54:55], 14, v16
    s_mov_b32 s74, 0x3fc62901
    s_mov_b32 s75, 0xbeeff558
    s_mov_b32 s56, 8
    s_waitcnt lgkmcnt(0)
    s_add_u32 s20, s10, 27262976
    s_addc_u32 s21, s11, 0
    s_mov_b32 s22, 11796480
    s_mov_b32 s23, 0x00020000
    s_add_u32 s64, s10, 51380224
    s_addc_u32 s65, s11, 0
    s_mov_b32 s66, 20480
    s_mov_b32 s67, 0x00020000
    v_mov_b32 v18, 163824
    v_readfirstlane_b32 s100, v14
    s_mov_b32 s59, 320000
recurrent_scan__sliding_local_dilated__mixer_gmlp__prompt_kernel_kvw:
    ds_read_b64 v[184:185], v18
    s_waitcnt lgkmcnt(0)
    v_xor_b32 v184, s100, v184
    v_xor_b32 v185, s100, v185
    v_or_b32 v184, v184, v185
    s_sub_u32 s59, s59, 1
    v_readfirstlane_b32 s57, v184
    s_cmp_eq_u32 s59, 0
    s_cbranch_scc1 recurrent_scan__sliding_local_dilated__mixer_gmlp__prompt_kernel_kvd
    s_cmp_lg_u32 s57, 0
    s_cbranch_scc1 recurrent_scan__sliding_local_dilated__mixer_gmlp__prompt_kernel_kvw
recurrent_scan__sliding_local_dilated__mixer_gmlp__prompt_kernel_kvd:
    ds_read_b128 v[184:187], v246 offset:8160
    ds_read_b128 v[188:191], v246 offset:9184
    ds_read_b128 v[192:195], v246 offset:10208
    ds_read_b128 v[88:91], v246 offset:224
    ds_read_b128 v[92:95], v246 offset:1504
    ds_read_b128 v[96:99], v246 offset:2784
    ds_read_b128 v[100:103], v246 offset:192
    ds_read_b128 v[104:107], v246 offset:1472
    ds_read_b128 v[108:111], v246 offset:2752
    ds_read_b128 v[112:115], v246 offset:160
    ds_read_b128 v[116:119], v246 offset:1440
    ds_read_b128 v[120:123], v246 offset:2720
    ds_read_b128 v[124:127], v246 offset:128
    ds_read_b128 v[128:131], v246 offset:1408
    ds_read_b128 v[132:135], v246 offset:2688
    ds_read_b128 v[136:139], v246 offset:96
    ds_read_b128 v[140:143], v246 offset:1376
    ds_read_b128 v[144:147], v246 offset:2656
    ds_read_b128 v[148:151], v246 offset:64
    ds_read_b128 v[152:155], v246 offset:1344
    ds_read_b128 v[156:159], v246 offset:2624
    ds_read_b128 v[160:163], v246 offset:32
    ds_read_b128 v[164:167], v246 offset:1312
    ds_read_b128 v[168:171], v246 offset:2592
    ds_read_b128 v[172:175], v246 offset:0
    ds_read_b128 v[176:179], v246 offset:1280
    ds_read_b128 v[180:183], v246 offset:2560
    s_cmp_lg_u32 s36, 0
    s_cbranch_scc1 recurrent_scan__sliding_local_dilated__mixer_gmlp__prompt_kernel_at1
    s_waitcnt lgkmcnt(15)
.p2align 3
    v_dot2_f32_bf16 v196, v184, v88, 0
    v_dot2_f32_bf16 v197, v184, v100, 0
    v_dot2_f32_bf16 v196, v185, v89, v196
    v_dot2_f32_bf16 v197, v185, v101, v197
    v_dot2_f32_bf16 v196, v186, v90, v196
    v_dot2_f32_bf16 v197, v186, v102, v197
    v_dot2_f32_bf16 v196, v187, v91, v196
    v_dot2_f32_bf16 v197, v187, v103, v197
    v_dot2_f32_bf16 v196, v188, v92, v196
    v_dot2_f32_bf16 v197, v188, v104, v197
    v_dot2_f32_bf16 v196, v189, v93, v196
    v_dot2_f32_bf16 v197, v189, v105, v197
    v_dot2_f32_bf16 v196, v190, v94, v196
    v_dot2_f32_bf16 v197, v190, v106, v197
    v_dot2_f32_bf16 v196, v191, v95, v196
    v_dot2_f32_bf16 v197, v191, v107, v197
    v_dot2_f32_bf16 v196, v192, v96, v196
    v_dot2_f32_bf16 v197, v192, v108, v197
    s_waitcnt lgkmcnt(12)
.p2align 3
    v_dot2_f32_bf16 v198, v184, v112, 0
    v_dot2_f32_bf16 v199, v184, v124, 0
    v_dot2_f32_bf16 v198, v185, v113, v198
    v_dot2_f32_bf16 v199, v185, v125, v199
    v_dot2_f32_bf16 v198, v186, v114, v198
    v_dot2_f32_bf16 v199, v186, v126, v199
    v_dot2_f32_bf16 v198, v187, v115, v198
    v_dot2_f32_bf16 v199, v187, v127, v199
    v_dot2_f32_bf16 v198, v188, v116, v198
    v_dot2_f32_bf16 v199, v188, v128, v199
    v_dot2_f32_bf16 v198, v189, v117, v198
    v_dot2_f32_bf16 v199, v189, v129, v199
    v_dot2_f32_bf16 v198, v190, v118, v198
    v_dot2_f32_bf16 v199, v190, v130, v199
    v_dot2_f32_bf16 v198, v191, v119, v198
    v_dot2_f32_bf16 v199, v191, v131, v199
    v_dot2_f32_bf16 v198, v192, v120, v198
    v_dot2_f32_bf16 v199, v192, v132, v199
    s_waitcnt lgkmcnt(6)
.p2align 3
    v_dot2_f32_bf16 v200, v184, v136, 0
    v_dot2_f32_bf16 v201, v184, v148, 0
    v_dot2_f32_bf16 v200, v185, v137, v200
    v_dot2_f32_bf16 v201, v185, v149, v201
    v_dot2_f32_bf16 v200, v186, v138, v200
    v_dot2_f32_bf16 v201, v186, v150, v201
    v_dot2_f32_bf16 v200, v187, v139, v200
    v_dot2_f32_bf16 v201, v187, v151, v201
    v_dot2_f32_bf16 v200, v188, v140, v200
    v_dot2_f32_bf16 v201, v188, v152, v201
    v_dot2_f32_bf16 v200, v189, v141, v200
    v_dot2_f32_bf16 v201, v189, v153, v201
    v_dot2_f32_bf16 v200, v190, v142, v200
    v_dot2_f32_bf16 v201, v190, v154, v201
    v_dot2_f32_bf16 v200, v191, v143, v200
    v_dot2_f32_bf16 v201, v191, v155, v201
    v_dot2_f32_bf16 v200, v192, v144, v200
    v_dot2_f32_bf16 v201, v192, v156, v201
    s_waitcnt lgkmcnt(0)
.p2align 3
    v_dot2_f32_bf16 v202, v184, v160, 0
    v_dot2_f32_bf16 v203, v184, v172, 0
    v_dot2_f32_bf16 v202, v185, v161, v202
    v_dot2_f32_bf16 v203, v185, v173, v203
    v_dot2_f32_bf16 v202, v186, v162, v202
    v_dot2_f32_bf16 v203, v186, v174, v203
    v_dot2_f32_bf16 v202, v187, v163, v202
    v_dot2_f32_bf16 v203, v187, v175, v203
    v_dot2_f32_bf16 v202, v188, v164, v202
    v_dot2_f32_bf16 v203, v188, v176, v203
    v_dot2_f32_bf16 v202, v189, v165, v202
    v_dot2_f32_bf16 v203, v189, v177, v203
    v_dot2_f32_bf16 v202, v190, v166, v202
    v_dot2_f32_bf16 v203, v190, v178, v203
    v_dot2_f32_bf16 v202, v191, v167, v202
    v_dot2_f32_bf16 v203, v191, v179, v203
    v_dot2_f32_bf16 v202, v192, v168, v202
    v_dot2_f32_bf16 v203, v192, v180, v203
    ds_read_b128 v[88:91], v246 offset:4320
    ds_read_b128 v[92:95], v246 offset:5600
    ds_read_b128 v[96:99], v246 offset:6880
    ds_read_b128 v[100:103], v246 offset:4288
    ds_read_b128 v[104:107], v246 offset:5568
    ds_read_b128 v[108:111], v246 offset:6848
    ds_read_b128 v[112:115], v246 offset:4256
    ds_read_b128 v[116:119], v246 offset:5536
    ds_read_b128 v[120:123], v246 offset:6816
    ds_read_b128 v[124:127], v246 offset:4224
    ds_read_b128 v[128:131], v246 offset:5504
    ds_read_b128 v[132:135], v246 offset:6784
    ds_read_b128 v[136:139], v246 offset:4192
    ds_read_b128 v[140:143], v246 offset:5472
    ds_read_b128 v[144:147], v246 offset:6752
    ds_read_b128 v[148:151], v246 offset:4160
    ds_read_b128 v[152:155], v246 offset:5440
    ds_read_b128 v[156:159], v246 offset:6720
    ds_read_b128 v[160:163], v246 offset:4128
    ds_read_b128 v[164:167], v246 offset:5408
    ds_read_b128 v[168:171], v246 offset:6688
    ds_read_b128 v[172:175], v246 offset:4096
    ds_read_b128 v[176:179], v246 offset:5376
    ds_read_b128 v[180:183], v246 offset:6656
    v_cndmask_b32 v197, v17, v197, s[42:43]
    v_cndmask_b32 v198, v17, v198, s[44:45]
    v_cndmask_b32 v199, v17, v199, s[46:47]
    v_cndmask_b32 v200, v17, v200, s[48:49]
    v_cndmask_b32 v201, v17, v201, s[50:51]
    v_cndmask_b32 v202, v17, v202, s[52:53]
    v_cndmask_b32 v203, v17, v203, s[54:55]
    v_max3_f32 v18, v196, v197, v198
    v_max3_f32 v18, v18, v199, v200
    v_max3_f32 v18, v18, v201, v202
    v_max_f32 v18, v18, v203
    v_sub_f32 v196, v196, v18
    v_sub_f32 v197, v197, v18
    v_sub_f32 v198, v198, v18
    v_sub_f32 v199, v199, v18
    v_sub_f32 v200, v200, v18
    v_sub_f32 v201, v201, v18
    v_sub_f32 v202, v202, v18
    v_sub_f32 v203, v203, v18
    v_mul_f32 v196, s74, v196
    v_mul_f32 v197, s74, v197
    v_mul_f32 v198, s74, v198
    v_mul_f32 v199, s74, v199
    v_mul_f32 v200, s74, v200
    v_mul_f32 v201, s74, v201
    v_mul_f32 v202, s74, v202
    v_mul_f32 v203, s74, v203
    v_exp_f32 v196, v196
    v_exp_f32 v197, v197
    v_exp_f32 v198, v198
    v_exp_f32 v199, v199
    v_exp_f32 v200, v200
    v_exp_f32 v201, v201
    v_exp_f32 v202, v202
    v_exp_f32 v203, v203
    v_cvt_pk_bf16_f32 v196, v196, 0
    v_cvt_pk_bf16_f32 v197, v197, 0
    v_cvt_pk_bf16_f32 v198, v198, 0
    v_cvt_pk_bf16_f32 v199, v199, 0
    v_cvt_pk_bf16_f32 v200, v200, 0
    v_cvt_pk_bf16_f32 v201, v201, 0
    v_cvt_pk_bf16_f32 v202, v202, 0
    v_cvt_pk_bf16_f32 v203, v203, 0
    v_lshlrev_b32 v60, 16, v196
    v_lshlrev_b32 v61, 16, v197
    v_lshlrev_b32 v62, 16, v198
    v_lshlrev_b32 v63, 16, v199
    v_lshlrev_b32 v64, 16, v200
    v_lshlrev_b32 v65, 16, v201
    v_lshlrev_b32 v66, 16, v202
    v_lshlrev_b32 v67, 16, v203
    v_add_f32 v19, v60, v61
    v_add_f32 v19, v19, v62
    v_add_f32 v19, v19, v63
    v_add_f32 v19, v19, v64
    v_add_f32 v19, v19, v65
    v_add_f32 v19, v19, v66
    v_add_f32 v19, v19, v67
    v_mul_f32 v19, s75, v19
    v_rcp_f32 v19, v19
    s_waitcnt lgkmcnt(15)
.p2align 3
    v_dot2_f32_bf16 v68, v88, v196, 0
    v_dot2_f32_bf16 v69, v88, v60, 0
    v_dot2_f32_bf16 v70, v89, v196, 0
    v_dot2_f32_bf16 v71, v89, v60, 0
    v_dot2_f32_bf16 v72, v90, v196, 0
    v_dot2_f32_bf16 v73, v90, v60, 0
    v_dot2_f32_bf16 v74, v91, v196, 0
    v_dot2_f32_bf16 v75, v91, v60, 0
    v_dot2_f32_bf16 v76, v92, v196, 0
    v_dot2_f32_bf16 v77, v92, v60, 0
    v_dot2_f32_bf16 v78, v93, v196, 0
    v_dot2_f32_bf16 v79, v93, v60, 0
    v_dot2_f32_bf16 v80, v94, v196, 0
    v_dot2_f32_bf16 v81, v94, v60, 0
    v_dot2_f32_bf16 v82, v95, v196, 0
    v_dot2_f32_bf16 v83, v95, v60, 0
    v_dot2_f32_bf16 v84, v96, v196, 0
    v_dot2_f32_bf16 v85, v96, v60, 0
    v_dot2_f32_bf16 v68, v100, v197, v68
    v_dot2_f32_bf16 v69, v100, v61, v69
    v_dot2_f32_bf16 v70, v101, v197, v70
    v_dot2_f32_bf16 v71, v101, v61, v71
    v_dot2_f32_bf16 v72, v102, v197, v72
    v_dot2_f32_bf16 v73, v102, v61, v73
    v_dot2_f32_bf16 v74, v103, v197, v74
    v_dot2_f32_bf16 v75, v103, v61, v75
    v_dot2_f32_bf16 v76, v104, v197, v76
    v_dot2_f32_bf16 v77, v104, v61, v77
    v_dot2_f32_bf16 v78, v105, v197, v78
    v_dot2_f32_bf16 v79, v105, v61, v79
    v_dot2_f32_bf16 v80, v106, v197, v80
    v_dot2_f32_bf16 v81, v106, v61, v81
    v_dot2_f32_bf16 v82, v107, v197, v82
    v_dot2_f32_bf16 v83, v107, v61, v83
    v_dot2_f32_bf16 v84, v108, v197, v84
    v_dot2_f32_bf16 v85, v108, v61, v85
    s_waitcnt lgkmcnt(12)
.p2align 3
    v_dot2_f32_bf16 v68, v112, v198, v68
    v_dot2_f32_bf16 v69, v112, v62, v69
    v_dot2_f32_bf16 v70, v113, v198, v70
    v_dot2_f32_bf16 v71, v113, v62, v71
    v_dot2_f32_bf16 v72, v114, v198, v72
    v_dot2_f32_bf16 v73, v114, v62, v73
    v_dot2_f32_bf16 v74, v115, v198, v74
    v_dot2_f32_bf16 v75, v115, v62, v75
    v_dot2_f32_bf16 v76, v116, v198, v76
    v_dot2_f32_bf16 v77, v116, v62, v77
    v_dot2_f32_bf16 v78, v117, v198, v78
    v_dot2_f32_bf16 v79, v117, v62, v79
    v_dot2_f32_bf16 v80, v118, v198, v80
    v_dot2_f32_bf16 v81, v118, v62, v81
    v_dot2_f32_bf16 v82, v119, v198, v82
    v_dot2_f32_bf16 v83, v119, v62, v83
    v_dot2_f32_bf16 v84, v120, v198, v84
    v_dot2_f32_bf16 v85, v120, v62, v85
    v_dot2_f32_bf16 v68, v124, v199, v68
    v_dot2_f32_bf16 v69, v124, v63, v69
    v_dot2_f32_bf16 v70, v125, v199, v70
    v_dot2_f32_bf16 v71, v125, v63, v71
    v_dot2_f32_bf16 v72, v126, v199, v72
    v_dot2_f32_bf16 v73, v126, v63, v73
    v_dot2_f32_bf16 v74, v127, v199, v74
    v_dot2_f32_bf16 v75, v127, v63, v75
    v_dot2_f32_bf16 v76, v128, v199, v76
    v_dot2_f32_bf16 v77, v128, v63, v77
    v_dot2_f32_bf16 v78, v129, v199, v78
    v_dot2_f32_bf16 v79, v129, v63, v79
    v_dot2_f32_bf16 v80, v130, v199, v80
    v_dot2_f32_bf16 v81, v130, v63, v81
    v_dot2_f32_bf16 v82, v131, v199, v82
    v_dot2_f32_bf16 v83, v131, v63, v83
    v_dot2_f32_bf16 v84, v132, v199, v84
    v_dot2_f32_bf16 v85, v132, v63, v85
    s_waitcnt lgkmcnt(6)
.p2align 3
    v_dot2_f32_bf16 v68, v136, v200, v68
    v_dot2_f32_bf16 v69, v136, v64, v69
    v_dot2_f32_bf16 v70, v137, v200, v70
    v_dot2_f32_bf16 v71, v137, v64, v71
    v_dot2_f32_bf16 v72, v138, v200, v72
    v_dot2_f32_bf16 v73, v138, v64, v73
    v_dot2_f32_bf16 v74, v139, v200, v74
    v_dot2_f32_bf16 v75, v139, v64, v75
    v_dot2_f32_bf16 v76, v140, v200, v76
    v_dot2_f32_bf16 v77, v140, v64, v77
    v_dot2_f32_bf16 v78, v141, v200, v78
    v_dot2_f32_bf16 v79, v141, v64, v79
    v_dot2_f32_bf16 v80, v142, v200, v80
    v_dot2_f32_bf16 v81, v142, v64, v81
    v_dot2_f32_bf16 v82, v143, v200, v82
    v_dot2_f32_bf16 v83, v143, v64, v83
    v_dot2_f32_bf16 v84, v144, v200, v84
    v_dot2_f32_bf16 v85, v144, v64, v85
    v_dot2_f32_bf16 v68, v148, v201, v68
    v_dot2_f32_bf16 v69, v148, v65, v69
    v_dot2_f32_bf16 v70, v149, v201, v70
    v_dot2_f32_bf16 v71, v149, v65, v71
    v_dot2_f32_bf16 v72, v150, v201, v72
    v_dot2_f32_bf16 v73, v150, v65, v73
    v_dot2_f32_bf16 v74, v151, v201, v74
    v_dot2_f32_bf16 v75, v151, v65, v75
    v_dot2_f32_bf16 v76, v152, v201, v76
    v_dot2_f32_bf16 v77, v152, v65, v77
    v_dot2_f32_bf16 v78, v153, v201, v78
    v_dot2_f32_bf16 v79, v153, v65, v79
    v_dot2_f32_bf16 v80, v154, v201, v80
    v_dot2_f32_bf16 v81, v154, v65, v81
    v_dot2_f32_bf16 v82, v155, v201, v82
    v_dot2_f32_bf16 v83, v155, v65, v83
    v_dot2_f32_bf16 v84, v156, v201, v84
    v_dot2_f32_bf16 v85, v156, v65, v85
    s_waitcnt lgkmcnt(0)
.p2align 3
    v_dot2_f32_bf16 v68, v160, v202, v68
    v_dot2_f32_bf16 v69, v160, v66, v69
    v_dot2_f32_bf16 v70, v161, v202, v70
    v_dot2_f32_bf16 v71, v161, v66, v71
    v_dot2_f32_bf16 v72, v162, v202, v72
    v_dot2_f32_bf16 v73, v162, v66, v73
    v_dot2_f32_bf16 v74, v163, v202, v74
    v_dot2_f32_bf16 v75, v163, v66, v75
    v_dot2_f32_bf16 v76, v164, v202, v76
    v_dot2_f32_bf16 v77, v164, v66, v77
    v_dot2_f32_bf16 v78, v165, v202, v78
    v_dot2_f32_bf16 v79, v165, v66, v79
    v_dot2_f32_bf16 v80, v166, v202, v80
    v_dot2_f32_bf16 v81, v166, v66, v81
    v_dot2_f32_bf16 v82, v167, v202, v82
    v_dot2_f32_bf16 v83, v167, v66, v83
    v_dot2_f32_bf16 v84, v168, v202, v84
    v_dot2_f32_bf16 v85, v168, v66, v85
    v_dot2_f32_bf16 v68, v172, v203, v68
    v_dot2_f32_bf16 v69, v172, v67, v69
    v_dot2_f32_bf16 v70, v173, v203, v70
    v_dot2_f32_bf16 v71, v173, v67, v71
    v_dot2_f32_bf16 v72, v174, v203, v72
    v_dot2_f32_bf16 v73, v174, v67, v73
    v_dot2_f32_bf16 v74, v175, v203, v74
    v_dot2_f32_bf16 v75, v175, v67, v75
    v_dot2_f32_bf16 v76, v176, v203, v76
    v_dot2_f32_bf16 v77, v176, v67, v77
    v_dot2_f32_bf16 v78, v177, v203, v78
    v_dot2_f32_bf16 v79, v177, v67, v79
    v_dot2_f32_bf16 v80, v178, v203, v80
    v_dot2_f32_bf16 v81, v178, v67, v81
    v_dot2_f32_bf16 v82, v179, v203, v82
    v_dot2_f32_bf16 v83, v179, v67, v83
    v_dot2_f32_bf16 v84, v180, v203, v84
    v_dot2_f32_bf16 v85, v180, v67, v85
    v_mul_f32 v68, v19, v68
    v_mul_f32 v69, v19, v69
    v_mul_f32 v70, v19, v70
    v_mul_f32 v71, v19, v71
    v_mul_f32 v72, v19, v72
    v_mul_f32 v73, v19, v73
    v_mul_f32 v74, v19, v74
    v_mul_f32 v75, v19, v75
    v_mul_f32 v76, v19, v76
    v_mul_f32 v77, v19, v77
    v_mul_f32 v78, v19, v78
    v_mul_f32 v79, v19, v79
    v_mul_f32 v80, v19, v80
    v_mul_f32 v81, v19, v81
    v_mul_f32 v82, v19, v82
    v_mul_f32 v83, v19, v83
    v_mul_f32 v84, v19, v84
    v_mul_f32 v85, v19, v85
    v_cvt_pk_bf16_f32 v184, v68, v69
    v_cvt_pk_bf16_f32 v185, v70, v71
    v_cvt_pk_bf16_f32 v186, v72, v73
    v_cvt_pk_bf16_f32 v187, v74, v75
    v_cvt_pk_bf16_f32 v188, v76, v77
    v_cvt_pk_bf16_f32 v189, v78, v79
    v_cvt_pk_bf16_f32 v190, v80, v81
    v_cvt_pk_bf16_f32 v191, v82, v83
    v_cvt_pk_bf16_f32 v192, v84, v85
    buffer_store_dwordx4 v[184:187], v245, s[20:23], s70 offen offset:0 sc1
    s_add_u32 s70, s70, 32768
    buffer_store_dwordx4 v[188:191], v245, s[20:23], s70 offen offset:0 sc1
    s_add_u32 s70, s70, 32768
    buffer_store_dword v192, v245, s[20:23], s70 offen offset:0 sc1
    s_branch recurrent_scan__sliding_local_dilated__mixer_gmlp__prompt_kernel_atd
recurrent_scan__sliding_local_dilated__mixer_gmlp__prompt_kernel_at1:
    s_cmp_lg_u32 s36, 1
    s_cbranch_scc1 recurrent_scan__sliding_local_dilated__mixer_gmlp__prompt_kernel_at2
    s_waitcnt lgkmcnt(15)
.p2align 3
    v_dot2_f32_bf16 v196, v185, v89, 0
    v_dot2_f32_bf16 v197, v185, v101, 0
    v_dot2_f32_bf16 v196, v186, v90, v196
    v_dot2_f32_bf16 v197, v186, v102, v197
    v_dot2_f32_bf16 v196, v187, v91, v196
    v_dot2_f32_bf16 v197, v187, v103, v197
    v_dot2_f32_bf16 v196, v188, v92, v196
    v_dot2_f32_bf16 v197, v188, v104, v197
    v_dot2_f32_bf16 v196, v189, v93, v196
    v_dot2_f32_bf16 v197, v189, v105, v197
    v_dot2_f32_bf16 v196, v190, v94, v196
    v_dot2_f32_bf16 v197, v190, v106, v197
    v_dot2_f32_bf16 v196, v191, v95, v196
    v_dot2_f32_bf16 v197, v191, v107, v197
    v_dot2_f32_bf16 v196, v192, v96, v196
    v_dot2_f32_bf16 v197, v192, v108, v197
    v_dot2_f32_bf16 v196, v193, v97, v196
    v_dot2_f32_bf16 v197, v193, v109, v197
    s_waitcnt lgkmcnt(12)
.p2align 3
    v_dot2_f32_bf16 v198, v185, v113, 0
    v_dot2_f32_bf16 v199, v185, v125, 0
    v_dot2_f32_bf16 v198, v186, v114, v198
    v_dot2_f32_bf16 v199, v186, v126, v199
    v_dot2_f32_bf16 v198, v187, v115, v198
    v_dot2_f32_bf16 v199, v187, v127, v199
    v_dot2_f32_bf16 v198, v188, v116, v198
    v_dot2_f32_bf16 v199, v188, v128, v199
    v_dot2_f32_bf16 v198, v189, v117, v198
    v_dot2_f32_bf16 v199, v189, v129, v199
    v_dot2_f32_bf16 v198, v190, v118, v198
    v_dot2_f32_bf16 v199, v190, v130, v199
    v_dot2_f32_bf16 v198, v191, v119, v198
    v_dot2_f32_bf16 v199, v191, v131, v199
    v_dot2_f32_bf16 v198, v192, v120, v198
    v_dot2_f32_bf16 v199, v192, v132, v199
    v_dot2_f32_bf16 v198, v193, v121, v198
    v_dot2_f32_bf16 v199, v193, v133, v199
    s_waitcnt lgkmcnt(6)
.p2align 3
    v_dot2_f32_bf16 v200, v185, v137, 0
    v_dot2_f32_bf16 v201, v185, v149, 0
    v_dot2_f32_bf16 v200, v186, v138, v200
    v_dot2_f32_bf16 v201, v186, v150, v201
    v_dot2_f32_bf16 v200, v187, v139, v200
    v_dot2_f32_bf16 v201, v187, v151, v201
    v_dot2_f32_bf16 v200, v188, v140, v200
    v_dot2_f32_bf16 v201, v188, v152, v201
    v_dot2_f32_bf16 v200, v189, v141, v200
    v_dot2_f32_bf16 v201, v189, v153, v201
    v_dot2_f32_bf16 v200, v190, v142, v200
    v_dot2_f32_bf16 v201, v190, v154, v201
    v_dot2_f32_bf16 v200, v191, v143, v200
    v_dot2_f32_bf16 v201, v191, v155, v201
    v_dot2_f32_bf16 v200, v192, v144, v200
    v_dot2_f32_bf16 v201, v192, v156, v201
    v_dot2_f32_bf16 v200, v193, v145, v200
    v_dot2_f32_bf16 v201, v193, v157, v201
    s_waitcnt lgkmcnt(0)
.p2align 3
    v_dot2_f32_bf16 v202, v185, v161, 0
    v_dot2_f32_bf16 v203, v185, v173, 0
    v_dot2_f32_bf16 v202, v186, v162, v202
    v_dot2_f32_bf16 v203, v186, v174, v203
    v_dot2_f32_bf16 v202, v187, v163, v202
    v_dot2_f32_bf16 v203, v187, v175, v203
    v_dot2_f32_bf16 v202, v188, v164, v202
    v_dot2_f32_bf16 v203, v188, v176, v203
    v_dot2_f32_bf16 v202, v189, v165, v202
    v_dot2_f32_bf16 v203, v189, v177, v203
    v_dot2_f32_bf16 v202, v190, v166, v202
    v_dot2_f32_bf16 v203, v190, v178, v203
    v_dot2_f32_bf16 v202, v191, v167, v202
    v_dot2_f32_bf16 v203, v191, v179, v203
    v_dot2_f32_bf16 v202, v192, v168, v202
    v_dot2_f32_bf16 v203, v192, v180, v203
    v_dot2_f32_bf16 v202, v193, v169, v202
    v_dot2_f32_bf16 v203, v193, v181, v203
    ds_read_b128 v[88:91], v246 offset:4320
    ds_read_b128 v[92:95], v246 offset:5600
    ds_read_b128 v[96:99], v246 offset:6880
    ds_read_b128 v[100:103], v246 offset:4288
    ds_read_b128 v[104:107], v246 offset:5568
    ds_read_b128 v[108:111], v246 offset:6848
    ds_read_b128 v[112:115], v246 offset:4256
    ds_read_b128 v[116:119], v246 offset:5536
    ds_read_b128 v[120:123], v246 offset:6816
    ds_read_b128 v[124:127], v246 offset:4224
    ds_read_b128 v[128:131], v246 offset:5504
    ds_read_b128 v[132:135], v246 offset:6784
    ds_read_b128 v[136:139], v246 offset:4192
    ds_read_b128 v[140:143], v246 offset:5472
    ds_read_b128 v[144:147], v246 offset:6752
    ds_read_b128 v[148:151], v246 offset:4160
    ds_read_b128 v[152:155], v246 offset:5440
    ds_read_b128 v[156:159], v246 offset:6720
    ds_read_b128 v[160:163], v246 offset:4128
    ds_read_b128 v[164:167], v246 offset:5408
    ds_read_b128 v[168:171], v246 offset:6688
    ds_read_b128 v[172:175], v246 offset:4096
    ds_read_b128 v[176:179], v246 offset:5376
    ds_read_b128 v[180:183], v246 offset:6656
    v_cndmask_b32 v197, v17, v197, s[42:43]
    v_cndmask_b32 v198, v17, v198, s[44:45]
    v_cndmask_b32 v199, v17, v199, s[46:47]
    v_cndmask_b32 v200, v17, v200, s[48:49]
    v_cndmask_b32 v201, v17, v201, s[50:51]
    v_cndmask_b32 v202, v17, v202, s[52:53]
    v_cndmask_b32 v203, v17, v203, s[54:55]
    v_max3_f32 v18, v196, v197, v198
    v_max3_f32 v18, v18, v199, v200
    v_max3_f32 v18, v18, v201, v202
    v_max_f32 v18, v18, v203
    v_sub_f32 v196, v196, v18
    v_sub_f32 v197, v197, v18
    v_sub_f32 v198, v198, v18
    v_sub_f32 v199, v199, v18
    v_sub_f32 v200, v200, v18
    v_sub_f32 v201, v201, v18
    v_sub_f32 v202, v202, v18
    v_sub_f32 v203, v203, v18
    v_mul_f32 v196, s74, v196
    v_mul_f32 v197, s74, v197
    v_mul_f32 v198, s74, v198
    v_mul_f32 v199, s74, v199
    v_mul_f32 v200, s74, v200
    v_mul_f32 v201, s74, v201
    v_mul_f32 v202, s74, v202
    v_mul_f32 v203, s74, v203
    v_exp_f32 v196, v196
    v_exp_f32 v197, v197
    v_exp_f32 v198, v198
    v_exp_f32 v199, v199
    v_exp_f32 v200, v200
    v_exp_f32 v201, v201
    v_exp_f32 v202, v202
    v_exp_f32 v203, v203
    v_cvt_pk_bf16_f32 v196, v196, 0
    v_cvt_pk_bf16_f32 v197, v197, 0
    v_cvt_pk_bf16_f32 v198, v198, 0
    v_cvt_pk_bf16_f32 v199, v199, 0
    v_cvt_pk_bf16_f32 v200, v200, 0
    v_cvt_pk_bf16_f32 v201, v201, 0
    v_cvt_pk_bf16_f32 v202, v202, 0
    v_cvt_pk_bf16_f32 v203, v203, 0
    v_lshlrev_b32 v60, 16, v196
    v_lshlrev_b32 v61, 16, v197
    v_lshlrev_b32 v62, 16, v198
    v_lshlrev_b32 v63, 16, v199
    v_lshlrev_b32 v64, 16, v200
    v_lshlrev_b32 v65, 16, v201
    v_lshlrev_b32 v66, 16, v202
    v_lshlrev_b32 v67, 16, v203
    v_add_f32 v19, v60, v61
    v_add_f32 v19, v19, v62
    v_add_f32 v19, v19, v63
    v_add_f32 v19, v19, v64
    v_add_f32 v19, v19, v65
    v_add_f32 v19, v19, v66
    v_add_f32 v19, v19, v67
    v_mul_f32 v19, s75, v19
    v_rcp_f32 v19, v19
    s_waitcnt lgkmcnt(15)
.p2align 3
    v_dot2_f32_bf16 v68, v89, v196, 0
    v_dot2_f32_bf16 v69, v89, v60, 0
    v_dot2_f32_bf16 v70, v90, v196, 0
    v_dot2_f32_bf16 v71, v90, v60, 0
    v_dot2_f32_bf16 v72, v91, v196, 0
    v_dot2_f32_bf16 v73, v91, v60, 0
    v_dot2_f32_bf16 v74, v92, v196, 0
    v_dot2_f32_bf16 v75, v92, v60, 0
    v_dot2_f32_bf16 v76, v93, v196, 0
    v_dot2_f32_bf16 v77, v93, v60, 0
    v_dot2_f32_bf16 v78, v94, v196, 0
    v_dot2_f32_bf16 v79, v94, v60, 0
    v_dot2_f32_bf16 v80, v95, v196, 0
    v_dot2_f32_bf16 v81, v95, v60, 0
    v_dot2_f32_bf16 v82, v96, v196, 0
    v_dot2_f32_bf16 v83, v96, v60, 0
    v_dot2_f32_bf16 v84, v97, v196, 0
    v_dot2_f32_bf16 v85, v97, v60, 0
    v_dot2_f32_bf16 v68, v101, v197, v68
    v_dot2_f32_bf16 v69, v101, v61, v69
    v_dot2_f32_bf16 v70, v102, v197, v70
    v_dot2_f32_bf16 v71, v102, v61, v71
    v_dot2_f32_bf16 v72, v103, v197, v72
    v_dot2_f32_bf16 v73, v103, v61, v73
    v_dot2_f32_bf16 v74, v104, v197, v74
    v_dot2_f32_bf16 v75, v104, v61, v75
    v_dot2_f32_bf16 v76, v105, v197, v76
    v_dot2_f32_bf16 v77, v105, v61, v77
    v_dot2_f32_bf16 v78, v106, v197, v78
    v_dot2_f32_bf16 v79, v106, v61, v79
    v_dot2_f32_bf16 v80, v107, v197, v80
    v_dot2_f32_bf16 v81, v107, v61, v81
    v_dot2_f32_bf16 v82, v108, v197, v82
    v_dot2_f32_bf16 v83, v108, v61, v83
    v_dot2_f32_bf16 v84, v109, v197, v84
    v_dot2_f32_bf16 v85, v109, v61, v85
    s_waitcnt lgkmcnt(12)
.p2align 3
    v_dot2_f32_bf16 v68, v113, v198, v68
    v_dot2_f32_bf16 v69, v113, v62, v69
    v_dot2_f32_bf16 v70, v114, v198, v70
    v_dot2_f32_bf16 v71, v114, v62, v71
    v_dot2_f32_bf16 v72, v115, v198, v72
    v_dot2_f32_bf16 v73, v115, v62, v73
    v_dot2_f32_bf16 v74, v116, v198, v74
    v_dot2_f32_bf16 v75, v116, v62, v75
    v_dot2_f32_bf16 v76, v117, v198, v76
    v_dot2_f32_bf16 v77, v117, v62, v77
    v_dot2_f32_bf16 v78, v118, v198, v78
    v_dot2_f32_bf16 v79, v118, v62, v79
    v_dot2_f32_bf16 v80, v119, v198, v80
    v_dot2_f32_bf16 v81, v119, v62, v81
    v_dot2_f32_bf16 v82, v120, v198, v82
    v_dot2_f32_bf16 v83, v120, v62, v83
    v_dot2_f32_bf16 v84, v121, v198, v84
    v_dot2_f32_bf16 v85, v121, v62, v85
    v_dot2_f32_bf16 v68, v125, v199, v68
    v_dot2_f32_bf16 v69, v125, v63, v69
    v_dot2_f32_bf16 v70, v126, v199, v70
    v_dot2_f32_bf16 v71, v126, v63, v71
    v_dot2_f32_bf16 v72, v127, v199, v72
    v_dot2_f32_bf16 v73, v127, v63, v73
    v_dot2_f32_bf16 v74, v128, v199, v74
    v_dot2_f32_bf16 v75, v128, v63, v75
    v_dot2_f32_bf16 v76, v129, v199, v76
    v_dot2_f32_bf16 v77, v129, v63, v77
    v_dot2_f32_bf16 v78, v130, v199, v78
    v_dot2_f32_bf16 v79, v130, v63, v79
    v_dot2_f32_bf16 v80, v131, v199, v80
    v_dot2_f32_bf16 v81, v131, v63, v81
    v_dot2_f32_bf16 v82, v132, v199, v82
    v_dot2_f32_bf16 v83, v132, v63, v83
    v_dot2_f32_bf16 v84, v133, v199, v84
    v_dot2_f32_bf16 v85, v133, v63, v85
    s_waitcnt lgkmcnt(6)
.p2align 3
    v_dot2_f32_bf16 v68, v137, v200, v68
    v_dot2_f32_bf16 v69, v137, v64, v69
    v_dot2_f32_bf16 v70, v138, v200, v70
    v_dot2_f32_bf16 v71, v138, v64, v71
    v_dot2_f32_bf16 v72, v139, v200, v72
    v_dot2_f32_bf16 v73, v139, v64, v73
    v_dot2_f32_bf16 v74, v140, v200, v74
    v_dot2_f32_bf16 v75, v140, v64, v75
    v_dot2_f32_bf16 v76, v141, v200, v76
    v_dot2_f32_bf16 v77, v141, v64, v77
    v_dot2_f32_bf16 v78, v142, v200, v78
    v_dot2_f32_bf16 v79, v142, v64, v79
    v_dot2_f32_bf16 v80, v143, v200, v80
    v_dot2_f32_bf16 v81, v143, v64, v81
    v_dot2_f32_bf16 v82, v144, v200, v82
    v_dot2_f32_bf16 v83, v144, v64, v83
    v_dot2_f32_bf16 v84, v145, v200, v84
    v_dot2_f32_bf16 v85, v145, v64, v85
    v_dot2_f32_bf16 v68, v149, v201, v68
    v_dot2_f32_bf16 v69, v149, v65, v69
    v_dot2_f32_bf16 v70, v150, v201, v70
    v_dot2_f32_bf16 v71, v150, v65, v71
    v_dot2_f32_bf16 v72, v151, v201, v72
    v_dot2_f32_bf16 v73, v151, v65, v73
    v_dot2_f32_bf16 v74, v152, v201, v74
    v_dot2_f32_bf16 v75, v152, v65, v75
    v_dot2_f32_bf16 v76, v153, v201, v76
    v_dot2_f32_bf16 v77, v153, v65, v77
    v_dot2_f32_bf16 v78, v154, v201, v78
    v_dot2_f32_bf16 v79, v154, v65, v79
    v_dot2_f32_bf16 v80, v155, v201, v80
    v_dot2_f32_bf16 v81, v155, v65, v81
    v_dot2_f32_bf16 v82, v156, v201, v82
    v_dot2_f32_bf16 v83, v156, v65, v83
    v_dot2_f32_bf16 v84, v157, v201, v84
    v_dot2_f32_bf16 v85, v157, v65, v85
    s_waitcnt lgkmcnt(0)
.p2align 3
    v_dot2_f32_bf16 v68, v161, v202, v68
    v_dot2_f32_bf16 v69, v161, v66, v69
    v_dot2_f32_bf16 v70, v162, v202, v70
    v_dot2_f32_bf16 v71, v162, v66, v71
    v_dot2_f32_bf16 v72, v163, v202, v72
    v_dot2_f32_bf16 v73, v163, v66, v73
    v_dot2_f32_bf16 v74, v164, v202, v74
    v_dot2_f32_bf16 v75, v164, v66, v75
    v_dot2_f32_bf16 v76, v165, v202, v76
    v_dot2_f32_bf16 v77, v165, v66, v77
    v_dot2_f32_bf16 v78, v166, v202, v78
    v_dot2_f32_bf16 v79, v166, v66, v79
    v_dot2_f32_bf16 v80, v167, v202, v80
    v_dot2_f32_bf16 v81, v167, v66, v81
    v_dot2_f32_bf16 v82, v168, v202, v82
    v_dot2_f32_bf16 v83, v168, v66, v83
    v_dot2_f32_bf16 v84, v169, v202, v84
    v_dot2_f32_bf16 v85, v169, v66, v85
    v_dot2_f32_bf16 v68, v173, v203, v68
    v_dot2_f32_bf16 v69, v173, v67, v69
    v_dot2_f32_bf16 v70, v174, v203, v70
    v_dot2_f32_bf16 v71, v174, v67, v71
    v_dot2_f32_bf16 v72, v175, v203, v72
    v_dot2_f32_bf16 v73, v175, v67, v73
    v_dot2_f32_bf16 v74, v176, v203, v74
    v_dot2_f32_bf16 v75, v176, v67, v75
    v_dot2_f32_bf16 v76, v177, v203, v76
    v_dot2_f32_bf16 v77, v177, v67, v77
    v_dot2_f32_bf16 v78, v178, v203, v78
    v_dot2_f32_bf16 v79, v178, v67, v79
    v_dot2_f32_bf16 v80, v179, v203, v80
    v_dot2_f32_bf16 v81, v179, v67, v81
    v_dot2_f32_bf16 v82, v180, v203, v82
    v_dot2_f32_bf16 v83, v180, v67, v83
    v_dot2_f32_bf16 v84, v181, v203, v84
    v_dot2_f32_bf16 v85, v181, v67, v85
    v_mul_f32 v68, v19, v68
    v_mul_f32 v69, v19, v69
    v_mul_f32 v70, v19, v70
    v_mul_f32 v71, v19, v71
    v_mul_f32 v72, v19, v72
    v_mul_f32 v73, v19, v73
    v_mul_f32 v74, v19, v74
    v_mul_f32 v75, v19, v75
    v_mul_f32 v76, v19, v76
    v_mul_f32 v77, v19, v77
    v_mul_f32 v78, v19, v78
    v_mul_f32 v79, v19, v79
    v_mul_f32 v80, v19, v80
    v_mul_f32 v81, v19, v81
    v_mul_f32 v82, v19, v82
    v_mul_f32 v83, v19, v83
    v_mul_f32 v84, v19, v84
    v_mul_f32 v85, v19, v85
    v_cvt_pk_bf16_f32 v185, v68, v69
    v_cvt_pk_bf16_f32 v186, v70, v71
    v_cvt_pk_bf16_f32 v187, v72, v73
    v_cvt_pk_bf16_f32 v188, v74, v75
    v_cvt_pk_bf16_f32 v189, v76, v77
    v_cvt_pk_bf16_f32 v190, v78, v79
    v_cvt_pk_bf16_f32 v191, v80, v81
    v_cvt_pk_bf16_f32 v192, v82, v83
    v_cvt_pk_bf16_f32 v193, v84, v85
    buffer_store_dword v185, v245, s[20:23], s70 offen offset:4 sc1
    buffer_store_dwordx2 v[186:187], v245, s[20:23], s70 offen offset:8 sc1
    s_add_u32 s70, s70, 32768
    buffer_store_dwordx4 v[188:191], v245, s[20:23], s70 offen offset:0 sc1
    s_add_u32 s70, s70, 32768
    buffer_store_dwordx2 v[192:193], v245, s[20:23], s70 offen offset:0 sc1
    s_branch recurrent_scan__sliding_local_dilated__mixer_gmlp__prompt_kernel_atd
recurrent_scan__sliding_local_dilated__mixer_gmlp__prompt_kernel_at2:
    s_cmp_lg_u32 s36, 2
    s_cbranch_scc1 recurrent_scan__sliding_local_dilated__mixer_gmlp__prompt_kernel_at3
    s_waitcnt lgkmcnt(15)
.p2align 3
    v_dot2_f32_bf16 v196, v186, v90, 0
    v_dot2_f32_bf16 v197, v186, v102, 0
    v_dot2_f32_bf16 v196, v187, v91, v196
    v_dot2_f32_bf16 v197, v187, v103, v197
    v_dot2_f32_bf16 v196, v188, v92, v196
    v_dot2_f32_bf16 v197, v188, v104, v197
    v_dot2_f32_bf16 v196, v189, v93, v196
    v_dot2_f32_bf16 v197, v189, v105, v197
    v_dot2_f32_bf16 v196, v190, v94, v196
    v_dot2_f32_bf16 v197, v190, v106, v197
    v_dot2_f32_bf16 v196, v191, v95, v196
    v_dot2_f32_bf16 v197, v191, v107, v197
    v_dot2_f32_bf16 v196, v192, v96, v196
    v_dot2_f32_bf16 v197, v192, v108, v197
    v_dot2_f32_bf16 v196, v193, v97, v196
    v_dot2_f32_bf16 v197, v193, v109, v197
    v_dot2_f32_bf16 v196, v194, v98, v196
    v_dot2_f32_bf16 v197, v194, v110, v197
    s_waitcnt lgkmcnt(12)
.p2align 3
    v_dot2_f32_bf16 v198, v186, v114, 0
    v_dot2_f32_bf16 v199, v186, v126, 0
    v_dot2_f32_bf16 v198, v187, v115, v198
    v_dot2_f32_bf16 v199, v187, v127, v199
    v_dot2_f32_bf16 v198, v188, v116, v198
    v_dot2_f32_bf16 v199, v188, v128, v199
    v_dot2_f32_bf16 v198, v189, v117, v198
    v_dot2_f32_bf16 v199, v189, v129, v199
    v_dot2_f32_bf16 v198, v190, v118, v198
    v_dot2_f32_bf16 v199, v190, v130, v199
    v_dot2_f32_bf16 v198, v191, v119, v198
    v_dot2_f32_bf16 v199, v191, v131, v199
    v_dot2_f32_bf16 v198, v192, v120, v198
    v_dot2_f32_bf16 v199, v192, v132, v199
    v_dot2_f32_bf16 v198, v193, v121, v198
    v_dot2_f32_bf16 v199, v193, v133, v199
    v_dot2_f32_bf16 v198, v194, v122, v198
    v_dot2_f32_bf16 v199, v194, v134, v199
    s_waitcnt lgkmcnt(6)
.p2align 3
    v_dot2_f32_bf16 v200, v186, v138, 0
    v_dot2_f32_bf16 v201, v186, v150, 0
    v_dot2_f32_bf16 v200, v187, v139, v200
    v_dot2_f32_bf16 v201, v187, v151, v201
    v_dot2_f32_bf16 v200, v188, v140, v200
    v_dot2_f32_bf16 v201, v188, v152, v201
    v_dot2_f32_bf16 v200, v189, v141, v200
    v_dot2_f32_bf16 v201, v189, v153, v201
    v_dot2_f32_bf16 v200, v190, v142, v200
    v_dot2_f32_bf16 v201, v190, v154, v201
    v_dot2_f32_bf16 v200, v191, v143, v200
    v_dot2_f32_bf16 v201, v191, v155, v201
    v_dot2_f32_bf16 v200, v192, v144, v200
    v_dot2_f32_bf16 v201, v192, v156, v201
    v_dot2_f32_bf16 v200, v193, v145, v200
    v_dot2_f32_bf16 v201, v193, v157, v201
    v_dot2_f32_bf16 v200, v194, v146, v200
    v_dot2_f32_bf16 v201, v194, v158, v201
    s_waitcnt lgkmcnt(0)
.p2align 3
    v_dot2_f32_bf16 v202, v186, v162, 0
    v_dot2_f32_bf16 v203, v186, v174, 0
    v_dot2_f32_bf16 v202, v187, v163, v202
    v_dot2_f32_bf16 v203, v187, v175, v203
    v_dot2_f32_bf16 v202, v188, v164, v202
    v_dot2_f32_bf16 v203, v188, v176, v203
    v_dot2_f32_bf16 v202, v189, v165, v202
    v_dot2_f32_bf16 v203, v189, v177, v203
    v_dot2_f32_bf16 v202, v190, v166, v202
    v_dot2_f32_bf16 v203, v190, v178, v203
    v_dot2_f32_bf16 v202, v191, v167, v202
    v_dot2_f32_bf16 v203, v191, v179, v203
    v_dot2_f32_bf16 v202, v192, v168, v202
    v_dot2_f32_bf16 v203, v192, v180, v203
    v_dot2_f32_bf16 v202, v193, v169, v202
    v_dot2_f32_bf16 v203, v193, v181, v203
    v_dot2_f32_bf16 v202, v194, v170, v202
    v_dot2_f32_bf16 v203, v194, v182, v203
    ds_read_b128 v[88:91], v246 offset:4320
    ds_read_b128 v[92:95], v246 offset:5600
    ds_read_b128 v[96:99], v246 offset:6880
    ds_read_b128 v[100:103], v246 offset:4288
    ds_read_b128 v[104:107], v246 offset:5568
    ds_read_b128 v[108:111], v246 offset:6848
    ds_read_b128 v[112:115], v246 offset:4256
    ds_read_b128 v[116:119], v246 offset:5536
    ds_read_b128 v[120:123], v246 offset:6816
    ds_read_b128 v[124:127], v246 offset:4224
    ds_read_b128 v[128:131], v246 offset:5504
    ds_read_b128 v[132:135], v246 offset:6784
    ds_read_b128 v[136:139], v246 offset:4192
    ds_read_b128 v[140:143], v246 offset:5472
    ds_read_b128 v[144:147], v246 offset:6752
    ds_read_b128 v[148:151], v246 offset:4160
    ds_read_b128 v[152:155], v246 offset:5440
    ds_read_b128 v[156:159], v246 offset:6720
    ds_read_b128 v[160:163], v246 offset:4128
    ds_read_b128 v[164:167], v246 offset:5408
    ds_read_b128 v[168:171], v246 offset:6688
    ds_read_b128 v[172:175], v246 offset:4096
    ds_read_b128 v[176:179], v246 offset:5376
    ds_read_b128 v[180:183], v246 offset:6656
    v_cndmask_b32 v197, v17, v197, s[42:43]
    v_cndmask_b32 v198, v17, v198, s[44:45]
    v_cndmask_b32 v199, v17, v199, s[46:47]
    v_cndmask_b32 v200, v17, v200, s[48:49]
    v_cndmask_b32 v201, v17, v201, s[50:51]
    v_cndmask_b32 v202, v17, v202, s[52:53]
    v_cndmask_b32 v203, v17, v203, s[54:55]
    v_max3_f32 v18, v196, v197, v198
    v_max3_f32 v18, v18, v199, v200
    v_max3_f32 v18, v18, v201, v202
    v_max_f32 v18, v18, v203
    v_sub_f32 v196, v196, v18
    v_sub_f32 v197, v197, v18
    v_sub_f32 v198, v198, v18
    v_sub_f32 v199, v199, v18
    v_sub_f32 v200, v200, v18
    v_sub_f32 v201, v201, v18
    v_sub_f32 v202, v202, v18
    v_sub_f32 v203, v203, v18
    v_mul_f32 v196, s74, v196
    v_mul_f32 v197, s74, v197
    v_mul_f32 v198, s74, v198
    v_mul_f32 v199, s74, v199
    v_mul_f32 v200, s74, v200
    v_mul_f32 v201, s74, v201
    v_mul_f32 v202, s74, v202
    v_mul_f32 v203, s74, v203
    v_exp_f32 v196, v196
    v_exp_f32 v197, v197
    v_exp_f32 v198, v198
    v_exp_f32 v199, v199
    v_exp_f32 v200, v200
    v_exp_f32 v201, v201
    v_exp_f32 v202, v202
    v_exp_f32 v203, v203
    v_cvt_pk_bf16_f32 v196, v196, 0
    v_cvt_pk_bf16_f32 v197, v197, 0
    v_cvt_pk_bf16_f32 v198, v198, 0
    v_cvt_pk_bf16_f32 v199, v199, 0
    v_cvt_pk_bf16_f32 v200, v200, 0
    v_cvt_pk_bf16_f32 v201, v201, 0
    v_cvt_pk_bf16_f32 v202, v202, 0
    v_cvt_pk_bf16_f32 v203, v203, 0
    v_lshlrev_b32 v60, 16, v196
    v_lshlrev_b32 v61, 16, v197
    v_lshlrev_b32 v62, 16, v198
    v_lshlrev_b32 v63, 16, v199
    v_lshlrev_b32 v64, 16, v200
    v_lshlrev_b32 v65, 16, v201
    v_lshlrev_b32 v66, 16, v202
    v_lshlrev_b32 v67, 16, v203
    v_add_f32 v19, v60, v61
    v_add_f32 v19, v19, v62
    v_add_f32 v19, v19, v63
    v_add_f32 v19, v19, v64
    v_add_f32 v19, v19, v65
    v_add_f32 v19, v19, v66
    v_add_f32 v19, v19, v67
    v_mul_f32 v19, s75, v19
    v_rcp_f32 v19, v19
    s_waitcnt lgkmcnt(15)
.p2align 3
    v_dot2_f32_bf16 v68, v90, v196, 0
    v_dot2_f32_bf16 v69, v90, v60, 0
    v_dot2_f32_bf16 v70, v91, v196, 0
    v_dot2_f32_bf16 v71, v91, v60, 0
    v_dot2_f32_bf16 v72, v92, v196, 0
    v_dot2_f32_bf16 v73, v92, v60, 0
    v_dot2_f32_bf16 v74, v93, v196, 0
    v_dot2_f32_bf16 v75, v93, v60, 0
    v_dot2_f32_bf16 v76, v94, v196, 0
    v_dot2_f32_bf16 v77, v94, v60, 0
    v_dot2_f32_bf16 v78, v95, v196, 0
    v_dot2_f32_bf16 v79, v95, v60, 0
    v_dot2_f32_bf16 v80, v96, v196, 0
    v_dot2_f32_bf16 v81, v96, v60, 0
    v_dot2_f32_bf16 v82, v97, v196, 0
    v_dot2_f32_bf16 v83, v97, v60, 0
    v_dot2_f32_bf16 v84, v98, v196, 0
    v_dot2_f32_bf16 v85, v98, v60, 0
    v_dot2_f32_bf16 v68, v102, v197, v68
    v_dot2_f32_bf16 v69, v102, v61, v69
    v_dot2_f32_bf16 v70, v103, v197, v70
    v_dot2_f32_bf16 v71, v103, v61, v71
    v_dot2_f32_bf16 v72, v104, v197, v72
    v_dot2_f32_bf16 v73, v104, v61, v73
    v_dot2_f32_bf16 v74, v105, v197, v74
    v_dot2_f32_bf16 v75, v105, v61, v75
    v_dot2_f32_bf16 v76, v106, v197, v76
    v_dot2_f32_bf16 v77, v106, v61, v77
    v_dot2_f32_bf16 v78, v107, v197, v78
    v_dot2_f32_bf16 v79, v107, v61, v79
    v_dot2_f32_bf16 v80, v108, v197, v80
    v_dot2_f32_bf16 v81, v108, v61, v81
    v_dot2_f32_bf16 v82, v109, v197, v82
    v_dot2_f32_bf16 v83, v109, v61, v83
    v_dot2_f32_bf16 v84, v110, v197, v84
    v_dot2_f32_bf16 v85, v110, v61, v85
    s_waitcnt lgkmcnt(12)
.p2align 3
    v_dot2_f32_bf16 v68, v114, v198, v68
    v_dot2_f32_bf16 v69, v114, v62, v69
    v_dot2_f32_bf16 v70, v115, v198, v70
    v_dot2_f32_bf16 v71, v115, v62, v71
    v_dot2_f32_bf16 v72, v116, v198, v72
    v_dot2_f32_bf16 v73, v116, v62, v73
    v_dot2_f32_bf16 v74, v117, v198, v74
    v_dot2_f32_bf16 v75, v117, v62, v75
    v_dot2_f32_bf16 v76, v118, v198, v76
    v_dot2_f32_bf16 v77, v118, v62, v77
    v_dot2_f32_bf16 v78, v119, v198, v78
    v_dot2_f32_bf16 v79, v119, v62, v79
    v_dot2_f32_bf16 v80, v120, v198, v80
    v_dot2_f32_bf16 v81, v120, v62, v81
    v_dot2_f32_bf16 v82, v121, v198, v82
    v_dot2_f32_bf16 v83, v121, v62, v83
    v_dot2_f32_bf16 v84, v122, v198, v84
    v_dot2_f32_bf16 v85, v122, v62, v85
    v_dot2_f32_bf16 v68, v126, v199, v68
    v_dot2_f32_bf16 v69, v126, v63, v69
    v_dot2_f32_bf16 v70, v127, v199, v70
    v_dot2_f32_bf16 v71, v127, v63, v71
    v_dot2_f32_bf16 v72, v128, v199, v72
    v_dot2_f32_bf16 v73, v128, v63, v73
    v_dot2_f32_bf16 v74, v129, v199, v74
    v_dot2_f32_bf16 v75, v129, v63, v75
    v_dot2_f32_bf16 v76, v130, v199, v76
    v_dot2_f32_bf16 v77, v130, v63, v77
    v_dot2_f32_bf16 v78, v131, v199, v78
    v_dot2_f32_bf16 v79, v131, v63, v79
    v_dot2_f32_bf16 v80, v132, v199, v80
    v_dot2_f32_bf16 v81, v132, v63, v81
    v_dot2_f32_bf16 v82, v133, v199, v82
    v_dot2_f32_bf16 v83, v133, v63, v83
    v_dot2_f32_bf16 v84, v134, v199, v84
    v_dot2_f32_bf16 v85, v134, v63, v85
    s_waitcnt lgkmcnt(6)
.p2align 3
    v_dot2_f32_bf16 v68, v138, v200, v68
    v_dot2_f32_bf16 v69, v138, v64, v69
    v_dot2_f32_bf16 v70, v139, v200, v70
    v_dot2_f32_bf16 v71, v139, v64, v71
    v_dot2_f32_bf16 v72, v140, v200, v72
    v_dot2_f32_bf16 v73, v140, v64, v73
    v_dot2_f32_bf16 v74, v141, v200, v74
    v_dot2_f32_bf16 v75, v141, v64, v75
    v_dot2_f32_bf16 v76, v142, v200, v76
    v_dot2_f32_bf16 v77, v142, v64, v77
    v_dot2_f32_bf16 v78, v143, v200, v78
    v_dot2_f32_bf16 v79, v143, v64, v79
    v_dot2_f32_bf16 v80, v144, v200, v80
    v_dot2_f32_bf16 v81, v144, v64, v81
    v_dot2_f32_bf16 v82, v145, v200, v82
    v_dot2_f32_bf16 v83, v145, v64, v83
    v_dot2_f32_bf16 v84, v146, v200, v84
    v_dot2_f32_bf16 v85, v146, v64, v85
    v_dot2_f32_bf16 v68, v150, v201, v68
    v_dot2_f32_bf16 v69, v150, v65, v69
    v_dot2_f32_bf16 v70, v151, v201, v70
    v_dot2_f32_bf16 v71, v151, v65, v71
    v_dot2_f32_bf16 v72, v152, v201, v72
    v_dot2_f32_bf16 v73, v152, v65, v73
    v_dot2_f32_bf16 v74, v153, v201, v74
    v_dot2_f32_bf16 v75, v153, v65, v75
    v_dot2_f32_bf16 v76, v154, v201, v76
    v_dot2_f32_bf16 v77, v154, v65, v77
    v_dot2_f32_bf16 v78, v155, v201, v78
    v_dot2_f32_bf16 v79, v155, v65, v79
    v_dot2_f32_bf16 v80, v156, v201, v80
    v_dot2_f32_bf16 v81, v156, v65, v81
    v_dot2_f32_bf16 v82, v157, v201, v82
    v_dot2_f32_bf16 v83, v157, v65, v83
    v_dot2_f32_bf16 v84, v158, v201, v84
    v_dot2_f32_bf16 v85, v158, v65, v85
    s_waitcnt lgkmcnt(0)
.p2align 3
    v_dot2_f32_bf16 v68, v162, v202, v68
    v_dot2_f32_bf16 v69, v162, v66, v69
    v_dot2_f32_bf16 v70, v163, v202, v70
    v_dot2_f32_bf16 v71, v163, v66, v71
    v_dot2_f32_bf16 v72, v164, v202, v72
    v_dot2_f32_bf16 v73, v164, v66, v73
    v_dot2_f32_bf16 v74, v165, v202, v74
    v_dot2_f32_bf16 v75, v165, v66, v75
    v_dot2_f32_bf16 v76, v166, v202, v76
    v_dot2_f32_bf16 v77, v166, v66, v77
    v_dot2_f32_bf16 v78, v167, v202, v78
    v_dot2_f32_bf16 v79, v167, v66, v79
    v_dot2_f32_bf16 v80, v168, v202, v80
    v_dot2_f32_bf16 v81, v168, v66, v81
    v_dot2_f32_bf16 v82, v169, v202, v82
    v_dot2_f32_bf16 v83, v169, v66, v83
    v_dot2_f32_bf16 v84, v170, v202, v84
    v_dot2_f32_bf16 v85, v170, v66, v85
    v_dot2_f32_bf16 v68, v174, v203, v68
    v_dot2_f32_bf16 v69, v174, v67, v69
    v_dot2_f32_bf16 v70, v175, v203, v70
    v_dot2_f32_bf16 v71, v175, v67, v71
    v_dot2_f32_bf16 v72, v176, v203, v72
    v_dot2_f32_bf16 v73, v176, v67, v73
    v_dot2_f32_bf16 v74, v177, v203, v74
    v_dot2_f32_bf16 v75, v177, v67, v75
    v_dot2_f32_bf16 v76, v178, v203, v76
    v_dot2_f32_bf16 v77, v178, v67, v77
    v_dot2_f32_bf16 v78, v179, v203, v78
    v_dot2_f32_bf16 v79, v179, v67, v79
    v_dot2_f32_bf16 v80, v180, v203, v80
    v_dot2_f32_bf16 v81, v180, v67, v81
    v_dot2_f32_bf16 v82, v181, v203, v82
    v_dot2_f32_bf16 v83, v181, v67, v83
    v_dot2_f32_bf16 v84, v182, v203, v84
    v_dot2_f32_bf16 v85, v182, v67, v85
    v_mul_f32 v68, v19, v68
    v_mul_f32 v69, v19, v69
    v_mul_f32 v70, v19, v70
    v_mul_f32 v71, v19, v71
    v_mul_f32 v72, v19, v72
    v_mul_f32 v73, v19, v73
    v_mul_f32 v74, v19, v74
    v_mul_f32 v75, v19, v75
    v_mul_f32 v76, v19, v76
    v_mul_f32 v77, v19, v77
    v_mul_f32 v78, v19, v78
    v_mul_f32 v79, v19, v79
    v_mul_f32 v80, v19, v80
    v_mul_f32 v81, v19, v81
    v_mul_f32 v82, v19, v82
    v_mul_f32 v83, v19, v83
    v_mul_f32 v84, v19, v84
    v_mul_f32 v85, v19, v85
    v_cvt_pk_bf16_f32 v186, v68, v69
    v_cvt_pk_bf16_f32 v187, v70, v71
    v_cvt_pk_bf16_f32 v188, v72, v73
    v_cvt_pk_bf16_f32 v189, v74, v75
    v_cvt_pk_bf16_f32 v190, v76, v77
    v_cvt_pk_bf16_f32 v191, v78, v79
    v_cvt_pk_bf16_f32 v192, v80, v81
    v_cvt_pk_bf16_f32 v193, v82, v83
    v_cvt_pk_bf16_f32 v194, v84, v85
    buffer_store_dwordx2 v[186:187], v245, s[20:23], s70 offen offset:8 sc1
    s_add_u32 s70, s70, 32768
    buffer_store_dwordx4 v[188:191], v245, s[20:23], s70 offen offset:0 sc1
    s_add_u32 s70, s70, 32768
    buffer_store_dwordx3 v[192:194], v245, s[20:23], s70 offen offset:0 sc1
    s_branch recurrent_scan__sliding_local_dilated__mixer_gmlp__prompt_kernel_atd
recurrent_scan__sliding_local_dilated__mixer_gmlp__prompt_kernel_at3:
    s_waitcnt lgkmcnt(15)
.p2align 3
    v_dot2_f32_bf16 v196, v187, v91, 0
    v_dot2_f32_bf16 v197, v187, v103, 0
    v_dot2_f32_bf16 v196, v188, v92, v196
    v_dot2_f32_bf16 v197, v188, v104, v197
    v_dot2_f32_bf16 v196, v189, v93, v196
    v_dot2_f32_bf16 v197, v189, v105, v197
    v_dot2_f32_bf16 v196, v190, v94, v196
    v_dot2_f32_bf16 v197, v190, v106, v197
    v_dot2_f32_bf16 v196, v191, v95, v196
    v_dot2_f32_bf16 v197, v191, v107, v197
    v_dot2_f32_bf16 v196, v192, v96, v196
    v_dot2_f32_bf16 v197, v192, v108, v197
    v_dot2_f32_bf16 v196, v193, v97, v196
    v_dot2_f32_bf16 v197, v193, v109, v197
    v_dot2_f32_bf16 v196, v194, v98, v196
    v_dot2_f32_bf16 v197, v194, v110, v197
    v_dot2_f32_bf16 v196, v195, v99, v196
    v_dot2_f32_bf16 v197, v195, v111, v197
    s_waitcnt lgkmcnt(12)
.p2align 3
    v_dot2_f32_bf16 v198, v187, v115, 0
    v_dot2_f32_bf16 v199, v187, v127, 0
    v_dot2_f32_bf16 v198, v188, v116, v198
    v_dot2_f32_bf16 v199, v188, v128, v199
    v_dot2_f32_bf16 v198, v189, v117, v198
    v_dot2_f32_bf16 v199, v189, v129, v199
    v_dot2_f32_bf16 v198, v190, v118, v198
    v_dot2_f32_bf16 v199, v190, v130, v199
    v_dot2_f32_bf16 v198, v191, v119, v198
    v_dot2_f32_bf16 v199, v191, v131, v199
    v_dot2_f32_bf16 v198, v192, v120, v198
    v_dot2_f32_bf16 v199, v192, v132, v199
    v_dot2_f32_bf16 v198, v193, v121, v198
    v_dot2_f32_bf16 v199, v193, v133, v199
    v_dot2_f32_bf16 v198, v194, v122, v198
    v_dot2_f32_bf16 v199, v194, v134, v199
    v_dot2_f32_bf16 v198, v195, v123, v198
    v_dot2_f32_bf16 v199, v195, v135, v199
    s_waitcnt lgkmcnt(6)
.p2align 3
    v_dot2_f32_bf16 v200, v187, v139, 0
    v_dot2_f32_bf16 v201, v187, v151, 0
    v_dot2_f32_bf16 v200, v188, v140, v200
    v_dot2_f32_bf16 v201, v188, v152, v201
    v_dot2_f32_bf16 v200, v189, v141, v200
    v_dot2_f32_bf16 v201, v189, v153, v201
    v_dot2_f32_bf16 v200, v190, v142, v200
    v_dot2_f32_bf16 v201, v190, v154, v201
    v_dot2_f32_bf16 v200, v191, v143, v200
    v_dot2_f32_bf16 v201, v191, v155, v201
    v_dot2_f32_bf16 v200, v192, v144, v200
    v_dot2_f32_bf16 v201, v192, v156, v201
    v_dot2_f32_bf16 v200, v193, v145, v200
    v_dot2_f32_bf16 v201, v193, v157, v201
    v_dot2_f32_bf16 v200, v194, v146, v200
    v_dot2_f32_bf16 v201, v194, v158, v201
    v_dot2_f32_bf16 v200, v195, v147, v200
    v_dot2_f32_bf16 v201, v195, v159, v201
    s_waitcnt lgkmcnt(0)
.p2align 3
    v_dot2_f32_bf16 v202, v187, v163, 0
    v_dot2_f32_bf16 v203, v187, v175, 0
    v_dot2_f32_bf16 v202, v188, v164, v202
    v_dot2_f32_bf16 v203, v188, v176, v203
    v_dot2_f32_bf16 v202, v189, v165, v202
    v_dot2_f32_bf16 v203, v189, v177, v203
    v_dot2_f32_bf16 v202, v190, v166, v202
    v_dot2_f32_bf16 v203, v190, v178, v203
    v_dot2_f32_bf16 v202, v191, v167, v202
    v_dot2_f32_bf16 v203, v191, v179, v203
    v_dot2_f32_bf16 v202, v192, v168, v202
    v_dot2_f32_bf16 v203, v192, v180, v203
    v_dot2_f32_bf16 v202, v193, v169, v202
    v_dot2_f32_bf16 v203, v193, v181, v203
    v_dot2_f32_bf16 v202, v194, v170, v202
    v_dot2_f32_bf16 v203, v194, v182, v203
    v_dot2_f32_bf16 v202, v195, v171, v202
    v_dot2_f32_bf16 v203, v195, v183, v203
    ds_read_b128 v[88:91], v246 offset:4320
    ds_read_b128 v[92:95], v246 offset:5600
    ds_read_b128 v[96:99], v246 offset:6880
    ds_read_b128 v[100:103], v246 offset:4288
    ds_read_b128 v[104:107], v246 offset:5568
    ds_read_b128 v[108:111], v246 offset:6848
    ds_read_b128 v[112:115], v246 offset:4256
    ds_read_b128 v[116:119], v246 offset:5536
    ds_read_b128 v[120:123], v246 offset:6816
    ds_read_b128 v[124:127], v246 offset:4224
    ds_read_b128 v[128:131], v246 offset:5504
    ds_read_b128 v[132:135], v246 offset:6784
    ds_read_b128 v[136:139], v246 offset:4192
    ds_read_b128 v[140:143], v246 offset:5472
    ds_read_b128 v[144:147], v246 offset:6752
    ds_read_b128 v[148:151], v246 offset:4160
    ds_read_b128 v[152:155], v246 offset:5440
    ds_read_b128 v[156:159], v246 offset:6720
    ds_read_b128 v[160:163], v246 offset:4128
    ds_read_b128 v[164:167], v246 offset:5408
    ds_read_b128 v[168:171], v246 offset:6688
    ds_read_b128 v[172:175], v246 offset:4096
    ds_read_b128 v[176:179], v246 offset:5376
    ds_read_b128 v[180:183], v246 offset:6656
    v_cndmask_b32 v197, v17, v197, s[42:43]
    v_cndmask_b32 v198, v17, v198, s[44:45]
    v_cndmask_b32 v199, v17, v199, s[46:47]
    v_cndmask_b32 v200, v17, v200, s[48:49]
    v_cndmask_b32 v201, v17, v201, s[50:51]
    v_cndmask_b32 v202, v17, v202, s[52:53]
    v_cndmask_b32 v203, v17, v203, s[54:55]
    v_max3_f32 v18, v196, v197, v198
    v_max3_f32 v18, v18, v199, v200
    v_max3_f32 v18, v18, v201, v202
    v_max_f32 v18, v18, v203
    v_sub_f32 v196, v196, v18
    v_sub_f32 v197, v197, v18
    v_sub_f32 v198, v198, v18
    v_sub_f32 v199, v199, v18
    v_sub_f32 v200, v200, v18
    v_sub_f32 v201, v201, v18
    v_sub_f32 v202, v202, v18
    v_sub_f32 v203, v203, v18
    v_mul_f32 v196, s74, v196
    v_mul_f32 v197, s74, v197
    v_mul_f32 v198, s74, v198
    v_mul_f32 v199, s74, v199
    v_mul_f32 v200, s74, v200
    v_mul_f32 v201, s74, v201
    v_mul_f32 v202, s74, v202
    v_mul_f32 v203, s74, v203
    v_exp_f32 v196, v196
    v_exp_f32 v197, v197
    v_exp_f32 v198, v198
    v_exp_f32 v199, v199
    v_exp_f32 v200, v200
    v_exp_f32 v201, v201
    v_exp_f32 v202, v202
    v_exp_f32 v203, v203
    v_cvt_pk_bf16_f32 v196, v196, 0
    v_cvt_pk_bf16_f32 v197, v197, 0
    v_cvt_pk_bf16_f32 v198, v198, 0
    v_cvt_pk_bf16_f32 v199, v199, 0
    v_cvt_pk_bf16_f32 v200, v200, 0
    v_cvt_pk_bf16_f32 v201, v201, 0
    v_cvt_pk_bf16_f32 v202, v202, 0
    v_cvt_pk_bf16_f32 v203, v203, 0
    v_lshlrev_b32 v60, 16, v196
    v_lshlrev_b32 v61, 16, v197
    v_lshlrev_b32 v62, 16, v198
    v_lshlrev_b32 v63, 16, v199
    v_lshlrev_b32 v64, 16, v200
    v_lshlrev_b32 v65, 16, v201
    v_lshlrev_b32 v66, 16, v202
    v_lshlrev_b32 v67, 16, v203
    v_add_f32 v19, v60, v61
    v_add_f32 v19, v19, v62
    v_add_f32 v19, v19, v63
    v_add_f32 v19, v19, v64
    v_add_f32 v19, v19, v65
    v_add_f32 v19, v19, v66
    v_add_f32 v19, v19, v67
    v_mul_f32 v19, s75, v19
    v_rcp_f32 v19, v19
    s_waitcnt lgkmcnt(15)
.p2align 3
    v_dot2_f32_bf16 v68, v91, v196, 0
    v_dot2_f32_bf16 v69, v91, v60, 0
    v_dot2_f32_bf16 v70, v92, v196, 0
    v_dot2_f32_bf16 v71, v92, v60, 0
    v_dot2_f32_bf16 v72, v93, v196, 0
    v_dot2_f32_bf16 v73, v93, v60, 0
    v_dot2_f32_bf16 v74, v94, v196, 0
    v_dot2_f32_bf16 v75, v94, v60, 0
    v_dot2_f32_bf16 v76, v95, v196, 0
    v_dot2_f32_bf16 v77, v95, v60, 0
    v_dot2_f32_bf16 v78, v96, v196, 0
    v_dot2_f32_bf16 v79, v96, v60, 0
    v_dot2_f32_bf16 v80, v97, v196, 0
    v_dot2_f32_bf16 v81, v97, v60, 0
    v_dot2_f32_bf16 v82, v98, v196, 0
    v_dot2_f32_bf16 v83, v98, v60, 0
    v_dot2_f32_bf16 v84, v99, v196, 0
    v_dot2_f32_bf16 v85, v99, v60, 0
    v_dot2_f32_bf16 v68, v103, v197, v68
    v_dot2_f32_bf16 v69, v103, v61, v69
    v_dot2_f32_bf16 v70, v104, v197, v70
    v_dot2_f32_bf16 v71, v104, v61, v71
    v_dot2_f32_bf16 v72, v105, v197, v72
    v_dot2_f32_bf16 v73, v105, v61, v73
    v_dot2_f32_bf16 v74, v106, v197, v74
    v_dot2_f32_bf16 v75, v106, v61, v75
    v_dot2_f32_bf16 v76, v107, v197, v76
    v_dot2_f32_bf16 v77, v107, v61, v77
    v_dot2_f32_bf16 v78, v108, v197, v78
    v_dot2_f32_bf16 v79, v108, v61, v79
    v_dot2_f32_bf16 v80, v109, v197, v80
    v_dot2_f32_bf16 v81, v109, v61, v81
    v_dot2_f32_bf16 v82, v110, v197, v82
    v_dot2_f32_bf16 v83, v110, v61, v83
    v_dot2_f32_bf16 v84, v111, v197, v84
    v_dot2_f32_bf16 v85, v111, v61, v85
    s_waitcnt lgkmcnt(12)
.p2align 3
    v_dot2_f32_bf16 v68, v115, v198, v68
    v_dot2_f32_bf16 v69, v115, v62, v69
    v_dot2_f32_bf16 v70, v116, v198, v70
    v_dot2_f32_bf16 v71, v116, v62, v71
    v_dot2_f32_bf16 v72, v117, v198, v72
    v_dot2_f32_bf16 v73, v117, v62, v73
    v_dot2_f32_bf16 v74, v118, v198, v74
    v_dot2_f32_bf16 v75, v118, v62, v75
    v_dot2_f32_bf16 v76, v119, v198, v76
    v_dot2_f32_bf16 v77, v119, v62, v77
    v_dot2_f32_bf16 v78, v120, v198, v78
    v_dot2_f32_bf16 v79, v120, v62, v79
    v_dot2_f32_bf16 v80, v121, v198, v80
    v_dot2_f32_bf16 v81, v121, v62, v81
    v_dot2_f32_bf16 v82, v122, v198, v82
    v_dot2_f32_bf16 v83, v122, v62, v83
    v_dot2_f32_bf16 v84, v123, v198, v84
    v_dot2_f32_bf16 v85, v123, v62, v85
    v_dot2_f32_bf16 v68, v127, v199, v68
    v_dot2_f32_bf16 v69, v127, v63, v69
    v_dot2_f32_bf16 v70, v128, v199, v70
    v_dot2_f32_bf16 v71, v128, v63, v71
    v_dot2_f32_bf16 v72, v129, v199, v72
    v_dot2_f32_bf16 v73, v129, v63, v73
    v_dot2_f32_bf16 v74, v130, v199, v74
    v_dot2_f32_bf16 v75, v130, v63, v75
    v_dot2_f32_bf16 v76, v131, v199, v76
    v_dot2_f32_bf16 v77, v131, v63, v77
    v_dot2_f32_bf16 v78, v132, v199, v78
    v_dot2_f32_bf16 v79, v132, v63, v79
    v_dot2_f32_bf16 v80, v133, v199, v80
    v_dot2_f32_bf16 v81, v133, v63, v81
    v_dot2_f32_bf16 v82, v134, v199, v82
    v_dot2_f32_bf16 v83, v134, v63, v83
    v_dot2_f32_bf16 v84, v135, v199, v84
    v_dot2_f32_bf16 v85, v135, v63, v85
    s_waitcnt lgkmcnt(6)
.p2align 3
    v_dot2_f32_bf16 v68, v139, v200, v68
    v_dot2_f32_bf16 v69, v139, v64, v69
    v_dot2_f32_bf16 v70, v140, v200, v70
    v_dot2_f32_bf16 v71, v140, v64, v71
    v_dot2_f32_bf16 v72, v141, v200, v72
    v_dot2_f32_bf16 v73, v141, v64, v73
    v_dot2_f32_bf16 v74, v142, v200, v74
    v_dot2_f32_bf16 v75, v142, v64, v75
    v_dot2_f32_bf16 v76, v143, v200, v76
    v_dot2_f32_bf16 v77, v143, v64, v77
    v_dot2_f32_bf16 v78, v144, v200, v78
    v_dot2_f32_bf16 v79, v144, v64, v79
    v_dot2_f32_bf16 v80, v145, v200, v80
    v_dot2_f32_bf16 v81, v145, v64, v81
    v_dot2_f32_bf16 v82, v146, v200, v82
    v_dot2_f32_bf16 v83, v146, v64, v83
    v_dot2_f32_bf16 v84, v147, v200, v84
    v_dot2_f32_bf16 v85, v147, v64, v85
    v_dot2_f32_bf16 v68, v151, v201, v68
    v_dot2_f32_bf16 v69, v151, v65, v69
    v_dot2_f32_bf16 v70, v152, v201, v70
    v_dot2_f32_bf16 v71, v152, v65, v71
    v_dot2_f32_bf16 v72, v153, v201, v72
    v_dot2_f32_bf16 v73, v153, v65, v73
    v_dot2_f32_bf16 v74, v154, v201, v74
    v_dot2_f32_bf16 v75, v154, v65, v75
    v_dot2_f32_bf16 v76, v155, v201, v76
    v_dot2_f32_bf16 v77, v155, v65, v77
    v_dot2_f32_bf16 v78, v156, v201, v78
    v_dot2_f32_bf16 v79, v156, v65, v79
    v_dot2_f32_bf16 v80, v157, v201, v80
    v_dot2_f32_bf16 v81, v157, v65, v81
    v_dot2_f32_bf16 v82, v158, v201, v82
    v_dot2_f32_bf16 v83, v158, v65, v83
    v_dot2_f32_bf16 v84, v159, v201, v84
    v_dot2_f32_bf16 v85, v159, v65, v85
    s_waitcnt lgkmcnt(0)
.p2align 3
    v_dot2_f32_bf16 v68, v163, v202, v68
    v_dot2_f32_bf16 v69, v163, v66, v69
    v_dot2_f32_bf16 v70, v164, v202, v70
    v_dot2_f32_bf16 v71, v164, v66, v71
    v_dot2_f32_bf16 v72, v165, v202, v72
    v_dot2_f32_bf16 v73, v165, v66, v73
    v_dot2_f32_bf16 v74, v166, v202, v74
    v_dot2_f32_bf16 v75, v166, v66, v75
    v_dot2_f32_bf16 v76, v167, v202, v76
    v_dot2_f32_bf16 v77, v167, v66, v77
    v_dot2_f32_bf16 v78, v168, v202, v78
    v_dot2_f32_bf16 v79, v168, v66, v79
    v_dot2_f32_bf16 v80, v169, v202, v80
    v_dot2_f32_bf16 v81, v169, v66, v81
    v_dot2_f32_bf16 v82, v170, v202, v82
    v_dot2_f32_bf16 v83, v170, v66, v83
    v_dot2_f32_bf16 v84, v171, v202, v84
    v_dot2_f32_bf16 v85, v171, v66, v85
    v_dot2_f32_bf16 v68, v175, v203, v68
    v_dot2_f32_bf16 v69, v175, v67, v69
    v_dot2_f32_bf16 v70, v176, v203, v70
    v_dot2_f32_bf16 v71, v176, v67, v71
    v_dot2_f32_bf16 v72, v177, v203, v72
    v_dot2_f32_bf16 v73, v177, v67, v73
    v_dot2_f32_bf16 v74, v178, v203, v74
    v_dot2_f32_bf16 v75, v178, v67, v75
    v_dot2_f32_bf16 v76, v179, v203, v76
    v_dot2_f32_bf16 v77, v179, v67, v77
    v_dot2_f32_bf16 v78, v180, v203, v78
    v_dot2_f32_bf16 v79, v180, v67, v79
    v_dot2_f32_bf16 v80, v181, v203, v80
    v_dot2_f32_bf16 v81, v181, v67, v81
    v_dot2_f32_bf16 v82, v182, v203, v82
    v_dot2_f32_bf16 v83, v182, v67, v83
    v_dot2_f32_bf16 v84, v183, v203, v84
    v_dot2_f32_bf16 v85, v183, v67, v85
    v_mul_f32 v68, v19, v68
    v_mul_f32 v69, v19, v69
    v_mul_f32 v70, v19, v70
    v_mul_f32 v71, v19, v71
    v_mul_f32 v72, v19, v72
    v_mul_f32 v73, v19, v73
    v_mul_f32 v74, v19, v74
    v_mul_f32 v75, v19, v75
    v_mul_f32 v76, v19, v76
    v_mul_f32 v77, v19, v77
    v_mul_f32 v78, v19, v78
    v_mul_f32 v79, v19, v79
    v_mul_f32 v80, v19, v80
    v_mul_f32 v81, v19, v81
    v_mul_f32 v82, v19, v82
    v_mul_f32 v83, v19, v83
    v_mul_f32 v84, v19, v84
    v_mul_f32 v85, v19, v85
    v_cvt_pk_bf16_f32 v187, v68, v69
    v_cvt_pk_bf16_f32 v188, v70, v71
    v_cvt_pk_bf16_f32 v189, v72, v73
    v_cvt_pk_bf16_f32 v190, v74, v75
    v_cvt_pk_bf16_f32 v191, v76, v77
    v_cvt_pk_bf16_f32 v192, v78, v79
    v_cvt_pk_bf16_f32 v193, v80, v81
    v_cvt_pk_bf16_f32 v194, v82, v83
    v_cvt_pk_bf16_f32 v195, v84, v85
    buffer_store_dword v187, v245, s[20:23], s70 offen offset:12 sc1
    s_add_u32 s70, s70, 32768
    buffer_store_dwordx4 v[188:191], v245, s[20:23], s70 offen offset:0 sc1
    s_add_u32 s70, s70, 32768
    buffer_store_dwordx4 v[192:195], v245, s[20:23], s70 offen offset:0 sc1
recurrent_scan__sliding_local_dilated__mixer_gmlp__prompt_kernel_atd:
    v_mov_b32 v16, 0
    v_mov_b32 v17, 0
    v_mov_b32 v18, 0
    v_mov_b32 v19, 0
    v_mov_b32 v60, 0
    v_mov_b32 v61, 0
    v_mov_b32 v62, 0
    v_mov_b32 v63, 0
    v_mov_b32 v64, 0
    v_mov_b32 v65, 0
    v_mov_b32 v66, 0
    v_mov_b32 v67, 0
    v_mov_b32 v68, 0
    v_mov_b32 v69, 0
    v_mov_b32 v70, 0
    v_mov_b32 v71, 0
    v_mov_b32 v72, 0
    v_mov_b32 v73, 0
    v_mov_b32 v74, 0
    v_mov_b32 v75, 0
    v_mov_b32 v76, 0
    v_mov_b32 v77, 0
    v_mov_b32 v78, 0
    v_mov_b32 v79, 0
    v_mov_b32 v80, 0
    v_mov_b32 v81, 0
    v_mov_b32 v82, 0
    v_mov_b32 v83, 0
    v_mov_b32 v84, 0
    v_mov_b32 v85, 0
    v_mov_b32 v86, 0
    v_mov_b32 v87, 0
    s_barrier
    ds_read_b128 v[160:163], v5 offset:0
    ds_read_b128 v[164:167], v5 offset:2048
    ds_read_b64_tr_b16 v[88:89], v2 offset:0
    ds_read_b64_tr_b16 v[90:91], v2 offset:64
    ds_read_b64_tr_b16 v[92:93], v3 offset:0
    ds_read_b64_tr_b16 v[94:95], v3 offset:64
    ds_read_b64_tr_b16 v[96:97], v2 offset:4224
    ds_read_b64_tr_b16 v[98:99], v2 offset:4288
    ds_read_b64_tr_b16 v[100:101], v3 offset:4224
    ds_read_b64_tr_b16 v[102:103], v3 offset:4288
    ds_read_b64_tr_b16 v[104:105], v2 offset:8448
    ds_read_b64_tr_b16 v[106:107], v2 offset:8512
    ds_read_b64_tr_b16 v[108:109], v3 offset:8448
    ds_read_b64_tr_b16 v[110:111], v3 offset:8512
    ds_read_b64_tr_b16 v[112:113], v2 offset:12672
    ds_read_b64_tr_b16 v[114:115], v2 offset:12736
    ds_read_b64_tr_b16 v[116:117], v3 offset:12672
    ds_read_b64_tr_b16 v[118:119], v3 offset:12736
    ds_read_b64_tr_b16 v[120:121], v4 offset:16896
    ds_read_b64_tr_b16 v[122:123], v4 offset:16960
.p2align 6
recurrent_scan__sliding_local_dilated__mixer_gmlp__prompt_kernel_Bloop:
    s_waitcnt lgkmcnt(12)
    v_mfma_f32_16x16x32_bf16 v[16:19], v[88:91], v[160:163], v[16:19]
    ds_read_b128 v[168:171], v6 offset:0
    v_mfma_f32_16x16x32_bf16 v[20:23], v[88:91], v[164:167], v[20:23]
    ds_read_b128 v[172:175], v6 offset:2048
    v_mfma_f32_16x16x32_bf16 v[24:27], v[92:95], v[160:163], v[24:27]
    ds_read_b64_tr_b16 v[124:125], v2 offset:512
    ds_read_b64_tr_b16 v[126:127], v2 offset:576
    v_mfma_f32_16x16x32_bf16 v[28:31], v[92:95], v[164:167], v[28:31]
    ds_read_b64_tr_b16 v[128:129], v3 offset:512
    ds_read_b64_tr_b16 v[130:131], v3 offset:576
    v_mfma_f32_16x16x32_bf16 v[32:35], v[96:99], v[160:163], v[32:35]
    ds_read_b64_tr_b16 v[132:133], v2 offset:4736
    v_mfma_f32_16x16x32_bf16 v[36:39], v[96:99], v[164:167], v[36:39]
    ds_read_b64_tr_b16 v[134:135], v2 offset:4800
    s_waitcnt lgkmcnt(14)
    v_mfma_f32_16x16x32_bf16 v[40:43], v[100:103], v[160:163], v[40:43]
    ds_read_b64_tr_b16 v[136:137], v3 offset:4736
    v_mfma_f32_16x16x32_bf16 v[44:47], v[100:103], v[164:167], v[44:47]
    ds_read_b64_tr_b16 v[138:139], v3 offset:4800
    v_mfma_f32_16x16x32_bf16 v[48:51], v[104:107], v[160:163], v[48:51]
    ds_read_b64_tr_b16 v[140:141], v2 offset:8960
    v_mfma_f32_16x16x32_bf16 v[52:55], v[104:107], v[164:167], v[52:55]
    ds_read_b64_tr_b16 v[142:143], v2 offset:9024
    v_mfma_f32_16x16x32_bf16 v[56:59], v[108:111], v[160:163], v[56:59]
    ds_read_b64_tr_b16 v[144:145], v3 offset:8960
    v_mfma_f32_16x16x32_bf16 v[60:63], v[108:111], v[164:167], v[60:63]
    ds_read_b64_tr_b16 v[146:147], v3 offset:9024
    s_waitcnt lgkmcnt(14)
    v_mfma_f32_16x16x32_bf16 v[64:67], v[112:115], v[160:163], v[64:67]
    ds_read_b64_tr_b16 v[148:149], v2 offset:13184
    v_mfma_f32_16x16x32_bf16 v[68:71], v[112:115], v[164:167], v[68:71]
    ds_read_b64_tr_b16 v[150:151], v2 offset:13248
    v_mfma_f32_16x16x32_bf16 v[72:75], v[116:119], v[160:163], v[72:75]
    ds_read_b64_tr_b16 v[152:153], v3 offset:13184
    v_mfma_f32_16x16x32_bf16 v[76:79], v[116:119], v[164:167], v[76:79]
    ds_read_b64_tr_b16 v[154:155], v3 offset:13248
    v_mfma_f32_16x16x32_bf16 v[80:83], v[120:123], v[160:163], v[80:83]
    ds_read_b64_tr_b16 v[156:157], v4 offset:17408
    v_mfma_f32_16x16x32_bf16 v[84:87], v[120:123], v[164:167], v[84:87]
    ds_read_b64_tr_b16 v[158:159], v4 offset:17472
    s_barrier
    s_waitcnt lgkmcnt(12)
    v_mfma_f32_16x16x32_bf16 v[16:19], v[124:127], v[168:171], v[16:19]
    ds_read_b128 v[160:163], v5 offset:35392
    v_mfma_f32_16x16x32_bf16 v[20:23], v[124:127], v[172:175], v[20:23]
    ds_read_b128 v[164:167], v5 offset:37440
    v_mfma_f32_16x16x32_bf16 v[24:27], v[128:131], v[168:171], v[24:27]
    ds_read_b64_tr_b16 v[88:89], v2 offset:35392
    ds_read_b64_tr_b16 v[90:91], v2 offset:35456
    v_mfma_f32_16x16x32_bf16 v[28:31], v[128:131], v[172:175], v[28:31]
    ds_read_b64_tr_b16 v[92:93], v3 offset:35392
    ds_read_b64_tr_b16 v[94:95], v3 offset:35456
    v_mfma_f32_16x16x32_bf16 v[32:35], v[132:135], v[168:171], v[32:35]
    ds_read_b64_tr_b16 v[96:97], v2 offset:39616
    v_mfma_f32_16x16x32_bf16 v[36:39], v[132:135], v[172:175], v[36:39]
    ds_read_b64_tr_b16 v[98:99], v2 offset:39680
    s_waitcnt lgkmcnt(14)
    v_mfma_f32_16x16x32_bf16 v[40:43], v[136:139], v[168:171], v[40:43]
    ds_read_b64_tr_b16 v[100:101], v3 offset:39616
    v_mfma_f32_16x16x32_bf16 v[44:47], v[136:139], v[172:175], v[44:47]
    ds_read_b64_tr_b16 v[102:103], v3 offset:39680
    v_mfma_f32_16x16x32_bf16 v[48:51], v[140:143], v[168:171], v[48:51]
    ds_read_b64_tr_b16 v[104:105], v2 offset:43840
    v_mfma_f32_16x16x32_bf16 v[52:55], v[140:143], v[172:175], v[52:55]
    ds_read_b64_tr_b16 v[106:107], v2 offset:43904
    v_mfma_f32_16x16x32_bf16 v[56:59], v[144:147], v[168:171], v[56:59]
    ds_read_b64_tr_b16 v[108:109], v3 offset:43840
    v_mfma_f32_16x16x32_bf16 v[60:63], v[144:147], v[172:175], v[60:63]
    ds_read_b64_tr_b16 v[110:111], v3 offset:43904
    s_waitcnt lgkmcnt(14)
    v_mfma_f32_16x16x32_bf16 v[64:67], v[148:151], v[168:171], v[64:67]
    ds_read_b64_tr_b16 v[112:113], v2 offset:48064
    v_mfma_f32_16x16x32_bf16 v[68:71], v[148:151], v[172:175], v[68:71]
    ds_read_b64_tr_b16 v[114:115], v2 offset:48128
    v_mfma_f32_16x16x32_bf16 v[72:75], v[152:155], v[168:171], v[72:75]
    ds_read_b64_tr_b16 v[116:117], v3 offset:48064
    v_mfma_f32_16x16x32_bf16 v[76:79], v[152:155], v[172:175], v[76:79]
    ds_read_b64_tr_b16 v[118:119], v3 offset:48128
    v_mfma_f32_16x16x32_bf16 v[80:83], v[156:159], v[168:171], v[80:83]
    ds_read_b64_tr_b16 v[120:121], v4 offset:52288
    v_mfma_f32_16x16x32_bf16 v[84:87], v[156:159], v[172:175], v[84:87]
    ds_read_b64_tr_b16 v[122:123], v4 offset:52352
    s_waitcnt lgkmcnt(12)
    v_mfma_f32_16x16x32_bf16 v[16:19], v[88:91], v[160:163], v[16:19]
    ds_read_b128 v[168:171], v6 offset:35392
    v_mfma_f32_16x16x32_bf16 v[20:23], v[88:91], v[164:167], v[20:23]
    ds_read_b128 v[172:175], v6 offset:37440
    v_mfma_f32_16x16x32_bf16 v[24:27], v[92:95], v[160:163], v[24:27]
    ds_read_b64_tr_b16 v[124:125], v2 offset:35904
    ds_read_b64_tr_b16 v[126:127], v2 offset:35968
    v_mfma_f32_16x16x32_bf16 v[28:31], v[92:95], v[164:167], v[28:31]
    ds_read_b64_tr_b16 v[128:129], v3 offset:35904
    ds_read_b64_tr_b16 v[130:131], v3 offset:35968
    v_mfma_f32_16x16x32_bf16 v[32:35], v[96:99], v[160:163], v[32:35]
    ds_read_b64_tr_b16 v[132:133], v2 offset:40128
    v_mfma_f32_16x16x32_bf16 v[36:39], v[96:99], v[164:167], v[36:39]
    ds_read_b64_tr_b16 v[134:135], v2 offset:40192
    s_waitcnt lgkmcnt(14)
    v_mfma_f32_16x16x32_bf16 v[40:43], v[100:103], v[160:163], v[40:43]
    ds_read_b64_tr_b16 v[136:137], v3 offset:40128
    v_mfma_f32_16x16x32_bf16 v[44:47], v[100:103], v[164:167], v[44:47]
    ds_read_b64_tr_b16 v[138:139], v3 offset:40192
    v_mfma_f32_16x16x32_bf16 v[48:51], v[104:107], v[160:163], v[48:51]
    ds_read_b64_tr_b16 v[140:141], v2 offset:44352
    v_mfma_f32_16x16x32_bf16 v[52:55], v[104:107], v[164:167], v[52:55]
    ds_read_b64_tr_b16 v[142:143], v2 offset:44416
    v_mfma_f32_16x16x32_bf16 v[56:59], v[108:111], v[160:163], v[56:59]
    ds_read_b64_tr_b16 v[144:145], v3 offset:44352
    v_mfma_f32_16x16x32_bf16 v[60:63], v[108:111], v[164:167], v[60:63]
    ds_read_b64_tr_b16 v[146:147], v3 offset:44416
    s_waitcnt lgkmcnt(14)
    v_mfma_f32_16x16x32_bf16 v[64:67], v[112:115], v[160:163], v[64:67]
    ds_read_b64_tr_b16 v[148:149], v2 offset:48576
    v_mfma_f32_16x16x32_bf16 v[68:71], v[112:115], v[164:167], v[68:71]
    ds_read_b64_tr_b16 v[150:151], v2 offset:48640
    v_mfma_f32_16x16x32_bf16 v[72:75], v[116:119], v[160:163], v[72:75]
    ds_read_b64_tr_b16 v[152:153], v3 offset:48576
    v_mfma_f32_16x16x32_bf16 v[76:79], v[116:119], v[164:167], v[76:79]
    ds_read_b64_tr_b16 v[154:155], v3 offset:48640
    v_mfma_f32_16x16x32_bf16 v[80:83], v[120:123], v[160:163], v[80:83]
    ds_read_b64_tr_b16 v[156:157], v4 offset:52800
    v_mfma_f32_16x16x32_bf16 v[84:87], v[120:123], v[164:167], v[84:87]
    ds_read_b64_tr_b16 v[158:159], v4 offset:52864
    s_barrier
    s_waitcnt lgkmcnt(12)
    v_mfma_f32_16x16x32_bf16 v[16:19], v[124:127], v[168:171], v[16:19]
    ds_read_b128 v[160:163], v240 offset:0
    v_mfma_f32_16x16x32_bf16 v[20:23], v[124:127], v[172:175], v[20:23]
    ds_read_b128 v[164:167], v240 offset:2048
    v_mfma_f32_16x16x32_bf16 v[24:27], v[128:131], v[168:171], v[24:27]
    ds_read_b64_tr_b16 v[88:89], v242 offset:0
    ds_read_b64_tr_b16 v[90:91], v242 offset:64
    v_mfma_f32_16x16x32_bf16 v[28:31], v[128:131], v[172:175], v[28:31]
    ds_read_b64_tr_b16 v[92:93], v243 offset:0
    ds_read_b64_tr_b16 v[94:95], v243 offset:64
    v_mfma_f32_16x16x32_bf16 v[32:35], v[132:135], v[168:171], v[32:35]
    ds_read_b64_tr_b16 v[96:97], v242 offset:4224
    v_mfma_f32_16x16x32_bf16 v[36:39], v[132:135], v[172:175], v[36:39]
    ds_read_b64_tr_b16 v[98:99], v242 offset:4288
    s_waitcnt lgkmcnt(14)
    v_mfma_f32_16x16x32_bf16 v[40:43], v[136:139], v[168:171], v[40:43]
    ds_read_b64_tr_b16 v[100:101], v243 offset:4224
    v_mfma_f32_16x16x32_bf16 v[44:47], v[136:139], v[172:175], v[44:47]
    ds_read_b64_tr_b16 v[102:103], v243 offset:4288
    v_mfma_f32_16x16x32_bf16 v[48:51], v[140:143], v[168:171], v[48:51]
    ds_read_b64_tr_b16 v[104:105], v242 offset:8448
    v_mfma_f32_16x16x32_bf16 v[52:55], v[140:143], v[172:175], v[52:55]
    ds_read_b64_tr_b16 v[106:107], v242 offset:8512
    v_mfma_f32_16x16x32_bf16 v[56:59], v[144:147], v[168:171], v[56:59]
    ds_read_b64_tr_b16 v[108:109], v243 offset:8448
    v_mfma_f32_16x16x32_bf16 v[60:63], v[144:147], v[172:175], v[60:63]
    ds_read_b64_tr_b16 v[110:111], v243 offset:8512
    s_waitcnt lgkmcnt(14)
    v_mfma_f32_16x16x32_bf16 v[64:67], v[148:151], v[168:171], v[64:67]
    ds_read_b64_tr_b16 v[112:113], v242 offset:12672
    v_mfma_f32_16x16x32_bf16 v[68:71], v[148:151], v[172:175], v[68:71]
    ds_read_b64_tr_b16 v[114:115], v242 offset:12736
    v_mfma_f32_16x16x32_bf16 v[72:75], v[152:155], v[168:171], v[72:75]
    ds_read_b64_tr_b16 v[116:117], v243 offset:12672
    v_mfma_f32_16x16x32_bf16 v[76:79], v[152:155], v[172:175], v[76:79]
    ds_read_b64_tr_b16 v[118:119], v243 offset:12736
    v_mfma_f32_16x16x32_bf16 v[80:83], v[156:159], v[168:171], v[80:83]
    ds_read_b64_tr_b16 v[120:121], v244 offset:16896
    v_mfma_f32_16x16x32_bf16 v[84:87], v[156:159], v[172:175], v[84:87]
    ds_read_b64_tr_b16 v[122:123], v244 offset:16960
    s_waitcnt lgkmcnt(12)
    v_mfma_f32_16x16x32_bf16 v[16:19], v[88:91], v[160:163], v[16:19]
    ds_read_b128 v[168:171], v241 offset:0
    v_mfma_f32_16x16x32_bf16 v[20:23], v[88:91], v[164:167], v[20:23]
    ds_read_b128 v[172:175], v241 offset:2048
    v_mfma_f32_16x16x32_bf16 v[24:27], v[92:95], v[160:163], v[24:27]
    ds_read_b64_tr_b16 v[124:125], v242 offset:512
    ds_read_b64_tr_b16 v[126:127], v242 offset:576
    v_mfma_f32_16x16x32_bf16 v[28:31], v[92:95], v[164:167], v[28:31]
    ds_read_b64_tr_b16 v[128:129], v243 offset:512
    ds_read_b64_tr_b16 v[130:131], v243 offset:576
    v_mfma_f32_16x16x32_bf16 v[32:35], v[96:99], v[160:163], v[32:35]
    ds_read_b64_tr_b16 v[132:133], v242 offset:4736
    v_mfma_f32_16x16x32_bf16 v[36:39], v[96:99], v[164:167], v[36:39]
    ds_read_b64_tr_b16 v[134:135], v242 offset:4800
    s_waitcnt lgkmcnt(14)
    v_mfma_f32_16x16x32_bf16 v[40:43], v[100:103], v[160:163], v[40:43]
    ds_read_b64_tr_b16 v[136:137], v243 offset:4736
    v_mfma_f32_16x16x32_bf16 v[44:47], v[100:103], v[164:167], v[44:47]
    ds_read_b64_tr_b16 v[138:139], v243 offset:4800
    v_mfma_f32_16x16x32_bf16 v[48:51], v[104:107], v[160:163], v[48:51]
    ds_read_b64_tr_b16 v[140:141], v242 offset:8960
    v_mfma_f32_16x16x32_bf16 v[52:55], v[104:107], v[164:167], v[52:55]
    ds_read_b64_tr_b16 v[142:143], v242 offset:9024
    v_mfma_f32_16x16x32_bf16 v[56:59], v[108:111], v[160:163], v[56:59]
    ds_read_b64_tr_b16 v[144:145], v243 offset:8960
    v_mfma_f32_16x16x32_bf16 v[60:63], v[108:111], v[164:167], v[60:63]
    ds_read_b64_tr_b16 v[146:147], v243 offset:9024
    s_waitcnt lgkmcnt(14)
    v_mfma_f32_16x16x32_bf16 v[64:67], v[112:115], v[160:163], v[64:67]
    ds_read_b64_tr_b16 v[148:149], v242 offset:13184
    v_mfma_f32_16x16x32_bf16 v[68:71], v[112:115], v[164:167], v[68:71]
    ds_read_b64_tr_b16 v[150:151], v242 offset:13248
    v_mfma_f32_16x16x32_bf16 v[72:75], v[116:119], v[160:163], v[72:75]
    ds_read_b64_tr_b16 v[152:153], v243 offset:13184
    v_mfma_f32_16x16x32_bf16 v[76:79], v[116:119], v[164:167], v[76:79]
    ds_read_b64_tr_b16 v[154:155], v243 offset:13248
    v_mfma_f32_16x16x32_bf16 v[80:83], v[120:123], v[160:163], v[80:83]
    ds_read_b64_tr_b16 v[156:157], v244 offset:17408
    v_mfma_f32_16x16x32_bf16 v[84:87], v[120:123], v[164:167], v[84:87]
    ds_read_b64_tr_b16 v[158:159], v244 offset:17472
    s_barrier
    s_waitcnt lgkmcnt(12)
    v_mfma_f32_16x16x32_bf16 v[16:19], v[124:127], v[168:171], v[16:19]
    ds_read_b128 v[160:163], v240 offset:35392
    v_mfma_f32_16x16x32_bf16 v[20:23], v[124:127], v[172:175], v[20:23]
    ds_read_b128 v[164:167], v240 offset:37440
    v_mfma_f32_16x16x32_bf16 v[24:27], v[128:131], v[168:171], v[24:27]
    ds_read_b64_tr_b16 v[88:89], v242 offset:35392
    ds_read_b64_tr_b16 v[90:91], v242 offset:35456
    v_mfma_f32_16x16x32_bf16 v[28:31], v[128:131], v[172:175], v[28:31]
    ds_read_b64_tr_b16 v[92:93], v243 offset:35392
    ds_read_b64_tr_b16 v[94:95], v243 offset:35456
    v_mfma_f32_16x16x32_bf16 v[32:35], v[132:135], v[168:171], v[32:35]
    ds_read_b64_tr_b16 v[96:97], v242 offset:39616
    v_mfma_f32_16x16x32_bf16 v[36:39], v[132:135], v[172:175], v[36:39]
    ds_read_b64_tr_b16 v[98:99], v242 offset:39680
    s_waitcnt lgkmcnt(14)
    v_mfma_f32_16x16x32_bf16 v[40:43], v[136:139], v[168:171], v[40:43]
    ds_read_b64_tr_b16 v[100:101], v243 offset:39616
    v_mfma_f32_16x16x32_bf16 v[44:47], v[136:139], v[172:175], v[44:47]
    ds_read_b64_tr_b16 v[102:103], v243 offset:39680
    v_mfma_f32_16x16x32_bf16 v[48:51], v[140:143], v[168:171], v[48:51]
    ds_read_b64_tr_b16 v[104:105], v242 offset:43840
    v_mfma_f32_16x16x32_bf16 v[52:55], v[140:143], v[172:175], v[52:55]
    ds_read_b64_tr_b16 v[106:107], v242 offset:43904
    v_mfma_f32_16x16x32_bf16 v[56:59], v[144:147], v[168:171], v[56:59]
    ds_read_b64_tr_b16 v[108:109], v243 offset:43840
    v_mfma_f32_16x16x32_bf16 v[60:63], v[144:147], v[172:175], v[60:63]
    ds_read_b64_tr_b16 v[110:111], v243 offset:43904
    s_waitcnt lgkmcnt(14)
    v_mfma_f32_16x16x32_bf16 v[64:67], v[148:151], v[168:171], v[64:67]
    ds_read_b64_tr_b16 v[112:113], v242 offset:48064
    v_mfma_f32_16x16x32_bf16 v[68:71], v[148:151], v[172:175], v[68:71]
    ds_read_b64_tr_b16 v[114:115], v242 offset:48128
    v_mfma_f32_16x16x32_bf16 v[72:75], v[152:155], v[168:171], v[72:75]
    ds_read_b64_tr_b16 v[116:117], v243 offset:48064
    v_mfma_f32_16x16x32_bf16 v[76:79], v[152:155], v[172:175], v[76:79]
    ds_read_b64_tr_b16 v[118:119], v243 offset:48128
    v_mfma_f32_16x16x32_bf16 v[80:83], v[156:159], v[168:171], v[80:83]
    ds_read_b64_tr_b16 v[120:121], v244 offset:52288
    v_mfma_f32_16x16x32_bf16 v[84:87], v[156:159], v[172:175], v[84:87]
    ds_read_b64_tr_b16 v[122:123], v244 offset:52352
    s_waitcnt lgkmcnt(12)
    v_mfma_f32_16x16x32_bf16 v[16:19], v[88:91], v[160:163], v[16:19]
    ds_read_b128 v[168:171], v241 offset:35392
    v_mfma_f32_16x16x32_bf16 v[20:23], v[88:91], v[164:167], v[20:23]
    ds_read_b128 v[172:175], v241 offset:37440
    v_mfma_f32_16x16x32_bf16 v[24:27], v[92:95], v[160:163], v[24:27]
    ds_read_b64_tr_b16 v[124:125], v242 offset:35904
    ds_read_b64_tr_b16 v[126:127], v242 offset:35968
    v_mfma_f32_16x16x32_bf16 v[28:31], v[92:95], v[164:167], v[28:31]
    ds_read_b64_tr_b16 v[128:129], v243 offset:35904
    ds_read_b64_tr_b16 v[130:131], v243 offset:35968
    v_mfma_f32_16x16x32_bf16 v[32:35], v[96:99], v[160:163], v[32:35]
    ds_read_b64_tr_b16 v[132:133], v242 offset:40128
    v_mfma_f32_16x16x32_bf16 v[36:39], v[96:99], v[164:167], v[36:39]
    ds_read_b64_tr_b16 v[134:135], v242 offset:40192
    s_waitcnt lgkmcnt(14)
    v_mfma_f32_16x16x32_bf16 v[40:43], v[100:103], v[160:163], v[40:43]
    ds_read_b64_tr_b16 v[136:137], v243 offset:40128
    v_mfma_f32_16x16x32_bf16 v[44:47], v[100:103], v[164:167], v[44:47]
    ds_read_b64_tr_b16 v[138:139], v243 offset:40192
    v_mfma_f32_16x16x32_bf16 v[48:51], v[104:107], v[160:163], v[48:51]
    ds_read_b64_tr_b16 v[140:141], v242 offset:44352
    v_mfma_f32_16x16x32_bf16 v[52:55], v[104:107], v[164:167], v[52:55]
    ds_read_b64_tr_b16 v[142:143], v242 offset:44416
    v_mfma_f32_16x16x32_bf16 v[56:59], v[108:111], v[160:163], v[56:59]
    ds_read_b64_tr_b16 v[144:145], v243 offset:44352
    v_mfma_f32_16x16x32_bf16 v[60:63], v[108:111], v[164:167], v[60:63]
    ds_read_b64_tr_b16 v[146:147], v243 offset:44416
    s_waitcnt lgkmcnt(14)
    v_mfma_f32_16x16x32_bf16 v[64:67], v[112:115], v[160:163], v[64:67]
    ds_read_b64_tr_b16 v[148:149], v242 offset:48576
    v_mfma_f32_16x16x32_bf16 v[68:71], v[112:115], v[164:167], v[68:71]
    ds_read_b64_tr_b16 v[150:151], v242 offset:48640
    v_mfma_f32_16x16x32_bf16 v[72:75], v[116:119], v[160:163], v[72:75]
    ds_read_b64_tr_b16 v[152:153], v243 offset:48576
    v_mfma_f32_16x16x32_bf16 v[76:79], v[116:119], v[164:167], v[76:79]
    ds_read_b64_tr_b16 v[154:155], v243 offset:48640
    v_mfma_f32_16x16x32_bf16 v[80:83], v[120:123], v[160:163], v[80:83]
    ds_read_b64_tr_b16 v[156:157], v244 offset:52800
    v_mfma_f32_16x16x32_bf16 v[84:87], v[120:123], v[164:167], v[84:87]
    ds_read_b64_tr_b16 v[158:159], v244 offset:52864
    s_sub_u32 s56, s56, 1
    s_waitcnt vmcnt(0)
    s_barrier
    s_waitcnt lgkmcnt(12)
    v_mfma_f32_16x16x32_bf16 v[16:19], v[124:127], v[168:171], v[16:19]
    ds_read_b128 v[160:163], v5 offset:0
    v_mfma_f32_16x16x32_bf16 v[20:23], v[124:127], v[172:175], v[20:23]
    ds_read_b128 v[164:167], v5 offset:2048
    v_mfma_f32_16x16x32_bf16 v[24:27], v[128:131], v[168:171], v[24:27]
    ds_read_b64_tr_b16 v[88:89], v2 offset:0
    ds_read_b64_tr_b16 v[90:91], v2 offset:64
    v_mfma_f32_16x16x32_bf16 v[28:31], v[128:131], v[172:175], v[28:31]
    ds_read_b64_tr_b16 v[92:93], v3 offset:0
    ds_read_b64_tr_b16 v[94:95], v3 offset:64
    v_mfma_f32_16x16x32_bf16 v[32:35], v[132:135], v[168:171], v[32:35]
    ds_read_b64_tr_b16 v[96:97], v2 offset:4224
    v_mfma_f32_16x16x32_bf16 v[36:39], v[132:135], v[172:175], v[36:39]
    ds_read_b64_tr_b16 v[98:99], v2 offset:4288
    s_waitcnt lgkmcnt(14)
    v_mfma_f32_16x16x32_bf16 v[40:43], v[136:139], v[168:171], v[40:43]
    ds_read_b64_tr_b16 v[100:101], v3 offset:4224
    v_mfma_f32_16x16x32_bf16 v[44:47], v[136:139], v[172:175], v[44:47]
    ds_read_b64_tr_b16 v[102:103], v3 offset:4288
    v_mfma_f32_16x16x32_bf16 v[48:51], v[140:143], v[168:171], v[48:51]
    ds_read_b64_tr_b16 v[104:105], v2 offset:8448
    v_mfma_f32_16x16x32_bf16 v[52:55], v[140:143], v[172:175], v[52:55]
    ds_read_b64_tr_b16 v[106:107], v2 offset:8512
    v_mfma_f32_16x16x32_bf16 v[56:59], v[144:147], v[168:171], v[56:59]
    ds_read_b64_tr_b16 v[108:109], v3 offset:8448
    v_mfma_f32_16x16x32_bf16 v[60:63], v[144:147], v[172:175], v[60:63]
    ds_read_b64_tr_b16 v[110:111], v3 offset:8512
    s_waitcnt lgkmcnt(14)
    v_mfma_f32_16x16x32_bf16 v[64:67], v[148:151], v[168:171], v[64:67]
    ds_read_b64_tr_b16 v[112:113], v2 offset:12672
    v_mfma_f32_16x16x32_bf16 v[68:71], v[148:151], v[172:175], v[68:71]
    ds_read_b64_tr_b16 v[114:115], v2 offset:12736
    v_mfma_f32_16x16x32_bf16 v[72:75], v[152:155], v[168:171], v[72:75]
    ds_read_b64_tr_b16 v[116:117], v3 offset:12672
    v_mfma_f32_16x16x32_bf16 v[76:79], v[152:155], v[172:175], v[76:79]
    ds_read_b64_tr_b16 v[118:119], v3 offset:12736
    v_mfma_f32_16x16x32_bf16 v[80:83], v[156:159], v[168:171], v[80:83]
    ds_read_b64_tr_b16 v[120:121], v4 offset:16896
    v_mfma_f32_16x16x32_bf16 v[84:87], v[156:159], v[172:175], v[84:87]
    ds_read_b64_tr_b16 v[122:123], v4 offset:16960
    s_cmp_lg_u32 s56, 0
    s_cbranch_scc1 recurrent_scan__sliding_local_dilated__mixer_gmlp__prompt_kernel_Bloop
    ds_read_b32 v11, v10 offset:64
    ds_read_b32 v10, v10
    s_waitcnt lgkmcnt(0)
    s_barrier
    s_add_u32 s40, s60, 0
    v_add_f32 v16, v10, v16
    v_add_f32 v17, v10, v17
    v_lshlrev_b32 v176, 16, v204
    v_and_b32 v177, 0xffff0000, v204
    v_mul_f32 v176, v176, v16
    v_mul_f32 v177, v177, v17
    v_cvt_pk_bf16_f32 v204, v176, v177
    v_add_f32 v18, v10, v18
    v_add_f32 v19, v10, v19
    v_lshlrev_b32 v180, 16, v205
    v_and_b32 v181, 0xffff0000, v205
    v_mul_f32 v180, v180, v18
    v_mul_f32 v181, v181, v19
    v_cvt_pk_bf16_f32 v205, v180, v181
    v_add_f32 v24, v10, v24
    v_add_f32 v25, v10, v25
    v_lshlrev_b32 v176, 16, v206
    v_and_b32 v177, 0xffff0000, v206
    v_mul_f32 v176, v176, v24
    v_mul_f32 v177, v177, v25
    v_cvt_pk_bf16_f32 v206, v176, v177
    v_add_f32 v26, v10, v26
    v_add_f32 v27, v10, v27
    v_lshlrev_b32 v180, 16, v207
    v_and_b32 v181, 0xffff0000, v207
    v_mul_f32 v180, v180, v26
    v_mul_f32 v181, v181, v27
    v_cvt_pk_bf16_f32 v207, v180, v181
    buffer_store_dwordx4 v[204:207], v7, s[20:23], s40 offen offset:0 sc1
    v_add_f32 v20, v11, v20
    v_add_f32 v21, v11, v21
    v_lshlrev_b32 v176, 16, v208
    v_and_b32 v177, 0xffff0000, v208
    v_mul_f32 v176, v176, v20
    v_mul_f32 v177, v177, v21
    v_cvt_pk_bf16_f32 v208, v176, v177
    v_add_f32 v22, v11, v22
    v_add_f32 v23, v11, v23
    v_lshlrev_b32 v180, 16, v209
    v_and_b32 v181, 0xffff0000, v209
    v_mul_f32 v180, v180, v22
    v_mul_f32 v181, v181, v23
    v_cvt_pk_bf16_f32 v209, v180, v181
    v_add_f32 v28, v11, v28
    v_add_f32 v29, v11, v29
    v_lshlrev_b32 v176, 16, v210
    v_and_b32 v177, 0xffff0000, v210
    v_mul_f32 v176, v176, v28
    v_mul_f32 v177, v177, v29
    v_cvt_pk_bf16_f32 v210, v176, v177
    v_add_f32 v30, v11, v30
    v_add_f32 v31, v11, v31
    v_lshlrev_b32 v180, 16, v211
    v_and_b32 v181, 0xffff0000, v211
    v_mul_f32 v180, v180, v30
    v_mul_f32 v181, v181, v31
    v_cvt_pk_bf16_f32 v211, v180, v181
    buffer_store_dwordx4 v[208:211], v7, s[20:23], s40 offen offset:256 sc1
    s_add_u32 s40, s60, 131072
    v_add_f32 v32, v10, v32
    v_add_f32 v33, v10, v33
    v_lshlrev_b32 v176, 16, v212
    v_and_b32 v177, 0xffff0000, v212
    v_mul_f32 v176, v176, v32
    v_mul_f32 v177, v177, v33
    v_cvt_pk_bf16_f32 v212, v176, v177
    v_add_f32 v34, v10, v34
    v_add_f32 v35, v10, v35
    v_lshlrev_b32 v180, 16, v213
    v_and_b32 v181, 0xffff0000, v213
    v_mul_f32 v180, v180, v34
    v_mul_f32 v181, v181, v35
    v_cvt_pk_bf16_f32 v213, v180, v181
    v_add_f32 v40, v10, v40
    v_add_f32 v41, v10, v41
    v_lshlrev_b32 v176, 16, v214
    v_and_b32 v177, 0xffff0000, v214
    v_mul_f32 v176, v176, v40
    v_mul_f32 v177, v177, v41
    v_cvt_pk_bf16_f32 v214, v176, v177
    v_add_f32 v42, v10, v42
    v_add_f32 v43, v10, v43
    v_lshlrev_b32 v180, 16, v215
    v_and_b32 v181, 0xffff0000, v215
    v_mul_f32 v180, v180, v42
    v_mul_f32 v181, v181, v43
    v_cvt_pk_bf16_f32 v215, v180, v181
    buffer_store_dwordx4 v[212:215], v7, s[20:23], s40 offen offset:0 sc1
    v_add_f32 v36, v11, v36
    v_add_f32 v37, v11, v37
    v_lshlrev_b32 v176, 16, v216
    v_and_b32 v177, 0xffff0000, v216
    v_mul_f32 v176, v176, v36
    v_mul_f32 v177, v177, v37
    v_cvt_pk_bf16_f32 v216, v176, v177
    v_add_f32 v38, v11, v38
    v_add_f32 v39, v11, v39
    v_lshlrev_b32 v180, 16, v217
    v_and_b32 v181, 0xffff0000, v217
    v_mul_f32 v180, v180, v38
    v_mul_f32 v181, v181, v39
    v_cvt_pk_bf16_f32 v217, v180, v181
    v_add_f32 v44, v11, v44
    v_add_f32 v45, v11, v45
    v_lshlrev_b32 v176, 16, v218
    v_and_b32 v177, 0xffff0000, v218
    v_mul_f32 v176, v176, v44
    v_mul_f32 v177, v177, v45
    v_cvt_pk_bf16_f32 v218, v176, v177
    v_add_f32 v46, v11, v46
    v_add_f32 v47, v11, v47
    v_lshlrev_b32 v180, 16, v219
    v_and_b32 v181, 0xffff0000, v219
    v_mul_f32 v180, v180, v46
    v_mul_f32 v181, v181, v47
    v_cvt_pk_bf16_f32 v219, v180, v181
    buffer_store_dwordx4 v[216:219], v7, s[20:23], s40 offen offset:256 sc1
    s_add_u32 s40, s60, 262144
    v_add_f32 v48, v10, v48
    v_add_f32 v49, v10, v49
    v_lshlrev_b32 v176, 16, v220
    v_and_b32 v177, 0xffff0000, v220
    v_mul_f32 v176, v176, v48
    v_mul_f32 v177, v177, v49
    v_cvt_pk_bf16_f32 v220, v176, v177
    v_add_f32 v50, v10, v50
    v_add_f32 v51, v10, v51
    v_lshlrev_b32 v180, 16, v221
    v_and_b32 v181, 0xffff0000, v221
    v_mul_f32 v180, v180, v50
    v_mul_f32 v181, v181, v51
    v_cvt_pk_bf16_f32 v221, v180, v181
    v_add_f32 v56, v10, v56
    v_add_f32 v57, v10, v57
    v_lshlrev_b32 v176, 16, v222
    v_and_b32 v177, 0xffff0000, v222
    v_mul_f32 v176, v176, v56
    v_mul_f32 v177, v177, v57
    v_cvt_pk_bf16_f32 v222, v176, v177
    v_add_f32 v58, v10, v58
    v_add_f32 v59, v10, v59
    v_lshlrev_b32 v180, 16, v223
    v_and_b32 v181, 0xffff0000, v223
    v_mul_f32 v180, v180, v58
    v_mul_f32 v181, v181, v59
    v_cvt_pk_bf16_f32 v223, v180, v181
    buffer_store_dwordx4 v[220:223], v7, s[20:23], s40 offen offset:0 sc1
    v_add_f32 v52, v11, v52
    v_add_f32 v53, v11, v53
    v_lshlrev_b32 v176, 16, v224
    v_and_b32 v177, 0xffff0000, v224
    v_mul_f32 v176, v176, v52
    v_mul_f32 v177, v177, v53
    v_cvt_pk_bf16_f32 v224, v176, v177
    v_add_f32 v54, v11, v54
    v_add_f32 v55, v11, v55
    v_lshlrev_b32 v180, 16, v225
    v_and_b32 v181, 0xffff0000, v225
    v_mul_f32 v180, v180, v54
    v_mul_f32 v181, v181, v55
    v_cvt_pk_bf16_f32 v225, v180, v181
    v_add_f32 v60, v11, v60
    v_add_f32 v61, v11, v61
    v_lshlrev_b32 v176, 16, v226
    v_and_b32 v177, 0xffff0000, v226
    v_mul_f32 v176, v176, v60
    v_mul_f32 v177, v177, v61
    v_cvt_pk_bf16_f32 v226, v176, v177
    v_add_f32 v62, v11, v62
    v_add_f32 v63, v11, v63
    v_lshlrev_b32 v180, 16, v227
    v_and_b32 v181, 0xffff0000, v227
    v_mul_f32 v180, v180, v62
    v_mul_f32 v181, v181, v63
    v_cvt_pk_bf16_f32 v227, v180, v181
    buffer_store_dwordx4 v[224:227], v7, s[20:23], s40 offen offset:256 sc1
    s_add_u32 s40, s60, 393216
    v_add_f32 v64, v10, v64
    v_add_f32 v65, v10, v65
    v_lshlrev_b32 v176, 16, v228
    v_and_b32 v177, 0xffff0000, v228
    v_mul_f32 v176, v176, v64
    v_mul_f32 v177, v177, v65
    v_cvt_pk_bf16_f32 v228, v176, v177
    v_add_f32 v66, v10, v66
    v_add_f32 v67, v10, v67
    v_lshlrev_b32 v180, 16, v229
    v_and_b32 v181, 0xffff0000, v229
    v_mul_f32 v180, v180, v66
    v_mul_f32 v181, v181, v67
    v_cvt_pk_bf16_f32 v229, v180, v181
    v_add_f32 v72, v10, v72
    v_add_f32 v73, v10, v73
    v_lshlrev_b32 v176, 16, v230
    v_and_b32 v177, 0xffff0000, v230
    v_mul_f32 v176, v176, v72
    v_mul_f32 v177, v177, v73
    v_cvt_pk_bf16_f32 v230, v176, v177
    v_add_f32 v74, v10, v74
    v_add_f32 v75, v10, v75
    v_lshlrev_b32 v180, 16, v231
    v_and_b32 v181, 0xffff0000, v231
    v_mul_f32 v180, v180, v74
    v_mul_f32 v181, v181, v75
    v_cvt_pk_bf16_f32 v231, v180, v181
    buffer_store_dwordx4 v[228:231], v7, s[20:23], s40 offen offset:0 sc1
    v_add_f32 v68, v11, v68
    v_add_f32 v69, v11, v69
    v_lshlrev_b32 v176, 16, v232
    v_and_b32 v177, 0xffff0000, v232
    v_mul_f32 v176, v176, v68
    v_mul_f32 v177, v177, v69
    v_cvt_pk_bf16_f32 v232, v176, v177
    v_add_f32 v70, v11, v70
    v_add_f32 v71, v11, v71
    v_lshlrev_b32 v180, 16, v233
    v_and_b32 v181, 0xffff0000, v233
    v_mul_f32 v180, v180, v70
    v_mul_f32 v181, v181, v71
    v_cvt_pk_bf16_f32 v233, v180, v181
    v_add_f32 v76, v11, v76
    v_add_f32 v77, v11, v77
    v_lshlrev_b32 v176, 16, v234
    v_and_b32 v177, 0xffff0000, v234
    v_mul_f32 v176, v176, v76
    v_mul_f32 v177, v177, v77
    v_cvt_pk_bf16_f32 v234, v176, v177
    v_add_f32 v78, v11, v78
    v_add_f32 v79, v11, v79
    v_lshlrev_b32 v180, 16, v235
    v_and_b32 v181, 0xffff0000, v235
    v_mul_f32 v180, v180, v78
    v_mul_f32 v181, v181, v79
    v_cvt_pk_bf16_f32 v235, v180, v181
    buffer_store_dwordx4 v[232:235], v7, s[20:23], s40 offen offset:256 sc1
    v_add_f32 v80, v10, v80
    v_add_f32 v81, v10, v81
    v_lshlrev_b32 v176, 16, v236
    v_and_b32 v177, 0xffff0000, v236
    v_mul_f32 v176, v176, v80
    v_mul_f32 v177, v177, v81
    v_cvt_pk_bf16_f32 v236, v176, v177
    v_add_f32 v82, v10, v82
    v_add_f32 v83, v10, v83
    v_lshlrev_b32 v180, 16, v237
    v_and_b32 v181, 0xffff0000, v237
    v_mul_f32 v180, v180, v82
    v_mul_f32 v181, v181, v83
    v_cvt_pk_bf16_f32 v237, v180, v181
    buffer_store_dwordx2 v[236:237], v8, s[20:23], s61 offen offset:0 sc1
    v_add_f32 v84, v11, v84
    v_add_f32 v85, v11, v85
    v_lshlrev_b32 v176, 16, v238
    v_and_b32 v177, 0xffff0000, v238
    v_mul_f32 v176, v176, v84
    v_mul_f32 v177, v177, v85
    v_cvt_pk_bf16_f32 v238, v176, v177
    v_add_f32 v86, v11, v86
    v_add_f32 v87, v11, v87
    v_lshlrev_b32 v180, 16, v239
    v_and_b32 v181, 0xffff0000, v239
    v_mul_f32 v180, v180, v86
    v_mul_f32 v181, v181, v87
    v_cvt_pk_bf16_f32 v239, v180, v181
    buffer_store_dwordx2 v[238:239], v8, s[20:23], s61 offen offset:256 sc1
    s_and_b32 s40, s2, 7
    s_lshr_b32 s41, s2, 3
    s_mul_i32 s42, s40, 29
    s_min_u32 s40, s40, 2
    s_add_u32 s42, s42, s40
    s_add_u32 s42, s42, s41
    s_mul_i32 s43, s42, 7282
    s_lshr_b32 s43, s43, 16
    s_mul_i32 s40, s43, 9
    s_sub_u32 s44, s42, s40
    s_min_u32 s41, s36, 4
    s_mul_i32 s98, s43, 5
    s_add_u32 s98, s98, s41
    s_cmp_ge_u32 s2, 234
    s_cselect_b32 s98, 128, s98
    s_min_u32 s40, s98, 127
    s_lshl_b32 s40, s40, 8
    v_lshrrev_b32 v247, 4, v1
    v_lshlrev_b32 v247, 15, v247
    v_and_b32 v248, 15, v1
    v_lshl_add_u32 v249, v248, 4, v247
    v_add_u32 v247, s40, v249
    s_mov_b32 s40, 9437184
    s_branch recurrent_scan__sliding_local_dilated__mixer_gmlp__prompt_kernel_Cc
recurrent_scan__sliding_local_dilated__mixer_gmlp__prompt_kernel_Bh:
    s_load_dwordx4 s[4:7], s[0:1], 48
    s_load_dwordx2 s[8:9], s[0:1], 16
    s_load_dwordx2 s[10:11], s[0:1], 80
    s_and_b32 s40, s2, 7
    s_lshr_b32 s41, s2, 3
    s_and_b32 s37, s40, 1
    s_lshl_b32 s37, s37, 3
    s_and_b32 s42, s41, 7
    s_add_u32 s37, s37, s42
    s_lshr_b32 s38, s40, 1
    s_lshl_b32 s38, s38, 2
    s_lshr_b32 s42, s41, 3
    s_add_u32 s38, s38, s42
    s_and_b32 s39, s38, 1
    s_mul_i32 s60, s38, 18
    s_lshl_b32 s40, s39, 1
    s_add_u32 s61, s60, 16
    s_lshl_b32 s41, s39, 4
    s_sub_u32 s61, s61, s41
    s_add_u32 s60, s60, s40
    s_lshl_b32 s60, s60, 15
    s_lshl_b32 s61, s61, 15
    s_sub_u32 s58, 73728, s101
    v_lshrrev_b32 v4, 3, v1
    v_and_b32 v5, 7, v1
    v_xor_b32 v5, v5, v4
    v_lshlrev_b32 v5, 4, v5
    v_lshl_add_u32 v2, v4, 12, v5
    v_lshlrev_b32 v3, 4, v1
    s_lshl_b32 s59, s37, 19
    s_lshl_b32 s41, s37, 11
    s_add_u32 s62, s60, s41
    s_add_u32 s63, s61, s41
    s_add_u32 s60, s60, 9437184
    s_add_u32 s61, s61, 9437184
    s_mov_b32 s57, s101
    s_waitcnt lgkmcnt(0)
    s_add_u32 s12, s10, 39845888
    s_addc_u32 s13, s11, 0
    s_mov_b32 s14, 8388608
    s_mov_b32 s15, 0x00020000
    s_add_u32 s16, s10, 0
    s_addc_u32 s17, s11, 0
    s_mov_b32 s18, 25952256
    s_mov_b32 s19, 0x00020000
    s_add_u32 s20, s10, 27262976
    s_addc_u32 s21, s11, 0
    s_mov_b32 s22, 11796480
    s_mov_b32 s23, 0x00020000
    s_add_u32 s24, s10, 50331648
    s_addc_u32 s25, s11, 0
    s_mov_b32 s26, 262144
    s_mov_b32 s27, 0x00020000
    s_mov_b32 s28, s4
    s_mov_b32 s29, s5
    s_mov_b32 s30, 4096
    s_mov_b32 s31, 0x00020000
    s_cmp_ge_u32 s36, 6
    s_cbranch_scc1 recurrent_scan__sliding_local_dilated__mixer_gmlp__prompt_kernel_xt
    v_add_u32 v8, 0, v1
    v_mul_u32_u24 v9, 3277, v8
    v_lshrrev_b32 v9, 18, v9
    v_mul_u32_u24 v10, 80, v9
    v_sub_u32 v8, v8, v10
    v_lshlrev_b32 v8, 4, v8
    v_lshl_add_u32 v4, v9, 15, v8
    v_add_u32 v8, 64, v1
    v_mul_u32_u24 v9, 3277, v8
    v_lshrrev_b32 v9, 18, v9
    v_mul_u32_u24 v10, 80, v9
    v_sub_u32 v8, v8, v10
    v_lshlrev_b32 v8, 4, v8
    v_lshl_add_u32 v5, v9, 15, v8
    v_subrev_u32 v5, 1024, v5
    v_add_u32 v8, 128, v1
    v_mul_u32_u24 v9, 3277, v8
    v_lshrrev_b32 v9, 18, v9
    v_mul_u32_u24 v10, 80, v9
    v_sub_u32 v8, v8, v10
    v_lshlrev_b32 v8, 4, v8
    v_lshl_add_u32 v6, v9, 15, v8
    v_subrev_u32 v6, 2048, v6
    v_add_u32 v8, 192, v1
    v_mul_u32_u24 v9, 3277, v8
    v_lshrrev_b32 v9, 18, v9
    v_mul_u32_u24 v10, 80, v9
    v_sub_u32 v8, v8, v10
    v_lshlrev_b32 v8, 4, v8
    v_lshl_add_u32 v7, v9, 15, v8
    v_subrev_u32 v7, 3072, v7
    s_and_b32 s42, s2, 7
    s_mul_i32 s42, s42, 294912
    s_lshr_b32 s43, s2, 3
    s_lshl_b32 s43, s43, 10
    s_add_u32 s42, s42, s43
    s_lshr_b32 s41, s2, 4
    s_max_u32 s43, s41, 1
    s_sub_u32 s43, s43, 1
    s_lshl_b32 s41, s41, 8
    s_lshl_b32 s43, s43, 8
    s_add_u32 s41, s41, 12288
    s_add_u32 s43, s43, 12288
    v_lshlrev_b32 v8, 2, v1
    s_mov_b32 s56, 0
    s_mov_b32 s40, 20000
recurrent_scan__sliding_local_dilated__mixer_gmlp__prompt_kernel_pq:
    buffer_load_dword v12, v8, s[64:67], s41 offen sc1
    buffer_load_dword v13, v8, s[64:67], s43 offen sc1
    s_waitcnt vmcnt(0)
    v_xor_b32 v12, s100, v12
    v_xor_b32 v13, s100, v13
    v_or_b32 v12, v12, v13
    v_cmp_ne_u32 vcc, 0, v12
    s_sub_u32 s40, s40, 1
    s_cmp_eq_u32 s40, 0
    s_cbranch_scc1 recurrent_scan__sliding_local_dilated__mixer_gmlp__prompt_kernel_pq_ok
    s_cmp_eq_u64 vcc, 0
    s_cbranch_scc1 recurrent_scan__sliding_local_dilated__mixer_gmlp__prompt_kernel_pq_ok
    s_cmp_ge_u32 s56, 2
    s_cbranch_scc1 recurrent_scan__sliding_local_dilated__mixer_gmlp__prompt_kernel_dn_11
    s_waitcnt vmcnt(0)
    s_barrier
    s_cmp_eq_u32 s56, 1
    s_cbranch_scc1 recurrent_scan__sliding_local_dilated__mixer_gmlp__prompt_kernel_dn_12
    s_barrier
recurrent_scan__sliding_local_dilated__mixer_gmlp__prompt_kernel_dn_12:
    s_add_u32 s56, s56, 1
recurrent_scan__sliding_local_dilated__mixer_gmlp__prompt_kernel_dn_11:
    s_sleep 8
    s_branch recurrent_scan__sliding_local_dilated__mixer_gmlp__prompt_kernel_pq
recurrent_scan__sliding_local_dilated__mixer_gmlp__prompt_kernel_pq_ok:
    s_cmp_ge_u32 s56, 2
    s_cbranch_scc1 recurrent_scan__sliding_local_dilated__mixer_gmlp__prompt_kernel_dn_13
    s_waitcnt vmcnt(0)
    s_barrier
    s_cmp_eq_u32 s56, 1
    s_cbranch_scc1 recurrent_scan__sliding_local_dilated__mixer_gmlp__prompt_kernel_dn_14
    s_barrier
recurrent_scan__sliding_local_dilated__mixer_gmlp__prompt_kernel_dn_14:
    s_add_u32 s56, s56, 1
recurrent_scan__sliding_local_dilated__mixer_gmlp__prompt_kernel_dn_13:
    s_cmp_ge_u32 s56, 2
    s_cbranch_scc1 recurrent_scan__sliding_local_dilated__mixer_gmlp__prompt_kernel_dn_15
    s_waitcnt vmcnt(0)
    s_barrier
    s_cmp_eq_u32 s56, 1
    s_cbranch_scc1 recurrent_scan__sliding_local_dilated__mixer_gmlp__prompt_kernel_dn_16
    s_barrier
recurrent_scan__sliding_local_dilated__mixer_gmlp__prompt_kernel_dn_16:
    s_add_u32 s56, s56, 1
recurrent_scan__sliding_local_dilated__mixer_gmlp__prompt_kernel_dn_15:
    s_cmp_eq_u32 s36, 5
    s_cbranch_scc1 recurrent_scan__sliding_local_dilated__mixer_gmlp__prompt_kernel_st1
    s_add_u32 m0, s58, 0
    s_add_u32 s40, s42, 21233408
    buffer_load_dwordx4 v4, s[16:19], s40 offen offset:0 lds
    buffer_load_dwordx4 v5, s[16:19], s40 offen offset:1024 lds
    buffer_load_dwordx4 v6, s[16:19], s40 offen offset:2048 lds
    buffer_load_dwordx4 v7, s[16:19], s40 offen offset:3072 lds
    s_add_u32 m0, s58, 12288
    s_add_u32 s40, s42, 21298944
    buffer_load_dwordx4 v4, s[16:19], s40 offen offset:0 lds
    buffer_load_dwordx4 v5, s[16:19], s40 offen offset:1024 lds
    buffer_load_dwordx4 v6, s[16:19], s40 offen offset:2048 lds
    buffer_load_dwordx4 v7, s[16:19], s40 offen offset:3072 lds
    s_add_u32 m0, s58, 8192
    s_add_u32 s40, s42, 18874368
    buffer_load_dwordx4 v3, s[16:19], s40 offen lds
    s_add_u32 m0, s58, 9216
    s_add_u32 s40, s42, 18907136
    buffer_load_dwordx4 v3, s[16:19], s40 offen lds
    s_add_u32 m0, s58, 10240
    s_add_u32 s40, s42, 18939904
    buffer_load_dwordx4 v3, s[16:19], s40 offen lds
    s_add_u32 m0, s58, 20480
    s_add_u32 s40, s42, 18939904
    buffer_load_dwordx4 v3, s[16:19], s40 offen lds
    s_add_u32 m0, s58, 21504
    s_add_u32 s40, s42, 18972672
    buffer_load_dwordx4 v3, s[16:19], s40 offen lds
    s_add_u32 m0, s58, 22528
    s_add_u32 s40, s42, 19005440
    buffer_load_dwordx4 v3, s[16:19], s40 offen lds
    s_add_u32 m0, s58, 4096
    s_add_u32 s40, s42, 23592704
    buffer_load_dwordx4 v4, s[16:19], s40 offen offset:0 lds
    buffer_load_dwordx4 v5, s[16:19], s40 offen offset:1024 lds
    buffer_load_dwordx4 v6, s[16:19], s40 offen offset:2048 lds
    buffer_load_dwordx4 v7, s[16:19], s40 offen offset:3072 lds
    s_add_u32 m0, s58, 16384
    s_add_u32 s40, s42, 23658240
    buffer_load_dwordx4 v4, s[16:19], s40 offen offset:0 lds
    buffer_load_dwordx4 v5, s[16:19], s40 offen offset:1024 lds
    buffer_load_dwordx4 v6, s[16:19], s40 offen offset:2048 lds
    buffer_load_dwordx4 v7, s[16:19], s40 offen offset:3072 lds
    s_branch recurrent_scan__sliding_local_dilated__mixer_gmlp__prompt_kernel_st2
recurrent_scan__sliding_local_dilated__mixer_gmlp__prompt_kernel_st1:
    s_add_u32 m0, s58, 24576
    s_add_u32 s40, s42, 21364480
    buffer_load_dwordx4 v4, s[16:19], s40 offen offset:0 lds
    buffer_load_dwordx4 v5, s[16:19], s40 offen offset:1024 lds
    buffer_load_dwordx4 v6, s[16:19], s40 offen offset:2048 lds
    buffer_load_dwordx4 v7, s[16:19], s40 offen offset:3072 lds
    s_add_u32 m0, s58, 36864
    s_add_u32 s40, s42, 21430016
    buffer_load_dwordx4 v4, s[16:19], s40 offen offset:0 lds
    buffer_load_dwordx4 v5, s[16:19], s40 offen offset:1024 lds
    buffer_load_dwordx4 v6, s[16:19], s40 offen offset:2048 lds
    buffer_load_dwordx4 v7, s[16:19], s40 offen offset:3072 lds
    s_add_u32 m0, s58, 32768
    s_add_u32 s40, s42, 19005440
    buffer_load_dwordx4 v3, s[16:19], s40 offen lds
    s_add_u32 m0, s58, 33792
    s_add_u32 s40, s42, 19038208
    buffer_load_dwordx4 v3, s[16:19], s40 offen lds
    s_add_u32 m0, s58, 34816
    s_add_u32 s40, s42, 19070976
    buffer_load_dwordx4 v3, s[16:19], s40 offen lds
    s_add_u32 m0, s58, 45056
    s_add_u32 s40, s42, 19070976
    buffer_load_dwordx4 v3, s[16:19], s40 offen lds
    s_add_u32 m0, s58, 46080
    s_add_u32 s40, s42, 19103744
    buffer_load_dwordx4 v3, s[16:19], s40 offen lds
    s_add_u32 m0, s58, 47104
    s_add_u32 s40, s42, 19136512
    buffer_load_dwordx4 v3, s[16:19], s40 offen lds
    s_add_u32 m0, s58, 28672
    s_add_u32 s40, s42, 23723776
    buffer_load_dwordx4 v4, s[16:19], s40 offen offset:0 lds
    buffer_load_dwordx4 v5, s[16:19], s40 offen offset:1024 lds
    buffer_load_dwordx4 v6, s[16:19], s40 offen offset:2048 lds
    buffer_load_dwordx4 v7, s[16:19], s40 offen offset:3072 lds
    s_add_u32 m0, s58, 40960
    s_add_u32 s40, s42, 23789312
    buffer_load_dwordx4 v4, s[16:19], s40 offen offset:0 lds
    buffer_load_dwordx4 v5, s[16:19], s40 offen offset:1024 lds
    buffer_load_dwordx4 v6, s[16:19], s40 offen offset:2048 lds
    buffer_load_dwordx4 v7, s[16:19], s40 offen offset:3072 lds
recurrent_scan__sliding_local_dilated__mixer_gmlp__prompt_kernel_st2:
    s_lshl_b32 s42, s37, 7
    v_and_b32 v10, 31, v1
    v_lshlrev_b32 v10, 2, v10
    s_lshl_b32 s43, s36, 2
    s_add_u32 s43, s43, 163808
    v_mov_b32 v8, s43
    v_mov_b32 v9, s100
    s_waitcnt vmcnt(0)
    ds_write_b32 v8, v9
    s_mov_b32 s44, 12288
    s_mov_b32 s45, 13312
    s_mov_b32 s46, 14336
    s_mov_b32 s47, 15360
    s_mov_b32 s40, 20000
recurrent_scan__sliding_local_dilated__mixer_gmlp__prompt_kernel_pz:
    buffer_load_dwordx4 v[16:19], v3, s[64:67], s44 offen sc1
    buffer_load_dwordx4 v[20:23], v3, s[64:67], s45 offen sc1
    buffer_load_dwordx4 v[24:27], v3, s[64:67], s46 offen sc1
    buffer_load_dwordx4 v[28:31], v3, s[64:67], s47 offen sc1
    buffer_load_dword v32, v10, s[64:67], s42 offen sc1
    s_waitcnt vmcnt(0)
    v_xor_b32 v16, s100, v16
    v_xor_b32 v17, s100, v17
    v_xor_b32 v18, s100, v18
    v_xor_b32 v19, s100, v19
    v_xor_b32 v20, s100, v20
    v_xor_b32 v21, s100, v21
    v_xor_b32 v22, s100, v22
    v_xor_b32 v23, s100, v23
    v_xor_b32 v24, s100, v24
    v_xor_b32 v25, s100, v25
    v_xor_b32 v26, s100, v26
    v_xor_b32 v27, s100, v27
    v_xor_b32 v28, s100, v28
    v_xor_b32 v29, s100, v29
    v_xor_b32 v30, s100, v30
    v_xor_b32 v31, s100, v31
    v_xor_b32 v32, s100, v32
    v_or_b32 v16, v16, v17
    v_or_b32 v16, v16, v18
    v_or_b32 v16, v16, v19
    v_or_b32 v16, v16, v20
    v_or_b32 v16, v16, v21
    v_or_b32 v16, v16, v22
    v_or_b32 v16, v16, v23
    v_or_b32 v16, v16, v24
    v_or_b32 v16, v16, v25
    v_or_b32 v16, v16, v26
    v_or_b32 v16, v16, v27
    v_or_b32 v16, v16, v28
    v_or_b32 v16, v16, v29
    v_or_b32 v16, v16, v30
    v_or_b32 v16, v16, v31
    v_or_b32 v16, v16, v32
    v_cmp_ne_u32 vcc, 0, v16
    s_sub_u32 s40, s40, 1
    s_cmp_eq_u32 s40, 0
    s_cbranch_scc1 recurrent_scan__sliding_local_dilated__mixer_gmlp__prompt_kernel_pz_ok
    s_cmp_eq_u64 vcc, 0
    s_cbranch_scc1 recurrent_scan__sliding_local_dilated__mixer_gmlp__prompt_kernel_pz_ok
    s_sleep 8
    s_branch recurrent_scan__sliding_local_dilated__mixer_gmlp__prompt_kernel_pz
recurrent_scan__sliding_local_dilated__mixer_gmlp__prompt_kernel_pz_ok:
    s_mov_b32 s45, 0
    s_cmp_eq_u32 s36, 5
    s_cbranch_scc1 recurrent_scan__sliding_local_dilated__mixer_gmlp__prompt_kernel_prod1
    s_add_u32 m0, s57, 0
    s_add_u32 s40, s59, 0
    buffer_load_dwordx4 v2, s[12:15], s40 offen  lds
    s_add_u32 m0, s57, 1024
    s_add_u32 s40, s59, 32768
    buffer_load_dwordx4 v2, s[12:15], s40 offen  lds
    s_add_u32 m0, s57, 2048
    s_add_u32 s40, s59, 65536
    buffer_load_dwordx4 v2, s[12:15], s40 offen  lds
    s_add_u32 m0, s57, 3072
    s_add_u32 s40, s59, 98304
    buffer_load_dwordx4 v2, s[12:15], s40 offen  lds
    s_add_u32 m0, s57, 4096
    s_add_u32 s40, s59, 131072
    buffer_load_dwordx4 v2, s[12:15], s40 offen  lds
    s_add_u32 m0, s57, 5120
    s_add_u32 s40, s59, 163840
    buffer_load_dwordx4 v2, s[12:15], s40 offen  lds
    s_add_u32 m0, s57, 6144
    s_add_u32 s40, s59, 196608
    buffer_load_dwordx4 v2, s[12:15], s40 offen  lds
    s_add_u32 m0, s57, 7168
    s_add_u32 s40, s59, 229376
    buffer_load_dwordx4 v2, s[12:15], s40 offen  lds
    s_add_u32 m0, s57, 8192
    s_add_u32 s40, s59, 262144
    buffer_load_dwordx4 v2, s[12:15], s40 offen  lds
    s_add_u32 m0, s57, 9216
    s_add_u32 s40, s59, 294912
    buffer_load_dwordx4 v2, s[12:15], s40 offen  lds
    s_add_u32 m0, s57, 10240
    s_add_u32 s40, s59, 327680
    buffer_load_dwordx4 v2, s[12:15], s40 offen  lds
    s_add_u32 m0, s57, 11264
    s_add_u32 s40, s59, 360448
    buffer_load_dwordx4 v2, s[12:15], s40 offen  lds
    s_add_u32 m0, s57, 12288
    s_add_u32 s40, s59, 393216
    buffer_load_dwordx4 v2, s[12:15], s40 offen  lds
    s_add_u32 m0, s57, 13312
    s_add_u32 s40, s59, 425984
    buffer_load_dwordx4 v2, s[12:15], s40 offen  lds
    s_add_u32 m0, s57, 14336
    s_add_u32 s40, s59, 458752
    buffer_load_dwordx4 v2, s[12:15], s40 offen  lds
    s_add_u32 m0, s57, 15360
    s_add_u32 s40, s59, 491520
    buffer_load_dwordx4 v2, s[12:15], s40 offen  lds
    s_add_u32 m0, s57, 16384
    s_add_u32 s40, s60, 0
    buffer_load_dwordx4 v3, s[16:19], s40 offen  lds
    s_add_u32 s59, s59, 128
    s_add_u32 s60, s60, 1024
    s_add_u32 s61, s61, 1024
    s_add_u32 s45, s45, 1
    s_bitcmp1_b32 s45, 1
    s_cselect_b32 s57, s58, s101
    s_bitcmp1_b32 s45, 0
    s_cselect_b32 s40, 35392, 0
    s_add_u32 s57, s57, s40
    s_add_u32 m0, s57, 0
    s_add_u32 s40, s59, 0
    buffer_load_dwordx4 v2, s[12:15], s40 offen  lds
    s_add_u32 m0, s57, 1024
    s_add_u32 s40, s59, 32768
    buffer_load_dwordx4 v2, s[12:15], s40 offen  lds
    s_add_u32 m0, s57, 2048
    s_add_u32 s40, s59, 65536
    buffer_load_dwordx4 v2, s[12:15], s40 offen  lds
    s_add_u32 m0, s57, 3072
    s_add_u32 s40, s59, 98304
    buffer_load_dwordx4 v2, s[12:15], s40 offen  lds
    s_add_u32 m0, s57, 4096
    s_add_u32 s40, s59, 131072
    buffer_load_dwordx4 v2, s[12:15], s40 offen  lds
    s_add_u32 m0, s57, 5120
    s_add_u32 s40, s59, 163840
    buffer_load_dwordx4 v2, s[12:15], s40 offen  lds
    s_add_u32 m0, s57, 6144
    s_add_u32 s40, s59, 196608
    buffer_load_dwordx4 v2, s[12:15], s40 offen  lds
    s_add_u32 m0, s57, 7168
    s_add_u32 s40, s59, 229376
    buffer_load_dwordx4 v2, s[12:15], s40 offen  lds
    s_add_u32 m0, s57, 8192
    s_add_u32 s40, s59, 262144
    buffer_load_dwordx4 v2, s[12:15], s40 offen  lds
    s_add_u32 m0, s57, 9216
    s_add_u32 s40, s59, 294912
    buffer_load_dwordx4 v2, s[12:15], s40 offen  lds
    s_add_u32 m0, s57, 10240
    s_add_u32 s40, s59, 327680
    buffer_load_dwordx4 v2, s[12:15], s40 offen  lds
    s_add_u32 m0, s57, 11264
    s_add_u32 s40, s59, 360448
    buffer_load_dwordx4 v2, s[12:15], s40 offen  lds
    s_add_u32 m0, s57, 12288
    s_add_u32 s40, s59, 393216
    buffer_load_dwordx4 v2, s[12:15], s40 offen  lds
    s_add_u32 m0, s57, 13312
    s_add_u32 s40, s59, 425984
    buffer_load_dwordx4 v2, s[12:15], s40 offen  lds
    s_add_u32 m0, s57, 14336
    s_add_u32 s40, s59, 458752
    buffer_load_dwordx4 v2, s[12:15], s40 offen  lds
    s_add_u32 m0, s57, 15360
    s_add_u32 s40, s59, 491520
    buffer_load_dwordx4 v2, s[12:15], s40 offen  lds
    s_add_u32 m0, s57, 16384
    s_add_u32 s40, s60, 0
    buffer_load_dwordx4 v3, s[16:19], s40 offen  lds
    s_add_u32 s59, s59, 128
    s_add_u32 s60, s60, 1024
    s_add_u32 s61, s61, 1024
    s_add_u32 s45, s45, 1
    s_bitcmp1_b32 s45, 1
    s_cselect_b32 s57, s58, s101
    s_bitcmp1_b32 s45, 0
    s_cselect_b32 s40, 35392, 0
    s_add_u32 s57, s57, s40
    s_waitcnt vmcnt(17)
    s_barrier
    s_mov_b32 s56, 30
recurrent_scan__sliding_local_dilated__mixer_gmlp__prompt_kernel_Bploop0:
    s_add_u32 m0, s57, 0
    s_add_u32 s40, s59, 0
    buffer_load_dwordx4 v2, s[12:15], s40 offen  lds
    s_add_u32 m0, s57, 1024
    s_add_u32 s40, s59, 32768
    buffer_load_dwordx4 v2, s[12:15], s40 offen  lds
    s_add_u32 m0, s57, 2048
    s_add_u32 s40, s59, 65536
    buffer_load_dwordx4 v2, s[12:15], s40 offen  lds
    s_add_u32 m0, s57, 3072
    s_add_u32 s40, s59, 98304
    buffer_load_dwordx4 v2, s[12:15], s40 offen  lds
    s_add_u32 m0, s57, 4096
    s_add_u32 s40, s59, 131072
    buffer_load_dwordx4 v2, s[12:15], s40 offen  lds
    s_add_u32 m0, s57, 5120
    s_add_u32 s40, s59, 163840
    buffer_load_dwordx4 v2, s[12:15], s40 offen  lds
    s_add_u32 m0, s57, 6144
    s_add_u32 s40, s59, 196608
    buffer_load_dwordx4 v2, s[12:15], s40 offen  lds
    s_add_u32 m0, s57, 7168
    s_add_u32 s40, s59, 229376
    buffer_load_dwordx4 v2, s[12:15], s40 offen  lds
    s_add_u32 m0, s57, 8192
    s_add_u32 s40, s59, 262144
    buffer_load_dwordx4 v2, s[12:15], s40 offen  lds
    s_add_u32 m0, s57, 9216
    s_add_u32 s40, s59, 294912
    buffer_load_dwordx4 v2, s[12:15], s40 offen  lds
    s_add_u32 m0, s57, 10240
    s_add_u32 s40, s59, 327680
    buffer_load_dwordx4 v2, s[12:15], s40 offen  lds
    s_add_u32 m0, s57, 11264
    s_add_u32 s40, s59, 360448
    buffer_load_dwordx4 v2, s[12:15], s40 offen  lds
    s_add_u32 m0, s57, 12288
    s_add_u32 s40, s59, 393216
    buffer_load_dwordx4 v2, s[12:15], s40 offen  lds
    s_add_u32 m0, s57, 13312
    s_add_u32 s40, s59, 425984
    buffer_load_dwordx4 v2, s[12:15], s40 offen  lds
    s_add_u32 m0, s57, 14336
    s_add_u32 s40, s59, 458752
    buffer_load_dwordx4 v2, s[12:15], s40 offen  lds
    s_add_u32 m0, s57, 15360
    s_add_u32 s40, s59, 491520
    buffer_load_dwordx4 v2, s[12:15], s40 offen  lds
    s_add_u32 m0, s57, 16384
    s_add_u32 s40, s60, 0
    buffer_load_dwordx4 v3, s[16:19], s40 offen  lds
    s_add_u32 s59, s59, 128
    s_add_u32 s60, s60, 1024
    s_add_u32 s61, s61, 1024
    s_add_u32 s45, s45, 1
    s_bitcmp1_b32 s45, 1
    s_cselect_b32 s57, s58, s101
    s_bitcmp1_b32 s45, 0
    s_cselect_b32 s40, 35392, 0
    s_add_u32 s57, s57, s40
    s_waitcnt vmcnt(17)
    s_barrier
    s_sub_u32 s56, s56, 1
    s_cmp_lg_u32 s56, 0
    s_cbranch_scc1 recurrent_scan__sliding_local_dilated__mixer_gmlp__prompt_kernel_Bploop0
    s_branch recurrent_scan__sliding_local_dilated__mixer_gmlp__prompt_kernel_Bpend
recurrent_scan__sliding_local_dilated__mixer_gmlp__prompt_kernel_prod1:
    s_add_u32 m0, s57, 17408
    s_add_u32 s40, s60, 32768
    buffer_load_dwordx4 v3, s[16:19], s40 offen  lds
    s_add_u32 m0, s57, 18496
    s_add_u32 s40, s60, 65536
    buffer_load_dwordx4 v3, s[16:19], s40 offen  lds
    s_add_u32 m0, s57, 19520
    s_add_u32 s40, s60, 98304
    buffer_load_dwordx4 v3, s[16:19], s40 offen  lds
    s_add_u32 m0, s57, 20608
    s_add_u32 s40, s60, 131072
    buffer_load_dwordx4 v3, s[16:19], s40 offen  lds
    s_add_u32 m0, s57, 21632
    s_add_u32 s40, s60, 163840
    buffer_load_dwordx4 v3, s[16:19], s40 offen  lds
    s_add_u32 m0, s57, 22720
    s_add_u32 s40, s60, 196608
    buffer_load_dwordx4 v3, s[16:19], s40 offen  lds
    s_add_u32 m0, s57, 23744
    s_add_u32 s40, s60, 229376
    buffer_load_dwordx4 v3, s[16:19], s40 offen  lds
    s_add_u32 m0, s57, 24832
    s_add_u32 s40, s60, 262144
    buffer_load_dwordx4 v3, s[16:19], s40 offen  lds
    s_add_u32 m0, s57, 25856
    s_add_u32 s40, s60, 294912
    buffer_load_dwordx4 v3, s[16:19], s40 offen  lds
    s_add_u32 m0, s57, 26944
    s_add_u32 s40, s60, 327680
    buffer_load_dwordx4 v3, s[16:19], s40 offen  lds
    s_add_u32 m0, s57, 27968
    s_add_u32 s40, s60, 360448
    buffer_load_dwordx4 v3, s[16:19], s40 offen  lds
    s_add_u32 m0, s57, 29056
    s_add_u32 s40, s60, 393216
    buffer_load_dwordx4 v3, s[16:19], s40 offen  lds
    s_add_u32 m0, s57, 30080
    s_add_u32 s40, s60, 425984
    buffer_load_dwordx4 v3, s[16:19], s40 offen  lds
    s_add_u32 m0, s57, 31168
    s_add_u32 s40, s60, 458752
    buffer_load_dwordx4 v3, s[16:19], s40 offen  lds
    s_add_u32 m0, s57, 32192
    s_add_u32 s40, s60, 491520
    buffer_load_dwordx4 v3, s[16:19], s40 offen  lds
    s_add_u32 m0, s57, 33280
    s_add_u32 s40, s61, 0
    buffer_load_dwordx4 v3, s[16:19], s40 offen  lds
    s_add_u32 m0, s57, 34368
    s_add_u32 s40, s61, 32768
    buffer_load_dwordx4 v3, s[16:19], s40 offen  lds
    s_add_u32 s59, s59, 128
    s_add_u32 s60, s60, 1024
    s_add_u32 s61, s61, 1024
    s_add_u32 s45, s45, 1
    s_bitcmp1_b32 s45, 1
    s_cselect_b32 s57, s58, s101
    s_bitcmp1_b32 s45, 0
    s_cselect_b32 s40, 35392, 0
    s_add_u32 s57, s57, s40
    s_add_u32 m0, s57, 17408
    s_add_u32 s40, s60, 32768
    buffer_load_dwordx4 v3, s[16:19], s40 offen  lds
    s_add_u32 m0, s57, 18496
    s_add_u32 s40, s60, 65536
    buffer_load_dwordx4 v3, s[16:19], s40 offen  lds
    s_add_u32 m0, s57, 19520
    s_add_u32 s40, s60, 98304
    buffer_load_dwordx4 v3, s[16:19], s40 offen  lds
    s_add_u32 m0, s57, 20608
    s_add_u32 s40, s60, 131072
    buffer_load_dwordx4 v3, s[16:19], s40 offen  lds
    s_add_u32 m0, s57, 21632
    s_add_u32 s40, s60, 163840
    buffer_load_dwordx4 v3, s[16:19], s40 offen  lds
    s_add_u32 m0, s57, 22720
    s_add_u32 s40, s60, 196608
    buffer_load_dwordx4 v3, s[16:19], s40 offen  lds
    s_add_u32 m0, s57, 23744
    s_add_u32 s40, s60, 229376
    buffer_load_dwordx4 v3, s[16:19], s40 offen  lds
    s_add_u32 m0, s57, 24832
    s_add_u32 s40, s60, 262144
    buffer_load_dwordx4 v3, s[16:19], s40 offen  lds
    s_add_u32 m0, s57, 25856
    s_add_u32 s40, s60, 294912
    buffer_load_dwordx4 v3, s[16:19], s40 offen  lds
    s_add_u32 m0, s57, 26944
    s_add_u32 s40, s60, 327680
    buffer_load_dwordx4 v3, s[16:19], s40 offen  lds
    s_add_u32 m0, s57, 27968
    s_add_u32 s40, s60, 360448
    buffer_load_dwordx4 v3, s[16:19], s40 offen  lds
    s_add_u32 m0, s57, 29056
    s_add_u32 s40, s60, 393216
    buffer_load_dwordx4 v3, s[16:19], s40 offen  lds
    s_add_u32 m0, s57, 30080
    s_add_u32 s40, s60, 425984
    buffer_load_dwordx4 v3, s[16:19], s40 offen  lds
    s_add_u32 m0, s57, 31168
    s_add_u32 s40, s60, 458752
    buffer_load_dwordx4 v3, s[16:19], s40 offen  lds
    s_add_u32 m0, s57, 32192
    s_add_u32 s40, s60, 491520
    buffer_load_dwordx4 v3, s[16:19], s40 offen  lds
    s_add_u32 m0, s57, 33280
    s_add_u32 s40, s61, 0
    buffer_load_dwordx4 v3, s[16:19], s40 offen  lds
    s_add_u32 m0, s57, 34368
    s_add_u32 s40, s61, 32768
    buffer_load_dwordx4 v3, s[16:19], s40 offen  lds
    s_add_u32 s59, s59, 128
    s_add_u32 s60, s60, 1024
    s_add_u32 s61, s61, 1024
    s_add_u32 s45, s45, 1
    s_bitcmp1_b32 s45, 1
    s_cselect_b32 s57, s58, s101
    s_bitcmp1_b32 s45, 0
    s_cselect_b32 s40, 35392, 0
    s_add_u32 s57, s57, s40
    s_waitcnt vmcnt(17)
    s_barrier
    s_mov_b32 s56, 30
recurrent_scan__sliding_local_dilated__mixer_gmlp__prompt_kernel_Bploop1:
    s_add_u32 m0, s57, 17408
    s_add_u32 s40, s60, 32768
    buffer_load_dwordx4 v3, s[16:19], s40 offen  lds
    s_add_u32 m0, s57, 18496
    s_add_u32 s40, s60, 65536
    buffer_load_dwordx4 v3, s[16:19], s40 offen  lds
    s_add_u32 m0, s57, 19520
    s_add_u32 s40, s60, 98304
    buffer_load_dwordx4 v3, s[16:19], s40 offen  lds
    s_add_u32 m0, s57, 20608
    s_add_u32 s40, s60, 131072
    buffer_load_dwordx4 v3, s[16:19], s40 offen  lds
    s_add_u32 m0, s57, 21632
    s_add_u32 s40, s60, 163840
    buffer_load_dwordx4 v3, s[16:19], s40 offen  lds
    s_add_u32 m0, s57, 22720
    s_add_u32 s40, s60, 196608
    buffer_load_dwordx4 v3, s[16:19], s40 offen  lds
    s_add_u32 m0, s57, 23744
    s_add_u32 s40, s60, 229376
    buffer_load_dwordx4 v3, s[16:19], s40 offen  lds
    s_add_u32 m0, s57, 24832
    s_add_u32 s40, s60, 262144
    buffer_load_dwordx4 v3, s[16:19], s40 offen  lds
    s_add_u32 m0, s57, 25856
    s_add_u32 s40, s60, 294912
    buffer_load_dwordx4 v3, s[16:19], s40 offen  lds
    s_add_u32 m0, s57, 26944
    s_add_u32 s40, s60, 327680
    buffer_load_dwordx4 v3, s[16:19], s40 offen  lds
    s_add_u32 m0, s57, 27968
    s_add_u32 s40, s60, 360448
    buffer_load_dwordx4 v3, s[16:19], s40 offen  lds
    s_add_u32 m0, s57, 29056
    s_add_u32 s40, s60, 393216
    buffer_load_dwordx4 v3, s[16:19], s40 offen  lds
    s_add_u32 m0, s57, 30080
    s_add_u32 s40, s60, 425984
    buffer_load_dwordx4 v3, s[16:19], s40 offen  lds
    s_add_u32 m0, s57, 31168
    s_add_u32 s40, s60, 458752
    buffer_load_dwordx4 v3, s[16:19], s40 offen  lds
    s_add_u32 m0, s57, 32192
    s_add_u32 s40, s60, 491520
    buffer_load_dwordx4 v3, s[16:19], s40 offen  lds
    s_add_u32 m0, s57, 33280
    s_add_u32 s40, s61, 0
    buffer_load_dwordx4 v3, s[16:19], s40 offen  lds
    s_add_u32 m0, s57, 34368
    s_add_u32 s40, s61, 32768
    buffer_load_dwordx4 v3, s[16:19], s40 offen  lds
    s_add_u32 s59, s59, 128
    s_add_u32 s60, s60, 1024
    s_add_u32 s61, s61, 1024
    s_add_u32 s45, s45, 1
    s_bitcmp1_b32 s45, 1
    s_cselect_b32 s57, s58, s101
    s_bitcmp1_b32 s45, 0
    s_cselect_b32 s40, 35392, 0
    s_add_u32 s57, s57, s40
    s_waitcnt vmcnt(17)
    s_barrier
    s_sub_u32 s56, s56, 1
    s_cmp_lg_u32 s56, 0
    s_cbranch_scc1 recurrent_scan__sliding_local_dilated__mixer_gmlp__prompt_kernel_Bploop1
    s_branch recurrent_scan__sliding_local_dilated__mixer_gmlp__prompt_kernel_Bpend
recurrent_scan__sliding_local_dilated__mixer_gmlp__prompt_kernel_Bpend:
    s_waitcnt vmcnt(0)
    s_barrier
    s_branch recurrent_scan__sliding_local_dilated__mixer_gmlp__prompt_kernel_Cp
recurrent_scan__sliding_local_dilated__mixer_gmlp__prompt_kernel_xt:
    s_cmp_eq_u32 s36, 7
    s_cbranch_scc1 recurrent_scan__sliding_local_dilated__mixer_gmlp__prompt_kernel_xtrb
    s_mul_i32 s41, s2, 10368
    s_add_u32 s68, s6, s41
    s_addc_u32 s69, s7, 0
    s_mul_i32 s41, s2, 2688
    s_min_u32 s41, s41, 660864
    s_add_u32 s70, s8, s41
    s_addc_u32 s71, s9, 0
    s_lshl_b32 s42, s2, 2
    s_add_u32 s42, s42, 4096
    v_mov_b32 v4, 0
    v_mov_b32 v5, s100
    s_barrier
    s_barrier
    s_waitcnt vmcnt(0)
    s_barrier
    s_load_dword s74, s[70:71], 0
    s_load_dword s75, s[70:71], 64
    s_load_dword s76, s[70:71], 128
    s_load_dword s77, s[70:71], 192
    s_load_dword s78, s[70:71], 256
    s_load_dword s79, s[70:71], 320
    s_load_dword s74, s[70:71], 384
    s_load_dword s75, s[70:71], 448
    s_load_dword s76, s[70:71], 512
    s_load_dword s77, s[70:71], 576
    s_barrier
    s_load_dword s78, s[70:71], 640
    s_load_dword s79, s[70:71], 704
    s_load_dword s74, s[70:71], 768
    s_load_dword s75, s[70:71], 832
    s_load_dword s76, s[70:71], 896
    s_load_dword s77, s[70:71], 960
    s_load_dword s78, s[70:71], 1024
    s_load_dword s79, s[70:71], 1088
    s_load_dword s74, s[70:71], 1152
    s_load_dword s75, s[70:71], 1216
    s_barrier
    s_load_dword s76, s[70:71], 1280
    s_load_dword s77, s[70:71], 1344
    s_load_dword s78, s[70:71], 1408
    s_load_dword s79, s[70:71], 1472
    s_load_dword s74, s[70:71], 1536
    s_load_dword s75, s[70:71], 1600
    s_load_dword s76, s[70:71], 1664
    s_load_dword s77, s[70:71], 1728
    s_load_dword s78, s[70:71], 1792
    s_load_dword s79, s[70:71], 1856
    buffer_store_dword v5, v4, s[64:67], s42 offen sc1
    s_barrier
    s_load_dword s74, s[70:71], 1920
    s_load_dword s75, s[70:71], 1984
    s_load_dword s76, s[70:71], 2048
    s_load_dword s77, s[70:71], 2112
    s_load_dword s78, s[70:71], 2176
    s_load_dword s79, s[70:71], 2240
    s_load_dword s74, s[70:71], 2304
    s_load_dword s75, s[70:71], 2368
    s_load_dword s76, s[70:71], 2432
    s_load_dword s77, s[70:71], 2496
    s_barrier
    s_load_dword s78, s[70:71], 2560
    s_load_dword s79, s[70:71], 2624
    s_load_dword s74, s[68:69], 0
    s_load_dword s75, s[68:69], 64
    s_load_dword s76, s[68:69], 128
    s_load_dword s77, s[68:69], 192
    s_load_dword s78, s[68:69], 256
    s_load_dword s79, s[68:69], 320
    s_load_dword s74, s[68:69], 384
    s_load_dword s75, s[68:69], 448
    s_barrier
    s_load_dword s76, s[68:69], 512
    s_load_dword s77, s[68:69], 576
    s_load_dword s78, s[68:69], 640
    s_load_dword s79, s[68:69], 704
    s_load_dword s74, s[68:69], 768
    s_load_dword s75, s[68:69], 832
    s_load_dword s76, s[68:69], 896
    s_load_dword s77, s[68:69], 960
    s_load_dword s78, s[68:69], 1024
    s_load_dword s79, s[68:69], 1088
    s_barrier
    s_load_dword s74, s[68:69], 1152
    s_load_dword s75, s[68:69], 1216
    s_load_dword s76, s[68:69], 1280
    s_load_dword s77, s[68:69], 1344
    s_load_dword s78, s[68:69], 1408
    s_load_dword s79, s[68:69], 1472
    s_load_dword s74, s[68:69], 1536
    s_load_dword s75, s[68:69], 1600
    s_load_dword s76, s[68:69], 1664
    s_load_dword s77, s[68:69], 1728
    s_barrier
    s_load_dword s78, s[68:69], 1792
    s_load_dword s79, s[68:69], 1856
    s_load_dword s74, s[68:69], 1920
    s_load_dword s75, s[68:69], 1984
    s_load_dword s76, s[68:69], 2048
    s_load_dword s77, s[68:69], 2112
    s_load_dword s78, s[68:69], 2176
    s_load_dword s79, s[68:69], 2240
    s_load_dword s74, s[68:69], 2304
    s_load_dword s75, s[68:69], 2368
    s_barrier
    s_load_dword s76, s[68:69], 2432
    s_load_dword s77, s[68:69], 2496
    s_load_dword s78, s[68:69], 2560
    s_load_dword s79, s[68:69], 2624
    s_load_dword s74, s[68:69], 2688
    s_load_dword s75, s[68:69], 2752
    s_load_dword s76, s[68:69], 2816
    s_load_dword s77, s[68:69], 2880
    s_load_dword s78, s[68:69], 2944
    s_load_dword s79, s[68:69], 3008
    s_barrier
    s_load_dword s74, s[68:69], 3072
    s_load_dword s75, s[68:69], 3136
    s_load_dword s76, s[68:69], 3200
    s_load_dword s77, s[68:69], 3264
    s_load_dword s78, s[68:69], 3328
    s_load_dword s79, s[68:69], 3392
    s_load_dword s74, s[68:69], 3456
    s_load_dword s75, s[68:69], 3520
    s_load_dword s76, s[68:69], 3584
    s_load_dword s77, s[68:69], 3648
    s_barrier
    s_load_dword s78, s[68:69], 3712
    s_load_dword s79, s[68:69], 3776
    s_load_dword s74, s[68:69], 3840
    s_load_dword s75, s[68:69], 3904
    s_load_dword s76, s[68:69], 3968
    s_load_dword s77, s[68:69], 4032
    s_load_dword s78, s[68:69], 4096
    s_load_dword s79, s[68:69], 4160
    s_load_dword s74, s[68:69], 4224
    s_load_dword s75, s[68:69], 4288
    s_barrier
    s_load_dword s76, s[68:69], 4352
    s_load_dword s77, s[68:69], 4416
    s_load_dword s78, s[68:69], 4480
    s_load_dword s79, s[68:69], 4544
    s_load_dword s74, s[68:69], 4608
    s_load_dword s75, s[68:69], 4672
    s_load_dword s76, s[68:69], 4736
    s_load_dword s77, s[68:69], 4800
    s_load_dword s78, s[68:69], 4864
    s_load_dword s79, s[68:69], 4928
    s_barrier
    s_load_dword s74, s[68:69], 4992
    s_load_dword s75, s[68:69], 5056
    s_load_dword s76, s[68:69], 5120
    s_load_dword s77, s[68:69], 5184
    s_load_dword s78, s[68:69], 5248
    s_load_dword s79, s[68:69], 5312
    s_load_dword s74, s[68:69], 5376
    s_load_dword s75, s[68:69], 5440
    s_load_dword s76, s[68:69], 5504
    s_load_dword s77, s[68:69], 5568
    s_barrier
    s_load_dword s78, s[68:69], 5632
    s_load_dword s79, s[68:69], 5696
    s_load_dword s74, s[68:69], 5760
    s_load_dword s75, s[68:69], 5824
    s_load_dword s76, s[68:69], 5888
    s_load_dword s77, s[68:69], 5952
    s_load_dword s78, s[68:69], 6016
    s_load_dword s79, s[68:69], 6080
    s_load_dword s74, s[68:69], 6144
    s_load_dword s75, s[68:69], 6208
    s_barrier
    s_load_dword s76, s[68:69], 6272
    s_load_dword s77, s[68:69], 6336
    s_load_dword s78, s[68:69], 6400
    s_load_dword s79, s[68:69], 6464
    s_load_dword s74, s[68:69], 6528
    s_load_dword s75, s[68:69], 6592
    s_load_dword s76, s[68:69], 6656
    s_load_dword s77, s[68:69], 6720
    s_load_dword s78, s[68:69], 6784
    s_load_dword s79, s[68:69], 6848
    s_barrier
    s_load_dword s74, s[68:69], 6912
    s_load_dword s75, s[68:69], 6976
    s_load_dword s76, s[68:69], 7040
    s_load_dword s77, s[68:69], 7104
    s_load_dword s78, s[68:69], 7168
    s_load_dword s79, s[68:69], 7232
    s_load_dword s74, s[68:69], 7296
    s_load_dword s75, s[68:69], 7360
    s_load_dword s76, s[68:69], 7424
    s_load_dword s77, s[68:69], 7488
    s_barrier
    s_load_dword s78, s[68:69], 7552
    s_load_dword s79, s[68:69], 7616
    s_load_dword s74, s[68:69], 7680
    s_load_dword s75, s[68:69], 7744
    s_load_dword s76, s[68:69], 7808
    s_load_dword s77, s[68:69], 7872
    s_load_dword s78, s[68:69], 7936
    s_load_dword s79, s[68:69], 8000
    s_load_dword s74, s[68:69], 8064
    s_load_dword s75, s[68:69], 8128
    s_barrier
    s_load_dword s76, s[68:69], 8192
    s_load_dword s77, s[68:69], 8256
    s_load_dword s78, s[68:69], 8320
    s_load_dword s79, s[68:69], 8384
    s_load_dword s74, s[68:69], 8448
    s_load_dword s75, s[68:69], 8512
    s_load_dword s76, s[68:69], 8576
    s_load_dword s77, s[68:69], 8640
    s_load_dword s78, s[68:69], 8704
    s_load_dword s79, s[68:69], 8768
    s_barrier
    s_load_dword s74, s[68:69], 8832
    s_load_dword s75, s[68:69], 8896
    s_load_dword s76, s[68:69], 8960
    s_load_dword s77, s[68:69], 9024
    s_load_dword s78, s[68:69], 9088
    s_load_dword s79, s[68:69], 9152
    s_load_dword s74, s[68:69], 9216
    s_load_dword s75, s[68:69], 9280
    s_load_dword s76, s[68:69], 9344
    s_load_dword s77, s[68:69], 9408
    s_mov_b32 s41, 4096
    s_mov_b32 s40, 20000
recurrent_scan__sliding_local_dilated__mixer_gmlp__prompt_kernel_pe:
    buffer_load_dwordx4 v[8:11], v3, s[64:67], s41 offen sc1
    s_waitcnt vmcnt(0)
    v_xor_b32 v8, s100, v8
    v_xor_b32 v9, s100, v9
    v_xor_b32 v10, s100, v10
    v_xor_b32 v11, s100, v11
    v_or_b32 v8, v8, v9
    v_or_b32 v8, v8, v10
    v_or_b32 v8, v8, v11
    v_cmp_ne_u32 vcc, 0, v8
    s_sub_u32 s40, s40, 1
    s_cmp_eq_u32 s40, 0
    s_cbranch_scc1 recurrent_scan__sliding_local_dilated__mixer_gmlp__prompt_kernel_pe_ok
    s_cmp_eq_u64 vcc, 0
    s_cbranch_scc1 recurrent_scan__sliding_local_dilated__mixer_gmlp__prompt_kernel_pe_ok
    s_sleep 8
    s_branch recurrent_scan__sliding_local_dilated__mixer_gmlp__prompt_kernel_pe
recurrent_scan__sliding_local_dilated__mixer_gmlp__prompt_kernel_pe_ok:
    s_lshl_b32 s42, s37, 9
    s_lshr_b32 s41, s42, 1
    v_lshlrev_b32 v4, 3, v1
    v_lshlrev_b32 v5, 2, v1
    s_barrier
    s_load_dword s78, s[68:69], 9472
    s_load_dword s79, s[68:69], 9536
    s_load_dword s74, s[68:69], 9600
    s_load_dword s75, s[68:69], 9664
    s_load_dword s76, s[68:69], 9728
    s_load_dword s77, s[68:69], 9792
    s_load_dword s78, s[68:69], 9856
    s_load_dword s79, s[68:69], 9920
    s_load_dword s74, s[68:69], 9984
    s_load_dword s75, s[68:69], 10048
    buffer_load_dword v8, v5, s[28:31], s41 offen
    buffer_load_dwordx2 v[16:17], v4, s[24:27], s42 offen
    s_add_u32 s42, s42, 8192
    buffer_load_dwordx2 v[18:19], v4, s[24:27], s42 offen
    s_add_u32 s42, s42, 8192
    buffer_load_dwordx2 v[20:21], v4, s[24:27], s42 offen
    s_add_u32 s42, s42, 8192
    buffer_load_dwordx2 v[22:23], v4, s[24:27], s42 offen
    s_add_u32 s42, s42, 8192
    buffer_load_dwordx2 v[24:25], v4, s[24:27], s42 offen
    s_add_u32 s42, s42, 8192
    buffer_load_dwordx2 v[26:27], v4, s[24:27], s42 offen
    s_add_u32 s42, s42, 8192
    buffer_load_dwordx2 v[28:29], v4, s[24:27], s42 offen
    s_add_u32 s42, s42, 8192
    buffer_load_dwordx2 v[30:31], v4, s[24:27], s42 offen
    s_add_u32 s42, s42, 8192
    s_barrier
    s_load_dword s76, s[68:69], 10112
    s_load_dword s77, s[68:69], 10176
    s_load_dword s78, s[68:69], 10240
    s_load_dword s79, s[68:69], 10304
    buffer_load_dwordx2 v[32:33], v4, s[24:27], s42 offen
    s_add_u32 s42, s42, 8192
    buffer_load_dwordx2 v[34:35], v4, s[24:27], s42 offen
    s_add_u32 s42, s42, 8192
    buffer_load_dwordx2 v[36:37], v4, s[24:27], s42 offen
    s_add_u32 s42, s42, 8192
    buffer_load_dwordx2 v[38:39], v4, s[24:27], s42 offen
    s_add_u32 s42, s42, 8192
    buffer_load_dwordx2 v[40:41], v4, s[24:27], s42 offen
    s_add_u32 s42, s42, 8192
    buffer_load_dwordx2 v[42:43], v4, s[24:27], s42 offen
    s_add_u32 s42, s42, 8192
    buffer_load_dwordx2 v[44:45], v4, s[24:27], s42 offen
    s_add_u32 s42, s42, 8192
    buffer_load_dwordx2 v[46:47], v4, s[24:27], s42 offen
    s_add_u32 s42, s42, 8192
    s_barrier
    buffer_load_dwordx2 v[48:49], v4, s[24:27], s42 offen
    s_add_u32 s42, s42, 8192
    buffer_load_dwordx2 v[50:51], v4, s[24:27], s42 offen
    s_add_u32 s42, s42, 8192
    buffer_load_dwordx2 v[52:53], v4, s[24:27], s42 offen
    s_add_u32 s42, s42, 8192
    buffer_load_dwordx2 v[54:55], v4, s[24:27], s42 offen
    s_add_u32 s42, s42, 8192
    buffer_load_dwordx2 v[56:57], v4, s[24:27], s42 offen
    s_add_u32 s42, s42, 8192
    buffer_load_dwordx2 v[58:59], v4, s[24:27], s42 offen
    s_add_u32 s42, s42, 8192
    buffer_load_dwordx2 v[60:61], v4, s[24:27], s42 offen
    s_add_u32 s42, s42, 8192
    buffer_load_dwordx2 v[62:63], v4, s[24:27], s42 offen
    s_add_u32 s42, s42, 8192
    s_barrier
    buffer_load_dwordx2 v[64:65], v4, s[24:27], s42 offen
    s_add_u32 s42, s42, 8192
    buffer_load_dwordx2 v[66:67], v4, s[24:27], s42 offen
    s_add_u32 s42, s42, 8192
    buffer_load_dwordx2 v[68:69], v4, s[24:27], s42 offen
    s_add_u32 s42, s42, 8192
    buffer_load_dwordx2 v[70:71], v4, s[24:27], s42 offen
    s_add_u32 s42, s42, 8192
    buffer_load_dwordx2 v[72:73], v4, s[24:27], s42 offen
    s_add_u32 s42, s42, 8192
    buffer_load_dwordx2 v[74:75], v4, s[24:27], s42 offen
    s_add_u32 s42, s42, 8192
    buffer_load_dwordx2 v[76:77], v4, s[24:27], s42 offen
    s_add_u32 s42, s42, 8192
    buffer_load_dwordx2 v[78:79], v4, s[24:27], s42 offen
    s_add_u32 s42, s42, 8192
    s_barrier
    s_barrier
    s_barrier
    s_waitcnt vmcnt(0)
    v_add_f32 v16, v16, v18
    v_add_f32 v17, v17, v19
    v_add_f32 v16, v16, v20
    v_add_f32 v17, v17, v21
    v_add_f32 v16, v16, v22
    v_add_f32 v17, v17, v23
    v_add_f32 v16, v16, v24
    v_add_f32 v17, v17, v25
    v_add_f32 v16, v16, v26
    v_add_f32 v17, v17, v27
    v_add_f32 v16, v16, v28
    v_add_f32 v17, v17, v29
    v_add_f32 v16, v16, v30
    v_add_f32 v17, v17, v31
    v_add_f32 v16, v16, v32
    v_add_f32 v17, v17, v33
    v_add_f32 v16, v16, v34
    v_add_f32 v17, v17, v35
    v_add_f32 v16, v16, v36
    v_add_f32 v17, v17, v37
    v_add_f32 v16, v16, v38
    v_add_f32 v17, v17, v39
    v_add_f32 v16, v16, v40
    v_add_f32 v17, v17, v41
    v_add_f32 v16, v16, v42
    v_add_f32 v17, v17, v43
    v_add_f32 v16, v16, v44
    v_add_f32 v17, v17, v45
    v_add_f32 v16, v16, v46
    v_add_f32 v17, v17, v47
    v_add_f32 v16, v16, v48
    v_add_f32 v17, v17, v49
    s_barrier
    v_add_f32 v16, v16, v50
    v_add_f32 v17, v17, v51
    v_add_f32 v16, v16, v52
    v_add_f32 v17, v17, v53
    v_add_f32 v16, v16, v54
    v_add_f32 v17, v17, v55
    v_add_f32 v16, v16, v56
    v_add_f32 v17, v17, v57
    v_add_f32 v16, v16, v58
    v_add_f32 v17, v17, v59
    v_add_f32 v16, v16, v60
    v_add_f32 v17, v17, v61
    v_add_f32 v16, v16, v62
    v_add_f32 v17, v17, v63
    v_add_f32 v16, v16, v64
    v_add_f32 v17, v17, v65
    v_add_f32 v16, v16, v66
    v_add_f32 v17, v17, v67
    v_add_f32 v16, v16, v68
    v_add_f32 v17, v17, v69
    v_add_f32 v16, v16, v70
    v_add_f32 v17, v17, v71
    v_add_f32 v16, v16, v72
    v_add_f32 v17, v17, v73
    v_add_f32 v16, v16, v74
    v_add_f32 v17, v17, v75
    v_add_f32 v16, v16, v76
    v_add_f32 v17, v17, v77
    v_add_f32 v16, v16, v78
    v_add_f32 v17, v17, v79
    s_mov_b32 s40, 0xc0088e99
    v_and_b32 v9, 0xffff0000, v8
    v_lshlrev_b32 v8, 16, v8
    v_fma_f32 v8, v8, s40, -v16
    v_fma_f32 v9, v9, s40, -v17
    v_add_u32 v4, 147456, v4
    ds_write_b64 v4, v[8:9]
    s_waitcnt vmcnt(0) lgkmcnt(0)
    s_and_b32 s40, s2, 7
    s_lshr_b32 s41, s2, 3
    s_mul_i32 s42, s40, 29
    s_min_u32 s40, s40, 2
    s_add_u32 s42, s42, s40
    s_add_u32 s42, s42, s41
    s_mul_i32 s43, s42, 7282
    s_lshr_b32 s43, s43, 16
    s_mul_i32 s40, s43, 9
    s_sub_u32 s44, s42, s40
    s_min_u32 s41, s36, 4
    s_mul_i32 s98, s43, 5
    s_add_u32 s98, s98, s41
    s_cmp_ge_u32 s2, 234
    s_cselect_b32 s98, 128, s98
    s_min_u32 s40, s98, 127
    s_lshl_b32 s40, s40, 8
    v_lshrrev_b32 v247, 4, v1
    v_lshlrev_b32 v247, 15, v247
    v_and_b32 v248, 15, v1
    v_lshl_add_u32 v249, v248, 4, v247
    v_add_u32 v247, s40, v249
    s_mov_b32 s40, 9437184
    s_barrier
    s_barrier
    s_mul_i32 s40, s43, 5
    s_add_u32 s40, s40, 0
    s_min_u32 s40, s40, 127
    s_lshl_b32 s40, s40, 8
    s_add_u32 m0, s101, 0
    s_add_u32 s41, s40, 9437184
    buffer_load_dwordx4 v249, s[20:23], s41 offen lds
    s_add_u32 m0, s101, 1024
    s_add_u32 s41, s40, 9568256
    buffer_load_dwordx4 v249, s[20:23], s41 offen lds
    s_add_u32 m0, s101, 2048
    s_add_u32 s41, s40, 9699328
    buffer_load_dwordx4 v249, s[20:23], s41 offen lds
    s_add_u32 m0, s101, 3072
    s_add_u32 s41, s40, 9830400
    buffer_load_dwordx4 v249, s[20:23], s41 offen lds
    s_add_u32 m0, s101, 4096
    s_add_u32 s41, s40, 9961472
    buffer_load_dwordx4 v249, s[20:23], s41 offen lds
    s_add_u32 m0, s101, 5120
    s_add_u32 s41, s40, 10092544
    buffer_load_dwordx4 v249, s[20:23], s41 offen lds
    s_add_u32 m0, s101, 6144
    s_add_u32 s41, s40, 10223616
    buffer_load_dwordx4 v249, s[20:23], s41 offen lds
    s_add_u32 m0, s101, 7168
    s_add_u32 s41, s40, 10354688
    buffer_load_dwordx4 v249, s[20:23], s41 offen lds
    s_add_u32 m0, s101, 8192
    s_add_u32 s41, s40, 10485760
    buffer_load_dwordx4 v249, s[20:23], s41 offen lds
    s_add_u32 m0, s101, 9216
    s_add_u32 s41, s40, 10616832
    buffer_load_dwordx4 v249, s[20:23], s41 offen lds
    s_add_u32 m0, s101, 10240
    s_add_u32 s41, s40, 10747904
    buffer_load_dwordx4 v249, s[20:23], s41 offen lds
    s_add_u32 m0, s101, 11264
    s_add_u32 s41, s40, 10878976
    buffer_load_dwordx4 v249, s[20:23], s41 offen lds
    s_add_u32 m0, s101, 12288
    s_add_u32 s41, s40, 11010048
    buffer_load_dwordx4 v249, s[20:23], s41 offen lds
    s_add_u32 m0, s101, 13312
    s_add_u32 s41, s40, 11141120
    buffer_load_dwordx4 v249, s[20:23], s41 offen lds
    s_add_u32 m0, s101, 14336
    s_add_u32 s41, s40, 11272192
    buffer_load_dwordx4 v249, s[20:23], s41 offen lds
    s_add_u32 m0, s101, 15360
    s_add_u32 s41, s40, 11403264
    buffer_load_dwordx4 v249, s[20:23], s41 offen lds
    s_add_u32 m0, s101, 16384
    s_add_u32 s41, s40, 11534336
    buffer_load_dwordx4 v249, s[20:23], s41 offen lds
    s_add_u32 m0, s101, 17408
    s_add_u32 s41, s40, 11665408
    buffer_load_dwordx4 v249, s[20:23], s41 offen lds
    s_barrier
    s_mul_i32 s40, s43, 5
    s_add_u32 s40, s40, 3
    s_min_u32 s40, s40, 127
    s_lshl_b32 s40, s40, 8
    s_add_u32 m0, s101, 55296
    s_add_u32 s41, s40, 9437184
    buffer_load_dwordx4 v249, s[20:23], s41 offen lds
    s_add_u32 m0, s101, 56320
    s_add_u32 s41, s40, 9568256
    buffer_load_dwordx4 v249, s[20:23], s41 offen lds
    s_add_u32 m0, s101, 57344
    s_add_u32 s41, s40, 9699328
    buffer_load_dwordx4 v249, s[20:23], s41 offen lds
    s_add_u32 m0, s101, 58368
    s_add_u32 s41, s40, 9830400
    buffer_load_dwordx4 v249, s[20:23], s41 offen lds
    s_add_u32 m0, s101, 59392
    s_add_u32 s41, s40, 9961472
    buffer_load_dwordx4 v249, s[20:23], s41 offen lds
    s_add_u32 m0, s101, 60416
    s_add_u32 s41, s40, 10092544
    buffer_load_dwordx4 v249, s[20:23], s41 offen lds
    s_add_u32 m0, s101, 61440
    s_add_u32 s41, s40, 10223616
    buffer_load_dwordx4 v249, s[20:23], s41 offen lds
    s_add_u32 m0, s101, 62464
    s_add_u32 s41, s40, 10354688
    buffer_load_dwordx4 v249, s[20:23], s41 offen lds
    s_add_u32 m0, s101, 63488
    s_add_u32 s41, s40, 10485760
    buffer_load_dwordx4 v249, s[20:23], s41 offen lds
    s_add_u32 m0, s101, 64512
    s_add_u32 s41, s40, 10616832
    buffer_load_dwordx4 v249, s[20:23], s41 offen lds
    s_add_u32 m0, s101, 65536
    s_add_u32 s41, s40, 10747904
    buffer_load_dwordx4 v249, s[20:23], s41 offen lds
    s_add_u32 m0, s101, 66560
    s_add_u32 s41, s40, 10878976
    buffer_load_dwordx4 v249, s[20:23], s41 offen lds
    s_add_u32 m0, s101, 67584
    s_add_u32 s41, s40, 11010048
    buffer_load_dwordx4 v249, s[20:23], s41 offen lds
    s_add_u32 m0, s101, 68608
    s_add_u32 s41, s40, 11141120
    buffer_load_dwordx4 v249, s[20:23], s41 offen lds
    s_add_u32 m0, s101, 69632
    s_add_u32 s41, s40, 11272192
    buffer_load_dwordx4 v249, s[20:23], s41 offen lds
    s_add_u32 m0, s101, 70656
    s_add_u32 s41, s40, 11403264
    buffer_load_dwordx4 v249, s[20:23], s41 offen lds
    s_add_u32 m0, s101, 71680
    s_add_u32 s41, s40, 11534336
    buffer_load_dwordx4 v249, s[20:23], s41 offen lds
    s_add_u32 m0, s101, 72704
    s_add_u32 s41, s40, 11665408
    buffer_load_dwordx4 v249, s[20:23], s41 offen lds
    s_barrier
    s_barrier
    s_waitcnt vmcnt(0) lgkmcnt(0)
    s_barrier
    s_endpgm
recurrent_scan__sliding_local_dilated__mixer_gmlp__prompt_kernel_xtrb:
    s_barrier
    s_barrier
    s_waitcnt vmcnt(0)
    s_mov_b32 s56, 20
recurrent_scan__sliding_local_dilated__mixer_gmlp__prompt_kernel_xb_loop:
    s_barrier
    s_sub_u32 s56, s56, 1
    s_cmp_lg_u32 s56, 0
    s_cbranch_scc1 recurrent_scan__sliding_local_dilated__mixer_gmlp__prompt_kernel_xb_loop
    s_getpc_b64 s[88:89]
recurrent_scan__sliding_local_dilated__mixer_gmlp__prompt_kernel_pc_17:
    s_sub_u32 s88, s88, recurrent_scan__sliding_local_dilated__mixer_gmlp__prompt_kernel_pc_17-code_begin
    s_subb_u32 s89, s89, 0
    s_mov_b32 s90, code_end-code_begin
    s_mov_b32 s91, 0x00020000
    s_lshr_b32 s92, s2, 3
    s_lshl_b32 s92, s92, 13
    v_lshlrev_b32 v26, 7, v1
    buffer_load_dword v27, v26, s[88:91], s92 offen
    s_and_b32 s40, s2, 7
    s_lshr_b32 s41, s2, 3
    s_mul_i32 s42, s40, 29
    s_min_u32 s40, s40, 2
    s_add_u32 s42, s42, s40
    s_add_u32 s42, s42, s41
    s_mul_i32 s43, s42, 7282
    s_lshr_b32 s43, s43, 16
    s_mul_i32 s40, s43, 9
    s_sub_u32 s44, s42, s40
    s_min_u32 s41, s36, 4
    s_mul_i32 s98, s43, 5
    s_add_u32 s98, s98, s41
    s_cmp_ge_u32 s2, 234
    s_cselect_b32 s98, 128, s98
    s_min_u32 s40, s98, 127
    s_lshl_b32 s40, s40, 8
    v_lshrrev_b32 v247, 4, v1
    v_lshlrev_b32 v247, 15, v247
    v_and_b32 v248, 15, v1
    v_lshl_add_u32 v249, v248, 4, v247
    v_add_u32 v247, s40, v249
    s_mov_b32 s40, 9437184
    buffer_load_dwordx4 v[88:91], v247, s[20:23], s40 offen
    s_add_u32 s40, s40, 131072
    buffer_load_dwordx4 v[92:95], v247, s[20:23], s40 offen
    s_add_u32 s40, s40, 131072
    buffer_load_dwordx4 v[96:99], v247, s[20:23], s40 offen
    s_add_u32 s40, s40, 131072
    s_barrier
    buffer_load_dwordx4 v[100:103], v247, s[20:23], s40 offen
    s_add_u32 s40, s40, 131072
    buffer_load_dwordx4 v[104:107], v247, s[20:23], s40 offen
    s_add_u32 s40, s40, 131072
    buffer_load_dwordx4 v[108:111], v247, s[20:23], s40 offen
    s_add_u32 s40, s40, 131072
    s_barrier
    buffer_load_dwordx4 v[112:115], v247, s[20:23], s40 offen
    s_add_u32 s40, s40, 131072
    buffer_load_dwordx4 v[116:119], v247, s[20:23], s40 offen
    s_add_u32 s40, s40, 131072
    buffer_load_dwordx4 v[120:123], v247, s[20:23], s40 offen
    s_add_u32 s40, s40, 131072
    s_barrier
    buffer_load_dwordx4 v[124:127], v247, s[20:23], s40 offen
    s_add_u32 s40, s40, 131072
    buffer_load_dwordx4 v[128:131], v247, s[20:23], s40 offen
    s_add_u32 s40, s40, 131072
    buffer_load_dwordx4 v[132:135], v247, s[20:23], s40 offen
    s_add_u32 s40, s40, 131072
    s_barrier
    buffer_load_dwordx4 v[136:139], v247, s[20:23], s40 offen
    s_add_u32 s40, s40, 131072
    buffer_load_dwordx4 v[140:143], v247, s[20:23], s40 offen
    s_add_u32 s40, s40, 131072
    buffer_load_dwordx4 v[144:147], v247, s[20:23], s40 offen
    s_add_u32 s40, s40, 131072
    s_barrier
    buffer_load_dwordx4 v[148:151], v247, s[20:23], s40 offen
    s_add_u32 s40, s40, 131072
    buffer_load_dwordx4 v[152:155], v247, s[20:23], s40 offen
    s_add_u32 s40, s40, 131072
    buffer_load_dwordx4 v[156:159], v247, s[20:23], s40 offen
    s_barrier
    s_mov_b32 s56, 3
recurrent_scan__sliding_local_dilated__mixer_gmlp__prompt_kernel_xb_loop2:
    s_barrier
    s_sub_u32 s56, s56, 1
    s_cmp_lg_u32 s56, 0
    s_cbranch_scc1 recurrent_scan__sliding_local_dilated__mixer_gmlp__prompt_kernel_xb_loop2
    s_mul_i32 s40, s43, 5
    s_add_u32 s40, s40, 1
    s_min_u32 s40, s40, 127
    s_lshl_b32 s40, s40, 8
    s_add_u32 m0, s101, 18432
    s_add_u32 s41, s40, 9437184
    buffer_load_dwordx4 v249, s[20:23], s41 offen lds
    s_add_u32 m0, s101, 19456
    s_add_u32 s41, s40, 9568256
    buffer_load_dwordx4 v249, s[20:23], s41 offen lds
    s_add_u32 m0, s101, 20480
    s_add_u32 s41, s40, 9699328
    buffer_load_dwordx4 v249, s[20:23], s41 offen lds
    s_add_u32 m0, s101, 21504
    s_add_u32 s41, s40, 9830400
    buffer_load_dwordx4 v249, s[20:23], s41 offen lds
    s_add_u32 m0, s101, 22528
    s_add_u32 s41, s40, 9961472
    buffer_load_dwordx4 v249, s[20:23], s41 offen lds
    s_add_u32 m0, s101, 23552
    s_add_u32 s41, s40, 10092544
    buffer_load_dwordx4 v249, s[20:23], s41 offen lds
    s_add_u32 m0, s101, 24576
    s_add_u32 s41, s40, 10223616
    buffer_load_dwordx4 v249, s[20:23], s41 offen lds
    s_add_u32 m0, s101, 25600
    s_add_u32 s41, s40, 10354688
    buffer_load_dwordx4 v249, s[20:23], s41 offen lds
    s_add_u32 m0, s101, 26624
    s_add_u32 s41, s40, 10485760
    buffer_load_dwordx4 v249, s[20:23], s41 offen lds
    s_add_u32 m0, s101, 27648
    s_add_u32 s41, s40, 10616832
    buffer_load_dwordx4 v249, s[20:23], s41 offen lds
    s_add_u32 m0, s101, 28672
    s_add_u32 s41, s40, 10747904
    buffer_load_dwordx4 v249, s[20:23], s41 offen lds
    s_add_u32 m0, s101, 29696
    s_add_u32 s41, s40, 10878976
    buffer_load_dwordx4 v249, s[20:23], s41 offen lds
    s_add_u32 m0, s101, 30720
    s_add_u32 s41, s40, 11010048
    buffer_load_dwordx4 v249, s[20:23], s41 offen lds
    s_add_u32 m0, s101, 31744
    s_add_u32 s41, s40, 11141120
    buffer_load_dwordx4 v249, s[20:23], s41 offen lds
    s_add_u32 m0, s101, 32768
    s_add_u32 s41, s40, 11272192
    buffer_load_dwordx4 v249, s[20:23], s41 offen lds
    s_add_u32 m0, s101, 33792
    s_add_u32 s41, s40, 11403264
    buffer_load_dwordx4 v249, s[20:23], s41 offen lds
    s_barrier
    s_mul_i32 s40, s43, 5
    s_add_u32 s40, s40, 1
    s_min_u32 s40, s40, 127
    s_lshl_b32 s40, s40, 8
    s_add_u32 m0, s101, 34816
    s_add_u32 s41, s40, 11534336
    buffer_load_dwordx4 v249, s[20:23], s41 offen lds
    s_add_u32 m0, s101, 35840
    s_add_u32 s41, s40, 11665408
    buffer_load_dwordx4 v249, s[20:23], s41 offen lds
    s_mul_i32 s40, s43, 5
    s_add_u32 s40, s40, 2
    s_min_u32 s40, s40, 127
    s_lshl_b32 s40, s40, 8
    s_add_u32 m0, s101, 36864
    s_add_u32 s41, s40, 9437184
    buffer_load_dwordx4 v249, s[20:23], s41 offen lds
    s_add_u32 m0, s101, 37888
    s_add_u32 s41, s40, 9568256
    buffer_load_dwordx4 v249, s[20:23], s41 offen lds
    s_add_u32 m0, s101, 38912
    s_add_u32 s41, s40, 9699328
    buffer_load_dwordx4 v249, s[20:23], s41 offen lds
    s_add_u32 m0, s101, 39936
    s_add_u32 s41, s40, 9830400
    buffer_load_dwordx4 v249, s[20:23], s41 offen lds
    s_add_u32 m0, s101, 40960
    s_add_u32 s41, s40, 9961472
    buffer_load_dwordx4 v249, s[20:23], s41 offen lds
    s_add_u32 m0, s101, 41984
    s_add_u32 s41, s40, 10092544
    buffer_load_dwordx4 v249, s[20:23], s41 offen lds
    s_add_u32 m0, s101, 43008
    s_add_u32 s41, s40, 10223616
    buffer_load_dwordx4 v249, s[20:23], s41 offen lds
    s_add_u32 m0, s101, 44032
    s_add_u32 s41, s40, 10354688
    buffer_load_dwordx4 v249, s[20:23], s41 offen lds
    s_add_u32 m0, s101, 45056
    s_add_u32 s41, s40, 10485760
    buffer_load_dwordx4 v249, s[20:23], s41 offen lds
    s_add_u32 m0, s101, 46080
    s_add_u32 s41, s40, 10616832
    buffer_load_dwordx4 v249, s[20:23], s41 offen lds
    s_add_u32 m0, s101, 47104
    s_add_u32 s41, s40, 10747904
    buffer_load_dwordx4 v249, s[20:23], s41 offen lds
    s_add_u32 m0, s101, 48128
    s_add_u32 s41, s40, 10878976
    buffer_load_dwordx4 v249, s[20:23], s41 offen lds
    s_add_u32 m0, s101, 49152
    s_add_u32 s41, s40, 11010048
    buffer_load_dwordx4 v249, s[20:23], s41 offen lds
    s_add_u32 m0, s101, 50176
    s_add_u32 s41, s40, 11141120
    buffer_load_dwordx4 v249, s[20:23], s41 offen lds
    s_add_u32 m0, s101, 51200
    s_add_u32 s41, s40, 11272192
    buffer_load_dwordx4 v249, s[20:23], s41 offen lds
    s_add_u32 m0, s101, 52224
    s_add_u32 s41, s40, 11403264
    buffer_load_dwordx4 v249, s[20:23], s41 offen lds
    s_add_u32 m0, s101, 53248
    s_add_u32 s41, s40, 11534336
    buffer_load_dwordx4 v249, s[20:23], s41 offen lds
    s_add_u32 m0, s101, 54272
    s_add_u32 s41, s40, 11665408
    buffer_load_dwordx4 v249, s[20:23], s41 offen lds
    s_barrier
    s_barrier
    s_mov_b32 s99, 0x7f000000
    s_waitcnt vmcnt(0)
    s_branch recurrent_scan__sliding_local_dilated__mixer_gmlp__prompt_kernel_Cc
recurrent_scan__sliding_local_dilated__mixer_gmlp__prompt_kernel_Cc:
    v_mov_b32 v13, 0
    s_cmp_lt_u32 s98, 128
    s_cbranch_scc1 recurrent_scan__sliding_local_dilated__mixer_gmlp__prompt_kernel_Ctile
    s_waitcnt vmcnt(0)
    buffer_store_dword v14, v13, s[64:67], s99 offen sc1
    s_endpgm
recurrent_scan__sliding_local_dilated__mixer_gmlp__prompt_kernel_Ctile:
    s_load_dwordx2 s[4:5], s[0:1], 0
    s_load_dwordx2 s[6:7], s[0:1], 16
    s_load_dwordx4 s[8:11], s[0:1], 56
    s_and_b32 s40, s2, 7
    s_lshr_b32 s41, s2, 3
    s_mul_i32 s42, s40, 29
    s_min_u32 s40, s40, 2
    s_add_u32 s42, s42, s40
    s_add_u32 s42, s42, s41
    s_mul_i32 s37, s42, 7282
    s_lshr_b32 s37, s37, 16
    s_mul_i32 s40, s37, 9
    s_sub_u32 s38, s42, s40
    s_sub_u32 s53, 73728, s101
    v_mov_b32 v12, v247
    v_lshrrev_b32 v56, 4, v1
    v_and_b32 v57, 15, v1
    s_lshl_b32 s40, s98, 4
    v_add_u32 v58, s40, v57
    s_mov_b32 s51, 0
    v_mul_u32_u24 v3, 1152, v58
    v_and_b32 v59, 1, v56
    v_lshl_add_u32 v3, v59, 5, v3
    v_lshrrev_b32 v59, 1, v56
    v_lshl_add_u32 v3, v59, 4, v3
    s_lshl_b32 s41, s38, 7
    v_bfe_u32 v59, v1, 2, 2
    v_lshl_add_u32 v60, v56, 3, v59
    v_lshlrev_b32 v60, 7, v60
    v_and_b32 v61, 3, v1
    v_lshl_add_u32 v60, v61, 3, v60
    v_lshrrev_b32 v59, 1, v59
    v_and_b32 v61, 1, v56
    v_lshl_add_u32 v59, v61, 1, v59
    v_lshl_add_u32 v4, v59, 5, v60
    v_add_u32 v4, s53, v4
    v_xor_b32 v5, 32, v4
    v_xor_b32 v6, 64, v4
    v_xor_b32 v7, 96, v4
    v_add_u32 v8, 65536, v4
    v_add_u32 v9, 65536, v5
    v_add_u32 v10, 65536, v6
    v_add_u32 v11, 65536, v7
    v_mov_b32 v16, 0
    v_mov_b32 v17, 0
    v_mov_b32 v18, 0
    v_mov_b32 v19, 0
    v_mov_b32 v20, 0
    v_mov_b32 v21, 0
    v_mov_b32 v22, 0
    v_mov_b32 v23, 0
    v_mov_b32 v24, 0
    v_mov_b32 v25, 0
    v_mov_b32 v26, 0
    v_mov_b32 v27, 0
    v_mov_b32 v28, 0
    v_mov_b32 v29, 0
    v_mov_b32 v30, 0
    v_mov_b32 v31, 0
    s_mov_b32 s50, 4
    s_barrier
    ds_read_b64_tr_b16 v[160:161], v4 offset:0
    ds_read_b64_tr_b16 v[162:163], v4 offset:512
    ds_read_b64_tr_b16 v[164:165], v5 offset:0
    ds_read_b64_tr_b16 v[166:167], v5 offset:512
    ds_read_b64_tr_b16 v[168:169], v6 offset:0
    ds_read_b64_tr_b16 v[170:171], v6 offset:512
    ds_read_b64_tr_b16 v[172:173], v7 offset:0
    ds_read_b64_tr_b16 v[174:175], v7 offset:512
    ds_read_b64_tr_b16 v[176:177], v4 offset:4096
    ds_read_b64_tr_b16 v[178:179], v4 offset:4608
    ds_read_b64_tr_b16 v[180:181], v5 offset:4096
    ds_read_b64_tr_b16 v[182:183], v5 offset:4608
    ds_read_b64_tr_b16 v[184:185], v6 offset:4096
    ds_read_b64_tr_b16 v[186:187], v6 offset:4608
    ds_read_b64_tr_b16 v[188:189], v7 offset:4096
    ds_read_b64_tr_b16 v[190:191], v7 offset:4608
    s_cmp_ge_u32 s36, 4
    s_cbranch_scc1 recurrent_scan__sliding_local_dilated__mixer_gmlp__prompt_kernel_Cno
    s_mul_i32 s40, s36, 18432
    s_add_u32 s40, s40, s101
    v_lshlrev_b32 v56, 4, v1
    v_add_u32 v56, s40, v56
    ds_read_b128 v[88:91], v56 offset:0
    ds_read_b128 v[92:95], v56 offset:1024
    ds_read_b128 v[96:99], v56 offset:2048
    ds_read_b128 v[100:103], v56 offset:3072
    ds_read_b128 v[104:107], v56 offset:4096
    ds_read_b128 v[108:111], v56 offset:5120
    ds_read_b128 v[112:115], v56 offset:6144
    ds_read_b128 v[116:119], v56 offset:7168
    ds_read_b128 v[120:123], v56 offset:8192
    ds_read_b128 v[124:127], v56 offset:9216
    ds_read_b128 v[128:131], v56 offset:10240
    ds_read_b128 v[132:135], v56 offset:11264
    ds_read_b128 v[136:139], v56 offset:12288
    ds_read_b128 v[140:143], v56 offset:13312
    ds_read_b128 v[144:147], v56 offset:14336
    ds_read_b128 v[148:151], v56 offset:15360
    ds_read_b128 v[152:155], v56 offset:16384
    ds_read_b128 v[156:159], v56 offset:17408
recurrent_scan__sliding_local_dilated__mixer_gmlp__prompt_kernel_Cno:
    s_waitcnt lgkmcnt(0)
    s_mov_b32 s24, s4
    s_mov_b32 s25, s5
    s_mov_b32 s26, 2359296
    s_mov_b32 s27, 0x00020000
    s_mov_b32 s28, s10
    s_mov_b32 s29, s11
    s_mov_b32 s30, 2359296
    s_mov_b32 s31, 0x00020000
    s_barrier
    v_mfma_f32_16x16x32_bf16 v[32:35], v[160:163], v[88:91], 0
    ds_read_b64_tr_b16 v[192:193], v4 offset:8192
    ds_read_b64_tr_b16 v[194:195], v4 offset:8704
    ds_read_b64_tr_b16 v[196:197], v5 offset:8192
    v_mfma_f32_16x16x32_bf16 v[36:39], v[164:167], v[88:91], 0
    ds_read_b64_tr_b16 v[198:199], v5 offset:8704
    ds_read_b64_tr_b16 v[200:201], v6 offset:8192
    ds_read_b64_tr_b16 v[202:203], v6 offset:8704
    v_mfma_f32_16x16x32_bf16 v[40:43], v[168:171], v[88:91], 0
    ds_read_b64_tr_b16 v[204:205], v7 offset:8192
    ds_read_b64_tr_b16 v[206:207], v7 offset:8704
    ds_read_b64_tr_b16 v[208:209], v4 offset:12288
    v_mfma_f32_16x16x32_bf16 v[44:47], v[172:175], v[88:91], 0
    ds_read_b64_tr_b16 v[210:211], v4 offset:12800
    ds_read_b64_tr_b16 v[212:213], v5 offset:12288
    ds_read_b64_tr_b16 v[214:215], v5 offset:12800
    v_mfma_f32_16x16x32_bf16 v[32:35], v[176:179], v[92:95], v[32:35]
    ds_read_b64_tr_b16 v[216:217], v6 offset:12288
    ds_read_b64_tr_b16 v[218:219], v6 offset:12800
    ds_read_b64_tr_b16 v[220:221], v7 offset:12288
    v_mfma_f32_16x16x32_bf16 v[36:39], v[180:183], v[92:95], v[36:39]
    ds_read_b64_tr_b16 v[222:223], v7 offset:12800
    v_mfma_f32_16x16x32_bf16 v[40:43], v[184:187], v[92:95], v[40:43]
    v_mfma_f32_16x16x32_bf16 v[44:47], v[188:191], v[92:95], v[44:47]
    s_waitcnt vmcnt(0)
    buffer_store_dword v14, v13, s[64:67], s99 offen sc1
    buffer_load_dwordx4 v[48:51], v3, s[24:27], s41 offen offset:0
    buffer_load_dwordx4 v[52:55], v3, s[24:27], s41 offen offset:64
    s_waitcnt lgkmcnt(0)
    s_barrier
    v_mfma_f32_16x16x32_bf16 v[32:35], v[192:195], v[96:99], v[32:35]
    ds_read_b64_tr_b16 v[224:225], v4 offset:16384
    ds_read_b64_tr_b16 v[226:227], v4 offset:16896
    ds_read_b64_tr_b16 v[228:229], v5 offset:16384
    v_mfma_f32_16x16x32_bf16 v[36:39], v[196:199], v[96:99], v[36:39]
    ds_read_b64_tr_b16 v[230:231], v5 offset:16896
    ds_read_b64_tr_b16 v[232:233], v6 offset:16384
    ds_read_b64_tr_b16 v[234:235], v6 offset:16896
    v_mfma_f32_16x16x32_bf16 v[40:43], v[200:203], v[96:99], v[40:43]
    ds_read_b64_tr_b16 v[236:237], v7 offset:16384
    ds_read_b64_tr_b16 v[238:239], v7 offset:16896
    ds_read_b64_tr_b16 v[240:241], v4 offset:20480
    v_mfma_f32_16x16x32_bf16 v[44:47], v[204:207], v[96:99], v[44:47]
    ds_read_b64_tr_b16 v[242:243], v4 offset:20992
    ds_read_b64_tr_b16 v[244:245], v5 offset:20480
    ds_read_b64_tr_b16 v[246:247], v5 offset:20992
    v_mfma_f32_16x16x32_bf16 v[32:35], v[208:211], v[100:103], v[32:35]
    ds_read_b64_tr_b16 v[248:249], v6 offset:20480
    ds_read_b64_tr_b16 v[250:251], v6 offset:20992
    ds_read_b64_tr_b16 v[252:253], v7 offset:20480
    v_mfma_f32_16x16x32_bf16 v[36:39], v[212:215], v[100:103], v[36:39]
    ds_read_b64_tr_b16 v[254:255], v7 offset:20992
    v_mfma_f32_16x16x32_bf16 v[40:43], v[216:219], v[100:103], v[40:43]
    v_mfma_f32_16x16x32_bf16 v[44:47], v[220:223], v[100:103], v[44:47]
    s_waitcnt lgkmcnt(0)
    s_barrier
    v_mfma_f32_16x16x32_bf16 v[32:35], v[224:227], v[104:107], v[32:35]
    ds_read_b64_tr_b16 v[160:161], v4 offset:24576
    ds_read_b64_tr_b16 v[162:163], v4 offset:25088
    ds_read_b64_tr_b16 v[164:165], v5 offset:24576
    v_mfma_f32_16x16x32_bf16 v[36:39], v[228:231], v[104:107], v[36:39]
    ds_read_b64_tr_b16 v[166:167], v5 offset:25088
    ds_read_b64_tr_b16 v[168:169], v6 offset:24576
    ds_read_b64_tr_b16 v[170:171], v6 offset:25088
    v_mfma_f32_16x16x32_bf16 v[40:43], v[232:235], v[104:107], v[40:43]
    ds_read_b64_tr_b16 v[172:173], v7 offset:24576
    ds_read_b64_tr_b16 v[174:175], v7 offset:25088
    ds_read_b64_tr_b16 v[176:177], v4 offset:28672
    v_mfma_f32_16x16x32_bf16 v[44:47], v[236:239], v[104:107], v[44:47]
    ds_read_b64_tr_b16 v[178:179], v4 offset:29184
    ds_read_b64_tr_b16 v[180:181], v5 offset:28672
    ds_read_b64_tr_b16 v[182:183], v5 offset:29184
    v_mfma_f32_16x16x32_bf16 v[32:35], v[240:243], v[108:111], v[32:35]
    ds_read_b64_tr_b16 v[184:185], v6 offset:28672
    ds_read_b64_tr_b16 v[186:187], v6 offset:29184
    ds_read_b64_tr_b16 v[188:189], v7 offset:28672
    v_mfma_f32_16x16x32_bf16 v[36:39], v[244:247], v[108:111], v[36:39]
    ds_read_b64_tr_b16 v[190:191], v7 offset:29184
    v_mfma_f32_16x16x32_bf16 v[40:43], v[248:251], v[108:111], v[40:43]
    v_mfma_f32_16x16x32_bf16 v[44:47], v[252:255], v[108:111], v[44:47]
    s_waitcnt lgkmcnt(0)
    s_barrier
    v_mfma_f32_16x16x32_bf16 v[32:35], v[160:163], v[112:115], v[32:35]
    ds_read_b64_tr_b16 v[192:193], v4 offset:32768
    ds_read_b64_tr_b16 v[194:195], v4 offset:33280
    ds_read_b64_tr_b16 v[196:197], v5 offset:32768
    v_mfma_f32_16x16x32_bf16 v[36:39], v[164:167], v[112:115], v[36:39]
    ds_read_b64_tr_b16 v[198:199], v5 offset:33280
    ds_read_b64_tr_b16 v[200:201], v6 offset:32768
    ds_read_b64_tr_b16 v[202:203], v6 offset:33280
    v_mfma_f32_16x16x32_bf16 v[40:43], v[168:171], v[112:115], v[40:43]
    ds_read_b64_tr_b16 v[204:205], v7 offset:32768
    ds_read_b64_tr_b16 v[206:207], v7 offset:33280
    ds_read_b64_tr_b16 v[208:209], v4 offset:36864
    v_mfma_f32_16x16x32_bf16 v[44:47], v[172:175], v[112:115], v[44:47]
    ds_read_b64_tr_b16 v[210:211], v4 offset:37376
    ds_read_b64_tr_b16 v[212:213], v5 offset:36864
    ds_read_b64_tr_b16 v[214:215], v5 offset:37376
    v_mfma_f32_16x16x32_bf16 v[32:35], v[176:179], v[116:119], v[32:35]
    ds_read_b64_tr_b16 v[216:217], v6 offset:36864
    ds_read_b64_tr_b16 v[218:219], v6 offset:37376
    ds_read_b64_tr_b16 v[220:221], v7 offset:36864
    v_mfma_f32_16x16x32_bf16 v[36:39], v[180:183], v[116:119], v[36:39]
    ds_read_b64_tr_b16 v[222:223], v7 offset:37376
    v_mfma_f32_16x16x32_bf16 v[40:43], v[184:187], v[116:119], v[40:43]
    v_mfma_f32_16x16x32_bf16 v[44:47], v[188:191], v[116:119], v[44:47]
    s_waitcnt lgkmcnt(0)
    s_barrier
    v_mfma_f32_16x16x32_bf16 v[32:35], v[192:195], v[120:123], v[32:35]
    ds_read_b64_tr_b16 v[224:225], v4 offset:40960
    ds_read_b64_tr_b16 v[226:227], v4 offset:41472
    ds_read_b64_tr_b16 v[228:229], v5 offset:40960
    v_mfma_f32_16x16x32_bf16 v[36:39], v[196:199], v[120:123], v[36:39]
    ds_read_b64_tr_b16 v[230:231], v5 offset:41472
    ds_read_b64_tr_b16 v[232:233], v6 offset:40960
    ds_read_b64_tr_b16 v[234:235], v6 offset:41472
    v_mfma_f32_16x16x32_bf16 v[40:43], v[200:203], v[120:123], v[40:43]
    ds_read_b64_tr_b16 v[236:237], v7 offset:40960
    ds_read_b64_tr_b16 v[238:239], v7 offset:41472
    ds_read_b64_tr_b16 v[240:241], v4 offset:45056
    v_mfma_f32_16x16x32_bf16 v[44:47], v[204:207], v[120:123], v[44:47]
    ds_read_b64_tr_b16 v[242:243], v4 offset:45568
    ds_read_b64_tr_b16 v[244:245], v5 offset:45056
    ds_read_b64_tr_b16 v[246:247], v5 offset:45568
    v_mfma_f32_16x16x32_bf16 v[32:35], v[208:211], v[124:127], v[32:35]
    ds_read_b64_tr_b16 v[248:249], v6 offset:45056
    ds_read_b64_tr_b16 v[250:251], v6 offset:45568
    ds_read_b64_tr_b16 v[252:253], v7 offset:45056
    v_mfma_f32_16x16x32_bf16 v[36:39], v[212:215], v[124:127], v[36:39]
    ds_read_b64_tr_b16 v[254:255], v7 offset:45568
    v_mfma_f32_16x16x32_bf16 v[40:43], v[216:219], v[124:127], v[40:43]
    v_mfma_f32_16x16x32_bf16 v[44:47], v[220:223], v[124:127], v[44:47]
    s_waitcnt lgkmcnt(0)
    s_barrier
    v_mfma_f32_16x16x32_bf16 v[32:35], v[224:227], v[128:131], v[32:35]
    ds_read_b64_tr_b16 v[160:161], v4 offset:49152
    ds_read_b64_tr_b16 v[162:163], v4 offset:49664
    ds_read_b64_tr_b16 v[164:165], v5 offset:49152
    v_mfma_f32_16x16x32_bf16 v[36:39], v[228:231], v[128:131], v[36:39]
    ds_read_b64_tr_b16 v[166:167], v5 offset:49664
    ds_read_b64_tr_b16 v[168:169], v6 offset:49152
    ds_read_b64_tr_b16 v[170:171], v6 offset:49664
    v_mfma_f32_16x16x32_bf16 v[40:43], v[232:235], v[128:131], v[40:43]
    ds_read_b64_tr_b16 v[172:173], v7 offset:49152
    ds_read_b64_tr_b16 v[174:175], v7 offset:49664
    ds_read_b64_tr_b16 v[176:177], v4 offset:53248
    v_mfma_f32_16x16x32_bf16 v[44:47], v[236:239], v[128:131], v[44:47]
    ds_read_b64_tr_b16 v[178:179], v4 offset:53760
    ds_read_b64_tr_b16 v[180:181], v5 offset:53248
    ds_read_b64_tr_b16 v[182:183], v5 offset:53760
    v_mfma_f32_16x16x32_bf16 v[32:35], v[240:243], v[132:135], v[32:35]
    ds_read_b64_tr_b16 v[184:185], v6 offset:53248
    ds_read_b64_tr_b16 v[186:187], v6 offset:53760
    ds_read_b64_tr_b16 v[188:189], v7 offset:53248
    v_mfma_f32_16x16x32_bf16 v[36:39], v[244:247], v[132:135], v[36:39]
    ds_read_b64_tr_b16 v[190:191], v7 offset:53760
    v_mfma_f32_16x16x32_bf16 v[40:43], v[248:251], v[132:135], v[40:43]
    v_mfma_f32_16x16x32_bf16 v[44:47], v[252:255], v[132:135], v[44:47]
    s_waitcnt lgkmcnt(0)
    s_barrier
    v_mfma_f32_16x16x32_bf16 v[32:35], v[160:163], v[136:139], v[32:35]
    ds_read_b64_tr_b16 v[192:193], v4 offset:57344
    ds_read_b64_tr_b16 v[194:195], v4 offset:57856
    ds_read_b64_tr_b16 v[196:197], v5 offset:57344
    v_mfma_f32_16x16x32_bf16 v[36:39], v[164:167], v[136:139], v[36:39]
    ds_read_b64_tr_b16 v[198:199], v5 offset:57856
    ds_read_b64_tr_b16 v[200:201], v6 offset:57344
    ds_read_b64_tr_b16 v[202:203], v6 offset:57856
    v_mfma_f32_16x16x32_bf16 v[40:43], v[168:171], v[136:139], v[40:43]
    ds_read_b64_tr_b16 v[204:205], v7 offset:57344
    ds_read_b64_tr_b16 v[206:207], v7 offset:57856
    ds_read_b64_tr_b16 v[208:209], v4 offset:61440
    v_mfma_f32_16x16x32_bf16 v[44:47], v[172:175], v[136:139], v[44:47]
    ds_read_b64_tr_b16 v[210:211], v4 offset:61952
    ds_read_b64_tr_b16 v[212:213], v5 offset:61440
    ds_read_b64_tr_b16 v[214:215], v5 offset:61952
    v_mfma_f32_16x16x32_bf16 v[32:35], v[176:179], v[140:143], v[32:35]
    ds_read_b64_tr_b16 v[216:217], v6 offset:61440
    ds_read_b64_tr_b16 v[218:219], v6 offset:61952
    ds_read_b64_tr_b16 v[220:221], v7 offset:61440
    v_mfma_f32_16x16x32_bf16 v[36:39], v[180:183], v[140:143], v[36:39]
    ds_read_b64_tr_b16 v[222:223], v7 offset:61952
    v_mfma_f32_16x16x32_bf16 v[40:43], v[184:187], v[140:143], v[40:43]
    v_mfma_f32_16x16x32_bf16 v[44:47], v[188:191], v[140:143], v[44:47]
    s_waitcnt lgkmcnt(0)
    s_barrier
    v_mfma_f32_16x16x32_bf16 v[32:35], v[192:195], v[144:147], v[32:35]
    ds_read_b64_tr_b16 v[224:225], v8 offset:0
    ds_read_b64_tr_b16 v[226:227], v8 offset:512
    ds_read_b64_tr_b16 v[228:229], v9 offset:0
    v_mfma_f32_16x16x32_bf16 v[36:39], v[196:199], v[144:147], v[36:39]
    ds_read_b64_tr_b16 v[230:231], v9 offset:512
    ds_read_b64_tr_b16 v[232:233], v10 offset:0
    ds_read_b64_tr_b16 v[234:235], v10 offset:512
    v_mfma_f32_16x16x32_bf16 v[40:43], v[200:203], v[144:147], v[40:43]
    ds_read_b64_tr_b16 v[236:237], v11 offset:0
    ds_read_b64_tr_b16 v[238:239], v11 offset:512
    ds_read_b64_tr_b16 v[240:241], v8 offset:4096
    v_mfma_f32_16x16x32_bf16 v[44:47], v[204:207], v[144:147], v[44:47]
    ds_read_b64_tr_b16 v[242:243], v8 offset:4608
    ds_read_b64_tr_b16 v[244:245], v9 offset:4096
    ds_read_b64_tr_b16 v[246:247], v9 offset:4608
    buffer_load_dwordx4 v[88:91], v12, s[20:23], s51 offen
    s_add_u32 s51, s51, 131072
    buffer_load_dwordx4 v[92:95], v12, s[20:23], s51 offen
    s_add_u32 s51, s51, 131072
    buffer_load_dwordx4 v[96:99], v12, s[20:23], s51 offen
    s_add_u32 s51, s51, 131072
    buffer_load_dwordx4 v[100:103], v12, s[20:23], s51 offen
    s_add_u32 s51, s51, 131072
    v_mfma_f32_16x16x32_bf16 v[32:35], v[208:211], v[148:151], v[32:35]
    ds_read_b64_tr_b16 v[248:249], v10 offset:4096
    ds_read_b64_tr_b16 v[250:251], v10 offset:4608
    ds_read_b64_tr_b16 v[252:253], v11 offset:4096
    v_mfma_f32_16x16x32_bf16 v[36:39], v[212:215], v[148:151], v[36:39]
    ds_read_b64_tr_b16 v[254:255], v11 offset:4608
    v_mfma_f32_16x16x32_bf16 v[40:43], v[216:219], v[148:151], v[40:43]
    v_mfma_f32_16x16x32_bf16 v[44:47], v[220:223], v[148:151], v[44:47]
    buffer_load_dwordx4 v[104:107], v12, s[20:23], s51 offen
    s_add_u32 s51, s51, 131072
    buffer_load_dwordx4 v[108:111], v12, s[20:23], s51 offen
    s_add_u32 s51, s51, 131072
    buffer_load_dwordx4 v[112:115], v12, s[20:23], s51 offen
    s_add_u32 s51, s51, 131072
    buffer_load_dwordx4 v[116:119], v12, s[20:23], s51 offen
    s_add_u32 s51, s51, 131072
    s_waitcnt lgkmcnt(0)
    s_barrier
    v_mfma_f32_16x16x32_bf16 v[32:35], v[224:227], v[152:155], v[32:35]
    ds_read_b64_tr_b16 v[160:161], v4 offset:0
    ds_read_b64_tr_b16 v[162:163], v4 offset:512
    ds_read_b64_tr_b16 v[164:165], v5 offset:0
    v_mfma_f32_16x16x32_bf16 v[36:39], v[228:231], v[152:155], v[36:39]
    ds_read_b64_tr_b16 v[166:167], v5 offset:512
    ds_read_b64_tr_b16 v[168:169], v6 offset:0
    ds_read_b64_tr_b16 v[170:171], v6 offset:512
    v_mfma_f32_16x16x32_bf16 v[40:43], v[232:235], v[152:155], v[40:43]
    ds_read_b64_tr_b16 v[172:173], v7 offset:0
    ds_read_b64_tr_b16 v[174:175], v7 offset:512
    ds_read_b64_tr_b16 v[176:177], v4 offset:4096
    v_mfma_f32_16x16x32_bf16 v[44:47], v[236:239], v[152:155], v[44:47]
    ds_read_b64_tr_b16 v[178:179], v4 offset:4608
    ds_read_b64_tr_b16 v[180:181], v5 offset:4096
    ds_read_b64_tr_b16 v[182:183], v5 offset:4608
    buffer_load_dwordx4 v[120:123], v12, s[20:23], s51 offen
    s_add_u32 s51, s51, 131072
    buffer_load_dwordx4 v[124:127], v12, s[20:23], s51 offen
    s_add_u32 s51, s51, 131072
    buffer_load_dwordx4 v[128:131], v12, s[20:23], s51 offen
    s_add_u32 s51, s51, 131072
    buffer_load_dwordx4 v[132:135], v12, s[20:23], s51 offen
    s_add_u32 s51, s51, 131072
    v_mfma_f32_16x16x32_bf16 v[32:35], v[240:243], v[156:159], v[32:35]
    ds_read_b64_tr_b16 v[184:185], v6 offset:4096
    ds_read_b64_tr_b16 v[186:187], v6 offset:4608
    ds_read_b64_tr_b16 v[188:189], v7 offset:4096
    v_mfma_f32_16x16x32_bf16 v[36:39], v[244:247], v[156:159], v[36:39]
    ds_read_b64_tr_b16 v[190:191], v7 offset:4608
    v_mfma_f32_16x16x32_bf16 v[40:43], v[248:251], v[156:159], v[40:43]
    v_mfma_f32_16x16x32_bf16 v[44:47], v[252:255], v[156:159], v[44:47]
    buffer_load_dwordx4 v[136:139], v12, s[20:23], s51 offen
    s_add_u32 s51, s51, 131072
    buffer_load_dwordx4 v[140:143], v12, s[20:23], s51 offen
    s_add_u32 s51, s51, 131072
    buffer_load_dwordx4 v[144:147], v12, s[20:23], s51 offen
    s_add_u32 s51, s51, 131072
    buffer_load_dwordx4 v[148:151], v12, s[20:23], s51 offen
    s_add_u32 s51, s51, 131072
    s_waitcnt lgkmcnt(0)
.p2align 6
recurrent_scan__sliding_local_dilated__mixer_gmlp__prompt_kernel_Cloop:
    s_barrier
    s_waitcnt vmcnt(15)
    v_mfma_f32_16x16x32_bf16 v[16:19], v[160:163], v[88:91], v[16:19]
    ds_read_b64_tr_b16 v[192:193], v4 offset:8192
    ds_read_b64_tr_b16 v[194:195], v4 offset:8704
    ds_read_b64_tr_b16 v[196:197], v5 offset:8192
    v_mfma_f32_16x16x32_bf16 v[20:23], v[164:167], v[88:91], v[20:23]
    ds_read_b64_tr_b16 v[198:199], v5 offset:8704
    ds_read_b64_tr_b16 v[200:201], v6 offset:8192
    ds_read_b64_tr_b16 v[202:203], v6 offset:8704
    v_mfma_f32_16x16x32_bf16 v[24:27], v[168:171], v[88:91], v[24:27]
    ds_read_b64_tr_b16 v[204:205], v7 offset:8192
    ds_read_b64_tr_b16 v[206:207], v7 offset:8704
    ds_read_b64_tr_b16 v[208:209], v4 offset:12288
    v_mfma_f32_16x16x32_bf16 v[28:31], v[172:175], v[88:91], v[28:31]
    ds_read_b64_tr_b16 v[210:211], v4 offset:12800
    ds_read_b64_tr_b16 v[212:213], v5 offset:12288
    ds_read_b64_tr_b16 v[214:215], v5 offset:12800
    buffer_load_dwordx4 v[152:155], v12, s[20:23], s51 offen
    s_add_u32 s51, s51, 131072
    s_waitcnt vmcnt(15)
    v_mfma_f32_16x16x32_bf16 v[16:19], v[176:179], v[92:95], v[16:19]
    ds_read_b64_tr_b16 v[216:217], v6 offset:12288
    ds_read_b64_tr_b16 v[218:219], v6 offset:12800
    ds_read_b64_tr_b16 v[220:221], v7 offset:12288
    v_mfma_f32_16x16x32_bf16 v[20:23], v[180:183], v[92:95], v[20:23]
    ds_read_b64_tr_b16 v[222:223], v7 offset:12800
    v_mfma_f32_16x16x32_bf16 v[24:27], v[184:187], v[92:95], v[24:27]
    v_mfma_f32_16x16x32_bf16 v[28:31], v[188:191], v[92:95], v[28:31]
    buffer_load_dwordx4 v[156:159], v12, s[20:23], s51 offen
    s_add_u32 s51, s51, 131072
    s_waitcnt lgkmcnt(0)
    s_barrier
    s_waitcnt vmcnt(15)
    v_mfma_f32_16x16x32_bf16 v[16:19], v[192:195], v[96:99], v[16:19]
    ds_read_b64_tr_b16 v[224:225], v4 offset:16384
    ds_read_b64_tr_b16 v[226:227], v4 offset:16896
    ds_read_b64_tr_b16 v[228:229], v5 offset:16384
    v_mfma_f32_16x16x32_bf16 v[20:23], v[196:199], v[96:99], v[20:23]
    ds_read_b64_tr_b16 v[230:231], v5 offset:16896
    ds_read_b64_tr_b16 v[232:233], v6 offset:16384
    ds_read_b64_tr_b16 v[234:235], v6 offset:16896
    v_mfma_f32_16x16x32_bf16 v[24:27], v[200:203], v[96:99], v[24:27]
    ds_read_b64_tr_b16 v[236:237], v7 offset:16384
    ds_read_b64_tr_b16 v[238:239], v7 offset:16896
    ds_read_b64_tr_b16 v[240:241], v4 offset:20480
    v_mfma_f32_16x16x32_bf16 v[28:31], v[204:207], v[96:99], v[28:31]
    ds_read_b64_tr_b16 v[242:243], v4 offset:20992
    ds_read_b64_tr_b16 v[244:245], v5 offset:20480
    ds_read_b64_tr_b16 v[246:247], v5 offset:20992
    buffer_load_dwordx4 v[88:91], v12, s[20:23], s51 offen
    s_add_u32 s51, s51, 131072
    s_waitcnt vmcnt(15)
    v_mfma_f32_16x16x32_bf16 v[16:19], v[208:211], v[100:103], v[16:19]
    ds_read_b64_tr_b16 v[248:249], v6 offset:20480
    ds_read_b64_tr_b16 v[250:251], v6 offset:20992
    ds_read_b64_tr_b16 v[252:253], v7 offset:20480
    v_mfma_f32_16x16x32_bf16 v[20:23], v[212:215], v[100:103], v[20:23]
    ds_read_b64_tr_b16 v[254:255], v7 offset:20992
    v_mfma_f32_16x16x32_bf16 v[24:27], v[216:219], v[100:103], v[24:27]
    v_mfma_f32_16x16x32_bf16 v[28:31], v[220:223], v[100:103], v[28:31]
    buffer_load_dwordx4 v[92:95], v12, s[20:23], s51 offen
    s_add_u32 s51, s51, 131072
    s_waitcnt lgkmcnt(0)
    s_barrier
    s_waitcnt vmcnt(15)
    v_mfma_f32_16x16x32_bf16 v[16:19], v[224:227], v[104:107], v[16:19]
    ds_read_b64_tr_b16 v[160:161], v4 offset:24576
    ds_read_b64_tr_b16 v[162:163], v4 offset:25088
    ds_read_b64_tr_b16 v[164:165], v5 offset:24576
    v_mfma_f32_16x16x32_bf16 v[20:23], v[228:231], v[104:107], v[20:23]
    ds_read_b64_tr_b16 v[166:167], v5 offset:25088
    ds_read_b64_tr_b16 v[168:169], v6 offset:24576
    ds_read_b64_tr_b16 v[170:171], v6 offset:25088
    v_mfma_f32_16x16x32_bf16 v[24:27], v[232:235], v[104:107], v[24:27]
    ds_read_b64_tr_b16 v[172:173], v7 offset:24576
    ds_read_b64_tr_b16 v[174:175], v7 offset:25088
    ds_read_b64_tr_b16 v[176:177], v4 offset:28672
    v_mfma_f32_16x16x32_bf16 v[28:31], v[236:239], v[104:107], v[28:31]
    ds_read_b64_tr_b16 v[178:179], v4 offset:29184
    ds_read_b64_tr_b16 v[180:181], v5 offset:28672
    ds_read_b64_tr_b16 v[182:183], v5 offset:29184
    buffer_load_dwordx4 v[96:99], v12, s[20:23], s51 offen
    s_add_u32 s51, s51, 131072
    s_waitcnt vmcnt(15)
    v_mfma_f32_16x16x32_bf16 v[16:19], v[240:243], v[108:111], v[16:19]
    ds_read_b64_tr_b16 v[184:185], v6 offset:28672
    ds_read_b64_tr_b16 v[186:187], v6 offset:29184
    ds_read_b64_tr_b16 v[188:189], v7 offset:28672
    v_mfma_f32_16x16x32_bf16 v[20:23], v[244:247], v[108:111], v[20:23]
    ds_read_b64_tr_b16 v[190:191], v7 offset:29184
    v_mfma_f32_16x16x32_bf16 v[24:27], v[248:251], v[108:111], v[24:27]
    v_mfma_f32_16x16x32_bf16 v[28:31], v[252:255], v[108:111], v[28:31]
    buffer_load_dwordx4 v[100:103], v12, s[20:23], s51 offen
    s_add_u32 s51, s51, 131072
    s_waitcnt lgkmcnt(0)
    s_barrier
    s_waitcnt vmcnt(15)
    v_mfma_f32_16x16x32_bf16 v[16:19], v[160:163], v[112:115], v[16:19]
    ds_read_b64_tr_b16 v[192:193], v4 offset:32768
    ds_read_b64_tr_b16 v[194:195], v4 offset:33280
    ds_read_b64_tr_b16 v[196:197], v5 offset:32768
    v_mfma_f32_16x16x32_bf16 v[20:23], v[164:167], v[112:115], v[20:23]
    ds_read_b64_tr_b16 v[198:199], v5 offset:33280
    ds_read_b64_tr_b16 v[200:201], v6 offset:32768
    ds_read_b64_tr_b16 v[202:203], v6 offset:33280
    v_mfma_f32_16x16x32_bf16 v[24:27], v[168:171], v[112:115], v[24:27]
    ds_read_b64_tr_b16 v[204:205], v7 offset:32768
    ds_read_b64_tr_b16 v[206:207], v7 offset:33280
    ds_read_b64_tr_b16 v[208:209], v4 offset:36864
    v_mfma_f32_16x16x32_bf16 v[28:31], v[172:175], v[112:115], v[28:31]
    ds_read_b64_tr_b16 v[210:211], v4 offset:37376
    ds_read_b64_tr_b16 v[212:213], v5 offset:36864
    ds_read_b64_tr_b16 v[214:215], v5 offset:37376
    buffer_load_dwordx4 v[104:107], v12, s[20:23], s51 offen
    s_add_u32 s51, s51, 131072
    s_waitcnt vmcnt(15)
    v_mfma_f32_16x16x32_bf16 v[16:19], v[176:179], v[116:119], v[16:19]
    ds_read_b64_tr_b16 v[216:217], v6 offset:36864
    ds_read_b64_tr_b16 v[218:219], v6 offset:37376
    ds_read_b64_tr_b16 v[220:221], v7 offset:36864
    v_mfma_f32_16x16x32_bf16 v[20:23], v[180:183], v[116:119], v[20:23]
    ds_read_b64_tr_b16 v[222:223], v7 offset:37376
    v_mfma_f32_16x16x32_bf16 v[24:27], v[184:187], v[116:119], v[24:27]
    v_mfma_f32_16x16x32_bf16 v[28:31], v[188:191], v[116:119], v[28:31]
    buffer_load_dwordx4 v[108:111], v12, s[20:23], s51 offen
    s_add_u32 s51, s51, 131072
    s_waitcnt lgkmcnt(0)
    s_barrier
    s_waitcnt vmcnt(15)
    v_mfma_f32_16x16x32_bf16 v[16:19], v[192:195], v[120:123], v[16:19]
    ds_read_b64_tr_b16 v[224:225], v4 offset:40960
    ds_read_b64_tr_b16 v[226:227], v4 offset:41472
    ds_read_b64_tr_b16 v[228:229], v5 offset:40960
    v_mfma_f32_16x16x32_bf16 v[20:23], v[196:199], v[120:123], v[20:23]
    ds_read_b64_tr_b16 v[230:231], v5 offset:41472
    ds_read_b64_tr_b16 v[232:233], v6 offset:40960
    ds_read_b64_tr_b16 v[234:235], v6 offset:41472
    v_mfma_f32_16x16x32_bf16 v[24:27], v[200:203], v[120:123], v[24:27]
    ds_read_b64_tr_b16 v[236:237], v7 offset:40960
    ds_read_b64_tr_b16 v[238:239], v7 offset:41472
    ds_read_b64_tr_b16 v[240:241], v4 offset:45056
    v_mfma_f32_16x16x32_bf16 v[28:31], v[204:207], v[120:123], v[28:31]
    ds_read_b64_tr_b16 v[242:243], v4 offset:45568
    ds_read_b64_tr_b16 v[244:245], v5 offset:45056
    ds_read_b64_tr_b16 v[246:247], v5 offset:45568
    buffer_load_dwordx4 v[112:115], v12, s[20:23], s51 offen
    s_add_u32 s51, s51, 131072
    s_waitcnt vmcnt(15)
    v_mfma_f32_16x16x32_bf16 v[16:19], v[208:211], v[124:127], v[16:19]
    ds_read_b64_tr_b16 v[248:249], v6 offset:45056
    ds_read_b64_tr_b16 v[250:251], v6 offset:45568
    ds_read_b64_tr_b16 v[252:253], v7 offset:45056
    v_mfma_f32_16x16x32_bf16 v[20:23], v[212:215], v[124:127], v[20:23]
    ds_read_b64_tr_b16 v[254:255], v7 offset:45568
    v_mfma_f32_16x16x32_bf16 v[24:27], v[216:219], v[124:127], v[24:27]
    v_mfma_f32_16x16x32_bf16 v[28:31], v[220:223], v[124:127], v[28:31]
    buffer_load_dwordx4 v[116:119], v12, s[20:23], s51 offen
    s_add_u32 s51, s51, 131072
    s_waitcnt lgkmcnt(0)
    s_barrier
    s_waitcnt vmcnt(15)
    v_mfma_f32_16x16x32_bf16 v[16:19], v[224:227], v[128:131], v[16:19]
    ds_read_b64_tr_b16 v[160:161], v4 offset:49152
    ds_read_b64_tr_b16 v[162:163], v4 offset:49664
    ds_read_b64_tr_b16 v[164:165], v5 offset:49152
    v_mfma_f32_16x16x32_bf16 v[20:23], v[228:231], v[128:131], v[20:23]
    ds_read_b64_tr_b16 v[166:167], v5 offset:49664
    ds_read_b64_tr_b16 v[168:169], v6 offset:49152
    ds_read_b64_tr_b16 v[170:171], v6 offset:49664
    v_mfma_f32_16x16x32_bf16 v[24:27], v[232:235], v[128:131], v[24:27]
    ds_read_b64_tr_b16 v[172:173], v7 offset:49152
    ds_read_b64_tr_b16 v[174:175], v7 offset:49664
    ds_read_b64_tr_b16 v[176:177], v4 offset:53248
    v_mfma_f32_16x16x32_bf16 v[28:31], v[236:239], v[128:131], v[28:31]
    ds_read_b64_tr_b16 v[178:179], v4 offset:53760
    ds_read_b64_tr_b16 v[180:181], v5 offset:53248
    ds_read_b64_tr_b16 v[182:183], v5 offset:53760
    buffer_load_dwordx4 v[120:123], v12, s[20:23], s51 offen
    s_add_u32 s51, s51, 131072
    s_waitcnt vmcnt(15)
    v_mfma_f32_16x16x32_bf16 v[16:19], v[240:243], v[132:135], v[16:19]
    ds_read_b64_tr_b16 v[184:185], v6 offset:53248
    ds_read_b64_tr_b16 v[186:187], v6 offset:53760
    ds_read_b64_tr_b16 v[188:189], v7 offset:53248
    v_mfma_f32_16x16x32_bf16 v[20:23], v[244:247], v[132:135], v[20:23]
    ds_read_b64_tr_b16 v[190:191], v7 offset:53760
    v_mfma_f32_16x16x32_bf16 v[24:27], v[248:251], v[132:135], v[24:27]
    v_mfma_f32_16x16x32_bf16 v[28:31], v[252:255], v[132:135], v[28:31]
    buffer_load_dwordx4 v[124:127], v12, s[20:23], s51 offen
    s_add_u32 s51, s51, 131072
    s_waitcnt lgkmcnt(0)
    s_barrier
    s_waitcnt vmcnt(15)
    v_mfma_f32_16x16x32_bf16 v[16:19], v[160:163], v[136:139], v[16:19]
    ds_read_b64_tr_b16 v[192:193], v4 offset:57344
    ds_read_b64_tr_b16 v[194:195], v4 offset:57856
    ds_read_b64_tr_b16 v[196:197], v5 offset:57344
    v_mfma_f32_16x16x32_bf16 v[20:23], v[164:167], v[136:139], v[20:23]
    ds_read_b64_tr_b16 v[198:199], v5 offset:57856
    ds_read_b64_tr_b16 v[200:201], v6 offset:57344
    ds_read_b64_tr_b16 v[202:203], v6 offset:57856
    v_mfma_f32_16x16x32_bf16 v[24:27], v[168:171], v[136:139], v[24:27]
    ds_read_b64_tr_b16 v[204:205], v7 offset:57344
    ds_read_b64_tr_b16 v[206:207], v7 offset:57856
    ds_read_b64_tr_b16 v[208:209], v4 offset:61440
    v_mfma_f32_16x16x32_bf16 v[28:31], v[172:175], v[136:139], v[28:31]
    ds_read_b64_tr_b16 v[210:211], v4 offset:61952
    ds_read_b64_tr_b16 v[212:213], v5 offset:61440
    ds_read_b64_tr_b16 v[214:215], v5 offset:61952
    buffer_load_dwordx4 v[128:131], v12, s[20:23], s51 offen
    s_add_u32 s51, s51, 131072
    s_waitcnt vmcnt(15)
    v_mfma_f32_16x16x32_bf16 v[16:19], v[176:179], v[140:143], v[16:19]
    ds_read_b64_tr_b16 v[216:217], v6 offset:61440
    ds_read_b64_tr_b16 v[218:219], v6 offset:61952
    ds_read_b64_tr_b16 v[220:221], v7 offset:61440
    v_mfma_f32_16x16x32_bf16 v[20:23], v[180:183], v[140:143], v[20:23]
    ds_read_b64_tr_b16 v[222:223], v7 offset:61952
    v_mfma_f32_16x16x32_bf16 v[24:27], v[184:187], v[140:143], v[24:27]
    v_mfma_f32_16x16x32_bf16 v[28:31], v[188:191], v[140:143], v[28:31]
    buffer_load_dwordx4 v[132:135], v12, s[20:23], s51 offen
    s_add_u32 s51, s51, 131072
    s_waitcnt lgkmcnt(0)
    s_barrier
    s_waitcnt vmcnt(15)
    v_mfma_f32_16x16x32_bf16 v[16:19], v[192:195], v[144:147], v[16:19]
    ds_read_b64_tr_b16 v[224:225], v8 offset:0
    ds_read_b64_tr_b16 v[226:227], v8 offset:512
    ds_read_b64_tr_b16 v[228:229], v9 offset:0
    v_mfma_f32_16x16x32_bf16 v[20:23], v[196:199], v[144:147], v[20:23]
    ds_read_b64_tr_b16 v[230:231], v9 offset:512
    ds_read_b64_tr_b16 v[232:233], v10 offset:0
    ds_read_b64_tr_b16 v[234:235], v10 offset:512
    v_mfma_f32_16x16x32_bf16 v[24:27], v[200:203], v[144:147], v[24:27]
    ds_read_b64_tr_b16 v[236:237], v11 offset:0
    ds_read_b64_tr_b16 v[238:239], v11 offset:512
    ds_read_b64_tr_b16 v[240:241], v8 offset:4096
    v_mfma_f32_16x16x32_bf16 v[28:31], v[204:207], v[144:147], v[28:31]
    ds_read_b64_tr_b16 v[242:243], v8 offset:4608
    ds_read_b64_tr_b16 v[244:245], v9 offset:4096
    ds_read_b64_tr_b16 v[246:247], v9 offset:4608
    buffer_load_dwordx4 v[136:139], v12, s[20:23], s51 offen
    s_add_u32 s51, s51, 131072
    s_waitcnt vmcnt(15)
    v_mfma_f32_16x16x32_bf16 v[16:19], v[208:211], v[148:151], v[16:19]
    ds_read_b64_tr_b16 v[248:249], v10 offset:4096
    ds_read_b64_tr_b16 v[250:251], v10 offset:4608
    ds_read_b64_tr_b16 v[252:253], v11 offset:4096
    v_mfma_f32_16x16x32_bf16 v[20:23], v[212:215], v[148:151], v[20:23]
    ds_read_b64_tr_b16 v[254:255], v11 offset:4608
    v_mfma_f32_16x16x32_bf16 v[24:27], v[216:219], v[148:151], v[24:27]
    v_mfma_f32_16x16x32_bf16 v[28:31], v[220:223], v[148:151], v[28:31]
    buffer_load_dwordx4 v[140:143], v12, s[20:23], s51 offen
    s_add_u32 s51, s51, 131072
    s_waitcnt lgkmcnt(0)
    s_barrier
    s_waitcnt vmcnt(15)
    v_mfma_f32_16x16x32_bf16 v[16:19], v[224:227], v[152:155], v[16:19]
    ds_read_b64_tr_b16 v[160:161], v4 offset:0
    ds_read_b64_tr_b16 v[162:163], v4 offset:512
    ds_read_b64_tr_b16 v[164:165], v5 offset:0
    v_mfma_f32_16x16x32_bf16 v[20:23], v[228:231], v[152:155], v[20:23]
    ds_read_b64_tr_b16 v[166:167], v5 offset:512
    ds_read_b64_tr_b16 v[168:169], v6 offset:0
    ds_read_b64_tr_b16 v[170:171], v6 offset:512
    v_mfma_f32_16x16x32_bf16 v[24:27], v[232:235], v[152:155], v[24:27]
    ds_read_b64_tr_b16 v[172:173], v7 offset:0
    ds_read_b64_tr_b16 v[174:175], v7 offset:512
    ds_read_b64_tr_b16 v[176:177], v4 offset:4096
    v_mfma_f32_16x16x32_bf16 v[28:31], v[236:239], v[152:155], v[28:31]
    ds_read_b64_tr_b16 v[178:179], v4 offset:4608
    ds_read_b64_tr_b16 v[180:181], v5 offset:4096
    ds_read_b64_tr_b16 v[182:183], v5 offset:4608
    buffer_load_dwordx4 v[144:147], v12, s[20:23], s51 offen
    s_add_u32 s51, s51, 131072
    s_waitcnt vmcnt(15)
    v_mfma_f32_16x16x32_bf16 v[16:19], v[240:243], v[156:159], v[16:19]
    ds_read_b64_tr_b16 v[184:185], v6 offset:4096
    ds_read_b64_tr_b16 v[186:187], v6 offset:4608
    ds_read_b64_tr_b16 v[188:189], v7 offset:4096
    v_mfma_f32_16x16x32_bf16 v[20:23], v[244:247], v[156:159], v[20:23]
    ds_read_b64_tr_b16 v[190:191], v7 offset:4608
    v_mfma_f32_16x16x32_bf16 v[24:27], v[248:251], v[156:159], v[24:27]
    v_mfma_f32_16x16x32_bf16 v[28:31], v[252:255], v[156:159], v[28:31]
    buffer_load_dwordx4 v[148:151], v12, s[20:23], s51 offen
    s_add_u32 s51, s51, 131072
    s_waitcnt lgkmcnt(0)
    s_sub_u32 s50, s50, 1
    s_cmp_lg_u32 s50, 0
    s_cbranch_scc1 recurrent_scan__sliding_local_dilated__mixer_gmlp__prompt_kernel_Cloop
    s_mov_b32 s40, 0xbfb8aa3b
    s_nop 4
    v_mul_f32 v56, s40, v16
    v_mul_f32 v57, s40, v17
    v_mul_f32 v58, s40, v18
    v_mul_f32 v59, s40, v19
    v_mul_f32 v60, s40, v20
    v_mul_f32 v61, s40, v21
    v_mul_f32 v62, s40, v22
    v_mul_f32 v63, s40, v23
    v_mul_f32 v64, s40, v24
    v_mul_f32 v65, s40, v25
    v_mul_f32 v66, s40, v26
    v_mul_f32 v67, s40, v27
    v_mul_f32 v68, s40, v28
    v_mul_f32 v69, s40, v29
    v_mul_f32 v70, s40, v30
    v_mul_f32 v71, s40, v31
    v_exp_f32 v56, v56
    v_exp_f32 v57, v57
    v_exp_f32 v58, v58
    v_exp_f32 v59, v59
    v_exp_f32 v60, v60
    v_exp_f32 v61, v61
    v_exp_f32 v62, v62
    v_exp_f32 v63, v63
    v_exp_f32 v64, v64
    v_exp_f32 v65, v65
    v_exp_f32 v66, v66
    v_exp_f32 v67, v67
    v_exp_f32 v68, v68
    v_exp_f32 v69, v69
    v_exp_f32 v70, v70
    v_exp_f32 v71, v71
    v_mul_f32 v32, v32, v16
    v_mul_f32 v33, v33, v17
    v_mul_f32 v34, v34, v18
    v_mul_f32 v35, v35, v19
    v_mul_f32 v36, v36, v20
    v_mul_f32 v37, v37, v21
    v_mul_f32 v38, v38, v22
    v_mul_f32 v39, v39, v23
    v_mul_f32 v40, v40, v24
    v_mul_f32 v41, v41, v25
    v_mul_f32 v42, v42, v26
    v_mul_f32 v43, v43, v27
    v_mul_f32 v44, v44, v28
    v_mul_f32 v45, v45, v29
    v_mul_f32 v46, v46, v30
    v_mul_f32 v47, v47, v31
    v_add_f32 v56, 1.0, v56
    v_add_f32 v57, 1.0, v57
    v_add_f32 v58, 1.0, v58
    v_add_f32 v59, 1.0, v59
    v_add_f32 v60, 1.0, v60
    v_add_f32 v61, 1.0, v61
    v_add_f32 v62, 1.0, v62
    v_add_f32 v63, 1.0, v63
    v_add_f32 v64, 1.0, v64
    v_add_f32 v65, 1.0, v65
    v_add_f32 v66, 1.0, v66
    v_add_f32 v67, 1.0, v67
    v_add_f32 v68, 1.0, v68
    v_add_f32 v69, 1.0, v69
    v_add_f32 v70, 1.0, v70
    v_add_f32 v71, 1.0, v71
    v_rcp_f32 v56, v56
    v_rcp_f32 v57, v57
    v_rcp_f32 v58, v58
    v_rcp_f32 v59, v59
    v_rcp_f32 v60, v60
    v_rcp_f32 v61, v61
    v_rcp_f32 v62, v62
    v_rcp_f32 v63, v63
    v_rcp_f32 v64, v64
    v_rcp_f32 v65, v65
    v_rcp_f32 v66, v66
    v_rcp_f32 v67, v67
    v_rcp_f32 v68, v68
    v_rcp_f32 v69, v69
    v_rcp_f32 v70, v70
    v_rcp_f32 v71, v71
    v_mul_f32 v32, v32, v56
    v_mul_f32 v33, v33, v57
    v_mul_f32 v34, v34, v58
    v_mul_f32 v35, v35, v59
    v_mul_f32 v36, v36, v60
    v_mul_f32 v37, v37, v61
    v_mul_f32 v38, v38, v62
    v_mul_f32 v39, v39, v63
    v_mul_f32 v40, v40, v64
    v_mul_f32 v41, v41, v65
    v_mul_f32 v42, v42, v66
    v_mul_f32 v43, v43, v67
    v_mul_f32 v44, v44, v68
    v_mul_f32 v45, v45, v69
    v_mul_f32 v46, v46, v70
    v_mul_f32 v47, v47, v71
    v_permlane16_swap_b32 v48, v50
    v_permlane16_swap_b32 v49, v51
    v_lshlrev_b32 v56, 16, v48
    v_and_b32 v57, 0xffff0000, v48
    v_add_f32 v56, v56, v32
    v_add_f32 v57, v57, v33
    v_cvt_pk_bf16_f32 v48, v56, v57
    v_lshlrev_b32 v56, 16, v49
    v_and_b32 v57, 0xffff0000, v49
    v_add_f32 v56, v56, v34
    v_add_f32 v57, v57, v35
    v_cvt_pk_bf16_f32 v49, v56, v57
    v_lshlrev_b32 v56, 16, v50
    v_and_b32 v57, 0xffff0000, v50
    v_add_f32 v56, v56, v36
    v_add_f32 v57, v57, v37
    v_cvt_pk_bf16_f32 v50, v56, v57
    v_lshlrev_b32 v56, 16, v51
    v_and_b32 v57, 0xffff0000, v51
    v_add_f32 v56, v56, v38
    v_add_f32 v57, v57, v39
    v_cvt_pk_bf16_f32 v51, v56, v57
    v_permlane16_swap_b32 v48, v50
    s_nop 0
    v_permlane16_swap_b32 v49, v51
    buffer_store_dwordx4 v[48:51], v3, s[28:31], s41 offen offset:0
    v_permlane16_swap_b32 v52, v54
    v_permlane16_swap_b32 v53, v55
    v_lshlrev_b32 v56, 16, v52
    v_and_b32 v57, 0xffff0000, v52
    v_add_f32 v56, v56, v40
    v_add_f32 v57, v57, v41
    v_cvt_pk_bf16_f32 v52, v56, v57
    v_lshlrev_b32 v56, 16, v53
    v_and_b32 v57, 0xffff0000, v53
    v_add_f32 v56, v56, v42
    v_add_f32 v57, v57, v43
    v_cvt_pk_bf16_f32 v53, v56, v57
    v_lshlrev_b32 v56, 16, v54
    v_and_b32 v57, 0xffff0000, v54
    v_add_f32 v56, v56, v44
    v_add_f32 v57, v57, v45
    v_cvt_pk_bf16_f32 v54, v56, v57
    v_lshlrev_b32 v56, 16, v55
    v_and_b32 v57, 0xffff0000, v55
    v_add_f32 v56, v56, v46
    v_add_f32 v57, v57, v47
    v_cvt_pk_bf16_f32 v55, v56, v57
    v_permlane16_swap_b32 v52, v54
    s_nop 0
    v_permlane16_swap_b32 v53, v55
    buffer_store_dwordx4 v[52:55], v3, s[28:31], s41 offen offset:64
    s_endpgm
recurrent_scan__sliding_local_dilated__mixer_gmlp__prompt_kernel_Cp:
    s_cmp_ge_u32 s2, 234
    s_cbranch_scc1 recurrent_scan__sliding_local_dilated__mixer_gmlp__prompt_kernel_end
    s_load_dwordx2 s[4:5], s[0:1], 0
    s_load_dwordx2 s[6:7], s[0:1], 16
    s_load_dwordx4 s[8:11], s[0:1], 56
    s_and_b32 s40, s2, 7
    s_lshr_b32 s41, s2, 3
    s_mul_i32 s42, s40, 29
    s_min_u32 s40, s40, 2
    s_add_u32 s42, s42, s40
    s_add_u32 s42, s42, s41
    s_mul_i32 s37, s42, 7282
    s_lshr_b32 s37, s37, 16
    s_mul_i32 s40, s37, 9
    s_sub_u32 s38, s42, s40
    s_sub_u32 s53, 73728, s101
    v_lshrrev_b32 v8, 3, v1
    v_and_b32 v9, 7, v1
    v_lshrrev_b32 v10, 3, v1
    v_and_b32 v10, 2, v10
    v_xor_b32 v9, v9, v10
    v_lshlrev_b32 v9, 4, v9
    v_mul_u32_u24 v2, 1152, v8
    v_add_u32 v2, v2, v9
    v_xor_b32 v3, 64, v2
    v_add_u32 v3, 8192, v3
    v_add_u32 v4, 16384, v2
    v_add_u32 v5, 16384, v3
    s_sub_u32 s40, s36, 4
    s_mul_i32 s52, s40, 36864
    s_lshl_b32 s41, s38, 7
    s_add_u32 s52, s52, s41
    s_mov_b32 s43, s52
    s_lshl_b32 s42, s40, 12
    s_add_u32 s42, s42, s53
    s_add_u32 s45, s53, 73728
    s_mov_b32 s44, s42
    s_mul_i32 s46, s37, 80
    s_add_u32 s47, s46, 79
    s_min_u32 s47, s47, 2047
    s_lshr_b32 s48, s46, 7
    s_lshl_b32 s48, s48, 8
    s_add_u32 s48, s48, 8192
    s_lshr_b32 s49, s47, 7
    s_lshl_b32 s49, s49, 8
    s_add_u32 s49, s49, 8192
    v_lshlrev_b32 v8, 2, v1
    s_waitcnt lgkmcnt(0)
    s_mov_b32 s32, s6
    s_mov_b32 s33, s7
    s_mov_b32 s34, 663552
    s_mov_b32 s35, 0x00020000
    s_barrier
    s_mov_b32 m0, s44
    s_add_u32 s44, s44, 8192
    buffer_load_dwordx4 v2, s[32:35], s52 offen offset:0  lds
    buffer_load_dwordx4 v3, s[32:35], s52 offen offset:1024  lds
    buffer_load_dwordx4 v4, s[32:35], s52 offen offset:2048  lds
    buffer_load_dwordx4 v5, s[32:35], s52 offen offset:3072  lds
    s_add_u32 s52, s52, 73728
    s_cmp_ge_u32 s44, s45
    s_cselect_b32 s44, s42, s44
    s_mov_b32 m0, s44
    s_add_u32 s44, s44, 8192
    buffer_load_dwordx4 v2, s[32:35], s52 offen offset:0  lds
    buffer_load_dwordx4 v3, s[32:35], s52 offen offset:1024  lds
    buffer_load_dwordx4 v4, s[32:35], s52 offen offset:2048  lds
    buffer_load_dwordx4 v5, s[32:35], s52 offen offset:3072  lds
    s_add_u32 s52, s52, 73728
    s_cmp_ge_u32 s44, s45
    s_cselect_b32 s44, s42, s44
    s_mov_b32 m0, s44
    s_add_u32 s44, s44, 8192
    buffer_load_dwordx4 v2, s[32:35], s52 offen offset:0  lds
    buffer_load_dwordx4 v3, s[32:35], s52 offen offset:1024  lds
    buffer_load_dwordx4 v4, s[32:35], s52 offen offset:2048  lds
    buffer_load_dwordx4 v5, s[32:35], s52 offen offset:3072  lds
    s_add_u32 s52, s52, 73728
    s_cmp_ge_u32 s44, s45
    s_cselect_b32 s44, s42, s44
    s_mov_b32 m0, s44
    s_add_u32 s44, s44, 8192
    buffer_load_dwordx4 v2, s[32:35], s52 offen offset:0  lds
    buffer_load_dwordx4 v3, s[32:35], s52 offen offset:1024  lds
    buffer_load_dwordx4 v4, s[32:35], s52 offen offset:2048  lds
    buffer_load_dwordx4 v5, s[32:35], s52 offen offset:3072  lds
    s_add_u32 s52, s52, 73728
    s_cmp_ge_u32 s44, s45
    s_cselect_b32 s44, s42, s44
    s_barrier
    s_mov_b32 m0, s44
    s_add_u32 s44, s44, 8192
    buffer_load_dwordx4 v2, s[32:35], s52 offen offset:0  lds
    buffer_load_dwordx4 v3, s[32:35], s52 offen offset:1024  lds
    buffer_load_dwordx4 v4, s[32:35], s52 offen offset:2048  lds
    buffer_load_dwordx4 v5, s[32:35], s52 offen offset:3072  lds
    s_add_u32 s52, s52, 73728
    s_cmp_ge_u32 s44, s45
    s_cselect_b32 s44, s42, s44
    s_mov_b32 m0, s44
    s_add_u32 s44, s44, 8192
    buffer_load_dwordx4 v2, s[32:35], s52 offen offset:0  lds
    buffer_load_dwordx4 v3, s[32:35], s52 offen offset:1024  lds
    buffer_load_dwordx4 v4, s[32:35], s52 offen offset:2048  lds
    buffer_load_dwordx4 v5, s[32:35], s52 offen offset:3072  lds
    s_add_u32 s52, s52, 73728
    s_cmp_ge_u32 s44, s45
    s_cselect_b32 s44, s42, s44
    s_mov_b32 m0, s44
    s_add_u32 s44, s44, 8192
    buffer_load_dwordx4 v2, s[32:35], s52 offen offset:0  lds
    buffer_load_dwordx4 v3, s[32:35], s52 offen offset:1024  lds
    buffer_load_dwordx4 v4, s[32:35], s52 offen offset:2048  lds
    buffer_load_dwordx4 v5, s[32:35], s52 offen offset:3072  lds
    s_add_u32 s52, s52, 73728
    s_cmp_ge_u32 s44, s45
    s_cselect_b32 s44, s42, s44
    s_mov_b32 m0, s44
    s_add_u32 s44, s44, 8192
    buffer_load_dwordx4 v2, s[32:35], s52 offen offset:0  lds
    buffer_load_dwordx4 v3, s[32:35], s52 offen offset:1024  lds
    buffer_load_dwordx4 v4, s[32:35], s52 offen offset:2048  lds
    buffer_load_dwordx4 v5, s[32:35], s52 offen offset:3072  lds
    s_add_u32 s52, s52, 73728
    s_cmp_ge_u32 s44, s45
    s_cselect_b32 s44, s42, s44
    s_mov_b32 m0, s44
    s_add_u32 s44, s44, 8192
    buffer_load_dwordx4 v2, s[32:35], s52 offen offset:0  lds
    buffer_load_dwordx4 v3, s[32:35], s52 offen offset:1024  lds
    buffer_load_dwordx4 v4, s[32:35], s52 offen offset:2048  lds
    buffer_load_dwordx4 v5, s[32:35], s52 offen offset:3072  lds
    s_add_u32 s52, s52, 73728
    s_cmp_ge_u32 s44, s45
    s_cselect_b32 s44, s42, s44
    s_mov_b32 s32, s8
    s_mov_b32 s33, s9
    s_mov_b32 s34, 2654208
    s_mov_b32 s35, 0x00020000
    s_mov_b32 s52, s43
    s_waitcnt vmcnt(32)
    s_barrier
    s_mov_b32 s50, 7
recurrent_scan__sliding_local_dilated__mixer_gmlp__prompt_kernel_Cploop:
    s_waitcnt vmcnt(28)
    s_barrier
    s_mov_b32 m0, s44
    s_add_u32 s44, s44, 8192
    buffer_load_dwordx4 v2, s[32:35], s52 offen offset:0  lds
    buffer_load_dwordx4 v3, s[32:35], s52 offen offset:1024  lds
    buffer_load_dwordx4 v4, s[32:35], s52 offen offset:2048  lds
    buffer_load_dwordx4 v5, s[32:35], s52 offen offset:3072  lds
    s_add_u32 s52, s52, 73728
    s_cmp_ge_u32 s44, s45
    s_cselect_b32 s44, s42, s44
    s_sub_u32 s50, s50, 1
    s_cmp_lg_u32 s50, 0
    s_cbranch_scc1 recurrent_scan__sliding_local_dilated__mixer_gmlp__prompt_kernel_Cploop
    s_mov_b32 s50, 20000
recurrent_scan__sliding_local_dilated__mixer_gmlp__prompt_kernel_pu:
    buffer_load_dword v16, v8, s[64:67], s48 offen sc1
    buffer_load_dword v17, v8, s[64:67], s49 offen sc1
    s_waitcnt vmcnt(0)
    v_xor_b32 v16, s100, v16
    v_xor_b32 v17, s100, v17
    v_or_b32 v16, v16, v17
    v_cmp_ne_u32 vcc, 0, v16
    s_sub_u32 s50, s50, 1
    s_cmp_eq_u32 s50, 0
    s_cbranch_scc1 recurrent_scan__sliding_local_dilated__mixer_gmlp__prompt_kernel_pu_ok
    s_cmp_eq_u64 vcc, 0
    s_cbranch_scc1 recurrent_scan__sliding_local_dilated__mixer_gmlp__prompt_kernel_pu_ok
    s_sleep 8
    s_branch recurrent_scan__sliding_local_dilated__mixer_gmlp__prompt_kernel_pu
recurrent_scan__sliding_local_dilated__mixer_gmlp__prompt_kernel_pu_ok:
    s_mov_b32 s50, 29
recurrent_scan__sliding_local_dilated__mixer_gmlp__prompt_kernel_Cploop2:
    s_waitcnt vmcnt(28)
    s_barrier
    s_mov_b32 m0, s44
    s_add_u32 s44, s44, 8192
    buffer_load_dwordx4 v2, s[32:35], s52 offen offset:0  lds
    buffer_load_dwordx4 v3, s[32:35], s52 offen offset:1024  lds
    buffer_load_dwordx4 v4, s[32:35], s52 offen offset:2048  lds
    buffer_load_dwordx4 v5, s[32:35], s52 offen offset:3072  lds
    s_add_u32 s52, s52, 73728
    s_cmp_ge_u32 s44, s45
    s_cselect_b32 s44, s42, s44
    s_sub_u32 s50, s50, 1
    s_cmp_lg_u32 s50, 0
    s_cbranch_scc1 recurrent_scan__sliding_local_dilated__mixer_gmlp__prompt_kernel_Cploop2
    s_waitcnt vmcnt(28)
    s_barrier
    s_waitcnt vmcnt(24)
    s_barrier
    s_waitcnt vmcnt(20)
    s_barrier
    s_waitcnt vmcnt(16)
    s_barrier
    s_waitcnt vmcnt(12)
    s_barrier
    s_waitcnt vmcnt(8)
    s_barrier
    s_waitcnt vmcnt(4)
    s_barrier
    s_waitcnt vmcnt(0)
    s_barrier
recurrent_scan__sliding_local_dilated__mixer_gmlp__prompt_kernel_end:
    s_endpgm
code_end:
.section .rodata,"a"
.p2align 6
.amdhsa_kernel recurrent_scan__sliding_local_dilated__mixer_gmlp__prompt_kernel
  .amdhsa_next_free_vgpr 256
  .amdhsa_next_free_sgpr 102
  .amdhsa_accum_offset 256
  .amdhsa_group_segment_fixed_size 0
  .amdhsa_kernarg_size 88
  .amdhsa_user_sgpr_count 2
  .amdhsa_user_sgpr_kernarg_segment_ptr 1
  .amdhsa_system_sgpr_workgroup_id_x 1
.end_amdhsa_kernel
```
